```python
import torch

def _softmax(x, axis=-1):
    return torch.softmax(x, dim=axis)

def _gelu(x):
    return torch.nn.functional.gelu(x, approximate='tanh')

def _silu(x):
    return torch.nn.functional.silu(x)

def _sigmoid(x):
    return torch.sigmoid(x)

def _layernorm(x, axis=-1, eps=1e-05):
    m = x.mean(dim=axis, keepdim=True)
    v = x.var(dim=axis, keepdim=True, unbiased=False)
    return (x - m) / torch.sqrt(v + eps)

def _scatter_add(tgt, idx, src, axis=0):
    return tgt.clone().index_add_(axis, idx, src)

def _segment_sum(src, seg, n):
    out = torch.zeros((n,) + src.shape[1:], dtype=src.dtype)
    return out.index_add_(0, seg, src)

def _pad(x, pw):
    flat = tuple((v for pair in reversed(pw) for v in pair))
    return torch.nn.functional.pad(x, flat)
kernel_name = 'parallel_sum__linear_kernel_hedgehog__mixer_gmlp__prompt'

def setup_inputs():

    _w = lambda a: (lambda t: t.to(torch.bfloat16) if t.is_floating_point() else t)(torch.as_tensor(a))

    def _A_setup():
        B, S, D, H = (1, 2048, 448, 16)
        Dh = D // H
        return {'x': _w((lambda *s: torch.randn(*s, dtype=torch.bfloat16) * 0.05)(B, S, D)), 'wqkv': _w((lambda *s: torch.randn(*s, dtype=torch.bfloat16) * 0.8)(D, 3 * D)), 'w_phi': _w((lambda *s: torch.randn(*s, dtype=torch.bfloat16) * 0.8)(H, Dh, Dh) * Dh ** (-0.5)), 'wo': _w((lambda *s: torch.randn(*s, dtype=torch.bfloat16) * 0.1)(D, D))}
    _A_in = _A_setup()

    def _B_setup():
        B, S, D, F = (1, 2048, 448, 1792)
        Fh = F // 2
        return {'x': _w((lambda *s: torch.randn(*s, dtype=torch.bfloat16) * 0.05)(B, S, D)), 'w_in': _w((lambda *s: torch.randn(*s, dtype=torch.bfloat16) * 0.4)(D, 2 * Fh)), 'w_sp': _w(0.01 * (lambda *s: torch.randn(*s, dtype=torch.bfloat16) * 0.4)(S, S)), 'b_sp': _w(1.0 + 0.01 * (lambda *s: torch.randn(*s, dtype=torch.bfloat16) * 0.05)(S)), 'w_out': _w((lambda *s: torch.randn(*s, dtype=torch.bfloat16) * 0.05)(Fh, D))}
    _B_in = _B_setup()
    return {'A_x': _A_in['x'], 'A_wqkv': _A_in['wqkv'], 'A_w_phi': _A_in['w_phi'], 'A_wo': _A_in['wo'], 'B_x': _B_in['x'], 'B_w_in': _B_in['w_in'], 'B_w_sp': _B_in['w_sp'], 'B_b_sp': _B_in['b_sp'], 'B_w_out': _B_in['w_out']}

def reference(A_x, A_wqkv, A_w_phi, A_wo, B_x, B_w_in, B_w_sp, B_b_sp, B_w_out):

    def _A_ref(x, wqkv, w_phi, wo):
        B, S, D = x.shape
        H = 16
        Dh = D // H
        qkv = (lambda x, *d: x.permute(*d))((x @ wqkv).reshape(B, S, 3, H, Dh), 2, 0, 3, 1, 4)
        q, k, v = (qkv[0], qkv[1], qkv[2])
        pq = torch.einsum('bhsd,hdf->bhsf', q, w_phi)
        pk = torch.einsum('bhsd,hdf->bhsf', k, w_phi)
        phi_q = torch.concatenate([_softmax(pq, axis=-1), _softmax(-pq, axis=-1)], axis=-1)
        phi_k = torch.concatenate([_softmax(pk, axis=-1), _softmax(-pk, axis=-1)], axis=-1)
        kv = torch.einsum('bhsf,bhsd->bhfd', phi_k, v)
        z = torch.einsum('bhsf->bhf', phi_k)
        num = torch.einsum('bhqf,bhfd->bhqd', phi_q, kv)
        den = torch.einsum('bhqf,bhf->bhq', phi_q, z)[..., None] + 1e-06
        o = num / den
        return (lambda x, *d: x.permute(*d))(o, 0, 2, 1, 3).reshape(B, S, D) @ wo

    def _B_ref(x, w_in, w_sp, b_sp, w_out):
        B, S, D = x.shape
        F = w_in.shape[-1]
        Fh = F // 2
        z = _gelu(torch.einsum('bsd,df->bsf', x, w_in))
        z1 = z[..., :Fh].clone()
        z2 = _layernorm(z[..., Fh:], axis=-1)
        g = torch.einsum('ts,bsf->btf', w_sp, z2) + b_sp[None, :, None]
        return torch.einsum('bsf,fd->bsd', z1 * g, w_out)
    x = A_x
    xn = _layernorm(x, axis=-1)
    return x + _A_ref(xn, A_wqkv, A_w_phi, A_wo) + _B_ref(xn, B_w_in, B_w_sp, B_b_sp, B_w_out)
```

```asm
; @launch kernel=k1_front_kernel grid=(256,1,1) block=(512,1,1) lds=159744
; @launch kernel=k2_spatial_kernel grid=(256,1,1) block=(256,1,1) lds=147456
; @launch kernel=k3_final_kernel grid=(256,1,1) block=(256,1,1) lds=98304
.amdgcn_target "amdgcn-amd-amdhsa--gfx950"
.text
.globl k1_front_kernel
.p2align 8
.type k1_front_kernel,@function
k1_front_kernel:
    s_cmp_ge_u32 s2, 256
    s_cbranch_scc1 K1_EXIT
    s_load_dwordx4 s[4:7], s[0:1], 0
    s_load_dwordx4 s[32:35], s[0:1], 16
    s_load_dwordx2 s[36:37], s[0:1], 40
    s_load_dwordx2 s[38:39], s[0:1], 64
    s_load_dwordx4 s[40:43], s[0:1], 80
    s_and_b32 s44, s2, 7
    s_lshr_b32 s45, s2, 3
    s_lshr_b32 s46, s45, 3
    s_lshl_b32 s54, s44, 2
    s_add_u32 s46, s46, s54
    s_and_b32 s47, s45, 7
    s_lshr_b32 s68, s47, 1
    s_and_b32 s69, s47, 1
    v_and_b32 v1, 63, v0
    v_lshrrev_b32 v2, 6, v0
    s_nop 0
    v_readfirstlane_b32 s81, v2
    s_nop 1
    s_and_b32 s48, s81, 3
    s_lshr_b32 s80, s81, 2
    v_lshrrev_b32 v2, 4, v1
    v_and_b32 v3, 15, v1
    s_waitcnt lgkmcnt(0)
    s_mov_b32 s12, s4
    s_mov_b32 s13, s5
    s_mov_b32 s14, 1835008
    s_mov_b32 s15, 0x00020000
    s_mov_b32 s20, s32
    s_mov_b32 s21, s33
    s_mov_b32 s22, 25088
    s_mov_b32 s23, 0x00020000
    s_add_u32 s24, s42, 25165824
    s_addc_u32 s25, s43, 0
    s_mov_b32 s26, 32768
    s_mov_b32 s27, 0x00020000
    s_mov_b32 s28, s40
    s_mov_b32 s29, s41
    s_mov_b32 s30, 256
    s_mov_b32 s31, 0x00020000
    s_cmp_lt_u32 s68, 2
    s_cselect_b32 s8, s6, s36
    s_cselect_b32 s9, s7, s37
    s_mov_b32 s10, 1605632
    s_cselect_b32 s10, 1204224, s10
    s_mov_b32 s11, 0x00020000
    s_mov_b32 s49, 3584
    s_cselect_b32 s49, 2688, s49
    s_mul_i32 s56, s49, 28
    v_lshrrev_b32 v8, 3, v1
    s_lshl_b32 s54, s46, 6
    s_lshl_b32 s55, s81, 3
    s_add_u32 s54, s54, s55
    v_add_u32 v9, s54, v8
    v_mul_u32_u24 v9, 896, v9
    v_and_b32 v10, 7, v1
    v_mul_u32_u24 v10, 112, v10
    v_add_u32 v9, v9, v10
    buffer_load_dwordx4 v[16:19], v9, s[12:15], 0 offen offset:0
    buffer_load_dwordx4 v[20:23], v9, s[12:15], 0 offen offset:16
    buffer_load_dwordx4 v[24:27], v9, s[12:15], 0 offen offset:32
    buffer_load_dwordx4 v[28:31], v9, s[12:15], 0 offen offset:48
    buffer_load_dwordx4 v[32:35], v9, s[12:15], 0 offen offset:64
    buffer_load_dwordx4 v[36:39], v9, s[12:15], 0 offen offset:80
    buffer_load_dwordx4 v[40:43], v9, s[12:15], 0 offen offset:96
    v_add_u32 v8, s55, v8
    v_mul_u32_u24 v14, 912, v8
    v_add_u32 v14, v14, v10
    v_lshlrev_b32 v4, 4, v1
    s_mul_i32 s54, s69, 448
    s_add_u32 s55, s54, 896
    s_sub_u32 s57, s47, 4
    s_mul_i32 s57, s57, 896
    s_cmp_eq_u32 s68, 1
    s_cselect_b32 s54, s55, s54
    s_cmp_ge_u32 s68, 2
    s_cselect_b32 s54, s57, s54
    v_add_u32 v4, s54, v4
    s_cmp_eq_u32 s68, 1
    s_cselect_b32 s57, 448, 0
    v_mov_b32 v8, s57
    v_cmp_le_u32 vcc, 28, v1
    s_nop 1
    v_cndmask_b32 v8, 0, v8, vcc
    v_add_u32 v4, v4, v8
    s_mul_i32 s55, s81, 4224
    s_lshr_b32 s54, s81, 1
    s_and_b32 s54, s54, 1
    s_lshl_b32 s54, s54, 7
    s_add_u32 s55, s55, s54
    s_cmp_eq_u32 s68, 0
    s_cselect_b32 s66, 0x1fffffff, -1
    s_cselect_b32 s67, 0, 0x01ffffff
    s_lshl_b32 s54, s81, 2
    s_mul_i32 s50, s54, s49
    s_mov_b32 s51, 58368
    s_mov_b32 s52, 58368
    s_lshr_b32 s54, s45, 3
    s_mul_i32 s54, s54, 112
    s_mul_i32 s57, s81, 14
    s_add_u32 s54, s54, s57
    s_mul_i32 s73, s54, s49
    s_add_u32 m0, s55, 58368
    s_mov_b64 exec, s[66:67]
    buffer_load_dwordx4 v4, s[8:11], s50 offen lds
    s_mov_b64 exec, -1
    s_add_u32 s50, s50, s49
    s_add_u32 m0, s55, 59424
    s_mov_b64 exec, s[66:67]
    buffer_load_dwordx4 v4, s[8:11], s50 offen lds
    s_mov_b64 exec, -1
    s_add_u32 s50, s50, s49
    s_add_u32 m0, s55, 60480
    s_mov_b64 exec, s[66:67]
    buffer_load_dwordx4 v4, s[8:11], s50 offen lds
    s_mov_b64 exec, -1
    s_add_u32 s50, s50, s49
    s_add_u32 m0, s55, 61536
    s_mov_b64 exec, s[66:67]
    buffer_load_dwordx4 v4, s[8:11], s50 offen lds
    s_mov_b64 exec, -1
    s_add_u32 s50, s50, s49
    s_add_u32 s50, s50, s56
    v_mul_u32_u24 v5, 912, v3
    v_lshl_add_u32 v5, v2, 4, v5
    s_mul_i32 s54, s80, 29184
    v_add_u32 v5, s54, v5
    v_lshrrev_b32 v8, 2, v3
    v_lshl_add_u32 v8, v2, 3, v8
    v_mul_u32_u24 v6, 1056, v8
    v_and_b32 v8, 3, v3
    v_lshl_add_u32 v6, v8, 3, v6
    v_and_b32 v8, 1, v2
    v_lshl_add_u32 v6, v8, 7, v6
    s_mul_i32 s54, s48, 224
    s_mul_i32 s57, s48, 112
    s_cmp_lt_u32 s68, 2
    s_cselect_b32 s54, s57, s54
    v_add_u32 v6, s54, v6
    v_mov_b32 v8, 0
    v_mov_b32 v9, 0
    v_mov_b32 v12, 0
    v_mov_b32 v13, 0
    s_waitcnt vmcnt(4)
    v_mov_b32 v72, 0
    v_mov_b32 v73, 0
    v_mov_b32 v74, 0
    v_mov_b32 v75, 0
    v_lshlrev_b32 v76, 16, v16
    v_and_b32 v77, 0xffff0000, v16
    v_lshlrev_b32 v78, 16, v17
    v_and_b32 v79, 0xffff0000, v17
    v_pk_add_f32 v[8:9], v[8:9], v[76:77]
    v_pk_add_f32 v[72:73], v[72:73], v[78:79]
    v_pk_fma_f32 v[12:13], v[76:77], v[76:77], v[12:13]
    v_pk_fma_f32 v[74:75], v[78:79], v[78:79], v[74:75]
    s_mov_b64 exec, s[66:67]
    buffer_load_dwordx4 v[192:195], v4, s[8:11], s73 offen
    s_mov_b64 exec, -1
    s_add_u32 s73, s73, s49
    v_lshlrev_b32 v76, 16, v18
    v_and_b32 v77, 0xffff0000, v18
    v_lshlrev_b32 v78, 16, v19
    v_and_b32 v79, 0xffff0000, v19
    v_pk_add_f32 v[8:9], v[8:9], v[76:77]
    v_pk_add_f32 v[72:73], v[72:73], v[78:79]
    v_pk_fma_f32 v[12:13], v[76:77], v[76:77], v[12:13]
    v_pk_fma_f32 v[74:75], v[78:79], v[78:79], v[74:75]
    s_mov_b64 exec, s[66:67]
    buffer_load_dwordx4 v[196:199], v4, s[8:11], s73 offen
    s_mov_b64 exec, -1
    s_add_u32 s73, s73, s49
    v_lshlrev_b32 v76, 16, v20
    v_and_b32 v77, 0xffff0000, v20
    v_lshlrev_b32 v78, 16, v21
    v_and_b32 v79, 0xffff0000, v21
    v_pk_add_f32 v[8:9], v[8:9], v[76:77]
    v_pk_add_f32 v[72:73], v[72:73], v[78:79]
    v_pk_fma_f32 v[12:13], v[76:77], v[76:77], v[12:13]
    v_pk_fma_f32 v[74:75], v[78:79], v[78:79], v[74:75]
    s_mov_b64 exec, s[66:67]
    buffer_load_dwordx4 v[200:203], v4, s[8:11], s73 offen
    s_mov_b64 exec, -1
    s_add_u32 s73, s73, s49
    v_lshlrev_b32 v76, 16, v22
    v_and_b32 v77, 0xffff0000, v22
    v_lshlrev_b32 v78, 16, v23
    v_and_b32 v79, 0xffff0000, v23
    v_pk_add_f32 v[8:9], v[8:9], v[76:77]
    v_pk_add_f32 v[72:73], v[72:73], v[78:79]
    v_pk_fma_f32 v[12:13], v[76:77], v[76:77], v[12:13]
    v_pk_fma_f32 v[74:75], v[78:79], v[78:79], v[74:75]
    s_mov_b64 exec, s[66:67]
    buffer_load_dwordx4 v[204:207], v4, s[8:11], s73 offen
    s_mov_b64 exec, -1
    s_add_u32 s73, s73, s49
    v_lshlrev_b32 v76, 16, v24
    v_and_b32 v77, 0xffff0000, v24
    v_lshlrev_b32 v78, 16, v25
    v_and_b32 v79, 0xffff0000, v25
    v_pk_add_f32 v[8:9], v[8:9], v[76:77]
    v_pk_add_f32 v[72:73], v[72:73], v[78:79]
    v_pk_fma_f32 v[12:13], v[76:77], v[76:77], v[12:13]
    v_pk_fma_f32 v[74:75], v[78:79], v[78:79], v[74:75]
    s_mov_b64 exec, s[66:67]
    buffer_load_dwordx4 v[208:211], v4, s[8:11], s73 offen
    s_mov_b64 exec, -1
    s_add_u32 s73, s73, s49
    v_lshlrev_b32 v76, 16, v26
    v_and_b32 v77, 0xffff0000, v26
    v_lshlrev_b32 v78, 16, v27
    v_and_b32 v79, 0xffff0000, v27
    v_pk_add_f32 v[8:9], v[8:9], v[76:77]
    v_pk_add_f32 v[72:73], v[72:73], v[78:79]
    v_pk_fma_f32 v[12:13], v[76:77], v[76:77], v[12:13]
    v_pk_fma_f32 v[74:75], v[78:79], v[78:79], v[74:75]
    s_mov_b64 exec, s[66:67]
    buffer_load_dwordx4 v[212:215], v4, s[8:11], s73 offen
    s_mov_b64 exec, -1
    s_add_u32 s73, s73, s49
    v_lshlrev_b32 v76, 16, v28
    v_and_b32 v77, 0xffff0000, v28
    v_lshlrev_b32 v78, 16, v29
    v_and_b32 v79, 0xffff0000, v29
    v_pk_add_f32 v[8:9], v[8:9], v[76:77]
    v_pk_add_f32 v[72:73], v[72:73], v[78:79]
    v_pk_fma_f32 v[12:13], v[76:77], v[76:77], v[12:13]
    v_pk_fma_f32 v[74:75], v[78:79], v[78:79], v[74:75]
    s_mov_b64 exec, s[66:67]
    buffer_load_dwordx4 v[216:219], v4, s[8:11], s73 offen
    s_mov_b64 exec, -1
    s_add_u32 s73, s73, s49
    v_lshlrev_b32 v76, 16, v30
    v_and_b32 v77, 0xffff0000, v30
    v_lshlrev_b32 v78, 16, v31
    v_and_b32 v79, 0xffff0000, v31
    v_pk_add_f32 v[8:9], v[8:9], v[76:77]
    v_pk_add_f32 v[72:73], v[72:73], v[78:79]
    v_pk_fma_f32 v[12:13], v[76:77], v[76:77], v[12:13]
    v_pk_fma_f32 v[74:75], v[78:79], v[78:79], v[74:75]
    s_mov_b64 exec, s[66:67]
    buffer_load_dwordx4 v[220:223], v4, s[8:11], s73 offen
    s_mov_b64 exec, -1
    s_add_u32 s73, s73, s49
    v_lshlrev_b32 v76, 16, v32
    v_and_b32 v77, 0xffff0000, v32
    v_lshlrev_b32 v78, 16, v33
    v_and_b32 v79, 0xffff0000, v33
    v_pk_add_f32 v[8:9], v[8:9], v[76:77]
    v_pk_add_f32 v[72:73], v[72:73], v[78:79]
    v_pk_fma_f32 v[12:13], v[76:77], v[76:77], v[12:13]
    v_pk_fma_f32 v[74:75], v[78:79], v[78:79], v[74:75]
    s_mov_b64 exec, s[66:67]
    buffer_load_dwordx4 v[224:227], v4, s[8:11], s73 offen
    s_mov_b64 exec, -1
    s_add_u32 s73, s73, s49
    v_lshlrev_b32 v76, 16, v34
    v_and_b32 v77, 0xffff0000, v34
    v_lshlrev_b32 v78, 16, v35
    v_and_b32 v79, 0xffff0000, v35
    v_pk_add_f32 v[8:9], v[8:9], v[76:77]
    v_pk_add_f32 v[72:73], v[72:73], v[78:79]
    v_pk_fma_f32 v[12:13], v[76:77], v[76:77], v[12:13]
    v_pk_fma_f32 v[74:75], v[78:79], v[78:79], v[74:75]
    s_mov_b64 exec, s[66:67]
    buffer_load_dwordx4 v[228:231], v4, s[8:11], s73 offen
    s_mov_b64 exec, -1
    s_add_u32 s73, s73, s49
    v_lshlrev_b32 v76, 16, v36
    v_and_b32 v77, 0xffff0000, v36
    v_lshlrev_b32 v78, 16, v37
    v_and_b32 v79, 0xffff0000, v37
    v_pk_add_f32 v[8:9], v[8:9], v[76:77]
    v_pk_add_f32 v[72:73], v[72:73], v[78:79]
    v_pk_fma_f32 v[12:13], v[76:77], v[76:77], v[12:13]
    v_pk_fma_f32 v[74:75], v[78:79], v[78:79], v[74:75]
    s_mov_b64 exec, s[66:67]
    buffer_load_dwordx4 v[232:235], v4, s[8:11], s73 offen
    s_mov_b64 exec, -1
    s_add_u32 s73, s73, s49
    v_lshlrev_b32 v76, 16, v38
    v_and_b32 v77, 0xffff0000, v38
    v_lshlrev_b32 v78, 16, v39
    v_and_b32 v79, 0xffff0000, v39
    v_pk_add_f32 v[8:9], v[8:9], v[76:77]
    v_pk_add_f32 v[72:73], v[72:73], v[78:79]
    v_pk_fma_f32 v[12:13], v[76:77], v[76:77], v[12:13]
    v_pk_fma_f32 v[74:75], v[78:79], v[78:79], v[74:75]
    s_mov_b64 exec, s[66:67]
    buffer_load_dwordx4 v[236:239], v4, s[8:11], s73 offen
    s_mov_b64 exec, -1
    s_add_u32 s73, s73, s49
    v_lshlrev_b32 v76, 16, v40
    v_and_b32 v77, 0xffff0000, v40
    v_lshlrev_b32 v78, 16, v41
    v_and_b32 v79, 0xffff0000, v41
    v_pk_add_f32 v[8:9], v[8:9], v[76:77]
    v_pk_add_f32 v[72:73], v[72:73], v[78:79]
    v_pk_fma_f32 v[12:13], v[76:77], v[76:77], v[12:13]
    v_pk_fma_f32 v[74:75], v[78:79], v[78:79], v[74:75]
    s_mov_b64 exec, s[66:67]
    buffer_load_dwordx4 v[240:243], v4, s[8:11], s73 offen
    s_mov_b64 exec, -1
    s_add_u32 s73, s73, s49
    v_lshlrev_b32 v76, 16, v42
    v_and_b32 v77, 0xffff0000, v42
    v_lshlrev_b32 v78, 16, v43
    v_and_b32 v79, 0xffff0000, v43
    v_pk_add_f32 v[8:9], v[8:9], v[76:77]
    v_pk_add_f32 v[72:73], v[72:73], v[78:79]
    v_pk_fma_f32 v[12:13], v[76:77], v[76:77], v[12:13]
    v_pk_fma_f32 v[74:75], v[78:79], v[78:79], v[74:75]
    s_mov_b64 exec, s[66:67]
    buffer_load_dwordx4 v[244:247], v4, s[8:11], s73 offen
    s_mov_b64 exec, -1
    s_add_u32 s73, s73, s49
    v_pk_add_f32 v[8:9], v[8:9], v[72:73]
    v_pk_add_f32 v[12:13], v[12:13], v[74:75]
    v_add_f32 v8, v8, v9
    v_add_f32 v9, v12, v13
    s_nop 0
    v_add_f32_dpp v8, v8, v8 quad_perm:[1,0,3,2] row_mask:0xf bank_mask:0xf
    v_add_f32_dpp v9, v9, v9 quad_perm:[1,0,3,2] row_mask:0xf bank_mask:0xf
    s_nop 0
    v_add_f32_dpp v8, v8, v8 quad_perm:[2,3,0,1] row_mask:0xf bank_mask:0xf
    v_add_f32_dpp v9, v9, v9 quad_perm:[2,3,0,1] row_mask:0xf bank_mask:0xf
    s_nop 0
    v_add_f32_dpp v8, v8, v8 row_half_mirror row_mask:0xf bank_mask:0xf
    v_add_f32_dpp v9, v9, v9 row_half_mirror row_mask:0xf bank_mask:0xf
    v_mul_f32 v8, 0x3b124925, v8
    v_mul_f32 v9, 0x3b124925, v9
    v_fma_f32 v9, -v8, v8, v9
    v_max_f32 v9, 0, v9
    v_cvt_pk_bf16_f32 v10, v8, v9
    v_lshlrev_b32 v8, 16, v10
    v_and_b32 v9, 0xffff0000, v10
    v_add_f32 v9, 0x3727c5ac, v9
    v_cvt_pk_bf16_f32 v9, v9, v9
    v_lshlrev_b32 v9, 16, v9
    v_sqrt_f32 v9, v9
    s_nop 0
    v_cvt_pk_bf16_f32 v9, v9, v9
    v_lshlrev_b32 v9, 16, v9
    v_rcp_f32 v9, v9
    v_sub_f32 v72, 0, v8
    v_mov_b32 v73, v72
    v_mov_b32 v74, v9
    v_mov_b32 v75, v9
    v_lshlrev_b32 v76, 16, v16
    v_and_b32 v77, 0xffff0000, v16
    v_lshlrev_b32 v78, 16, v17
    v_and_b32 v79, 0xffff0000, v17
    v_lshlrev_b32 v80, 16, v18
    v_and_b32 v81, 0xffff0000, v18
    v_lshlrev_b32 v82, 16, v19
    v_and_b32 v83, 0xffff0000, v19
    v_pk_add_f32 v[76:77], v[76:77], v[72:73]
    v_pk_add_f32 v[78:79], v[78:79], v[72:73]
    v_pk_add_f32 v[80:81], v[80:81], v[72:73]
    v_pk_add_f32 v[82:83], v[82:83], v[72:73]
    v_cvt_pk_bf16_f32 v16, v76, v77
    v_cvt_pk_bf16_f32 v17, v78, v79
    v_cvt_pk_bf16_f32 v18, v80, v81
    v_cvt_pk_bf16_f32 v19, v82, v83
    v_lshlrev_b32 v76, 16, v16
    v_and_b32 v77, 0xffff0000, v16
    v_lshlrev_b32 v78, 16, v17
    v_and_b32 v79, 0xffff0000, v17
    v_lshlrev_b32 v80, 16, v18
    v_and_b32 v81, 0xffff0000, v18
    v_lshlrev_b32 v82, 16, v19
    v_and_b32 v83, 0xffff0000, v19
    v_pk_mul_f32 v[76:77], v[76:77], v[74:75]
    v_pk_mul_f32 v[78:79], v[78:79], v[74:75]
    v_pk_mul_f32 v[80:81], v[80:81], v[74:75]
    v_pk_mul_f32 v[82:83], v[82:83], v[74:75]
    v_cvt_pk_bf16_f32 v16, v76, v77
    v_cvt_pk_bf16_f32 v17, v78, v79
    v_cvt_pk_bf16_f32 v18, v80, v81
    v_cvt_pk_bf16_f32 v19, v82, v83
    s_add_u32 m0, s55, 92160
    s_mov_b64 exec, s[66:67]
    buffer_load_dwordx4 v4, s[8:11], s50 offen lds
    s_mov_b64 exec, -1
    s_add_u32 s50, s50, s49
    s_add_u32 m0, s55, 93216
    s_mov_b64 exec, s[66:67]
    buffer_load_dwordx4 v4, s[8:11], s50 offen lds
    s_mov_b64 exec, -1
    s_add_u32 s50, s50, s49
    v_lshlrev_b32 v76, 16, v20
    v_and_b32 v77, 0xffff0000, v20
    v_lshlrev_b32 v78, 16, v21
    v_and_b32 v79, 0xffff0000, v21
    v_lshlrev_b32 v80, 16, v22
    v_and_b32 v81, 0xffff0000, v22
    v_lshlrev_b32 v82, 16, v23
    v_and_b32 v83, 0xffff0000, v23
    v_pk_add_f32 v[76:77], v[76:77], v[72:73]
    v_pk_add_f32 v[78:79], v[78:79], v[72:73]
    v_pk_add_f32 v[80:81], v[80:81], v[72:73]
    v_pk_add_f32 v[82:83], v[82:83], v[72:73]
    v_cvt_pk_bf16_f32 v20, v76, v77
    v_cvt_pk_bf16_f32 v21, v78, v79
    v_cvt_pk_bf16_f32 v22, v80, v81
    v_cvt_pk_bf16_f32 v23, v82, v83
    v_lshlrev_b32 v76, 16, v20
    v_and_b32 v77, 0xffff0000, v20
    v_lshlrev_b32 v78, 16, v21
    v_and_b32 v79, 0xffff0000, v21
    v_lshlrev_b32 v80, 16, v22
    v_and_b32 v81, 0xffff0000, v22
    v_lshlrev_b32 v82, 16, v23
    v_and_b32 v83, 0xffff0000, v23
    v_pk_mul_f32 v[76:77], v[76:77], v[74:75]
    v_pk_mul_f32 v[78:79], v[78:79], v[74:75]
    v_pk_mul_f32 v[80:81], v[80:81], v[74:75]
    v_pk_mul_f32 v[82:83], v[82:83], v[74:75]
    v_cvt_pk_bf16_f32 v20, v76, v77
    v_cvt_pk_bf16_f32 v21, v78, v79
    v_cvt_pk_bf16_f32 v22, v80, v81
    v_cvt_pk_bf16_f32 v23, v82, v83
    s_add_u32 m0, s55, 94272
    s_mov_b64 exec, s[66:67]
    buffer_load_dwordx4 v4, s[8:11], s50 offen lds
    s_mov_b64 exec, -1
    s_add_u32 s50, s50, s49
    s_add_u32 m0, s55, 95328
    s_mov_b64 exec, s[66:67]
    buffer_load_dwordx4 v4, s[8:11], s50 offen lds
    s_mov_b64 exec, -1
    s_add_u32 s50, s50, s49
    s_add_u32 s50, s50, s56
    v_lshlrev_b32 v76, 16, v24
    v_and_b32 v77, 0xffff0000, v24
    v_lshlrev_b32 v78, 16, v25
    v_and_b32 v79, 0xffff0000, v25
    v_lshlrev_b32 v80, 16, v26
    v_and_b32 v81, 0xffff0000, v26
    v_lshlrev_b32 v82, 16, v27
    v_and_b32 v83, 0xffff0000, v27
    v_pk_add_f32 v[76:77], v[76:77], v[72:73]
    v_pk_add_f32 v[78:79], v[78:79], v[72:73]
    v_pk_add_f32 v[80:81], v[80:81], v[72:73]
    v_pk_add_f32 v[82:83], v[82:83], v[72:73]
    v_cvt_pk_bf16_f32 v24, v76, v77
    v_cvt_pk_bf16_f32 v25, v78, v79
    v_cvt_pk_bf16_f32 v26, v80, v81
    v_cvt_pk_bf16_f32 v27, v82, v83
    v_lshlrev_b32 v76, 16, v24
    v_and_b32 v77, 0xffff0000, v24
    v_lshlrev_b32 v78, 16, v25
    v_and_b32 v79, 0xffff0000, v25
    v_lshlrev_b32 v80, 16, v26
    v_and_b32 v81, 0xffff0000, v26
    v_lshlrev_b32 v82, 16, v27
    v_and_b32 v83, 0xffff0000, v27
    v_pk_mul_f32 v[76:77], v[76:77], v[74:75]
    v_pk_mul_f32 v[78:79], v[78:79], v[74:75]
    v_pk_mul_f32 v[80:81], v[80:81], v[74:75]
    v_pk_mul_f32 v[82:83], v[82:83], v[74:75]
    v_cvt_pk_bf16_f32 v24, v76, v77
    v_cvt_pk_bf16_f32 v25, v78, v79
    v_cvt_pk_bf16_f32 v26, v80, v81
    v_cvt_pk_bf16_f32 v27, v82, v83
    s_add_u32 m0, s55, 125952
    s_mov_b64 exec, s[66:67]
    buffer_load_dwordx4 v4, s[8:11], s50 offen lds
    s_mov_b64 exec, -1
    s_add_u32 s50, s50, s49
    s_add_u32 m0, s55, 127008
    s_mov_b64 exec, s[66:67]
    buffer_load_dwordx4 v4, s[8:11], s50 offen lds
    s_mov_b64 exec, -1
    s_add_u32 s50, s50, s49
    v_lshlrev_b32 v76, 16, v28
    v_and_b32 v77, 0xffff0000, v28
    v_lshlrev_b32 v78, 16, v29
    v_and_b32 v79, 0xffff0000, v29
    v_lshlrev_b32 v80, 16, v30
    v_and_b32 v81, 0xffff0000, v30
    v_lshlrev_b32 v82, 16, v31
    v_and_b32 v83, 0xffff0000, v31
    v_pk_add_f32 v[76:77], v[76:77], v[72:73]
    v_pk_add_f32 v[78:79], v[78:79], v[72:73]
    v_pk_add_f32 v[80:81], v[80:81], v[72:73]
    v_pk_add_f32 v[82:83], v[82:83], v[72:73]
    v_cvt_pk_bf16_f32 v28, v76, v77
    v_cvt_pk_bf16_f32 v29, v78, v79
    v_cvt_pk_bf16_f32 v30, v80, v81
    v_cvt_pk_bf16_f32 v31, v82, v83
    v_lshlrev_b32 v76, 16, v28
    v_and_b32 v77, 0xffff0000, v28
    v_lshlrev_b32 v78, 16, v29
    v_and_b32 v79, 0xffff0000, v29
    v_lshlrev_b32 v80, 16, v30
    v_and_b32 v81, 0xffff0000, v30
    v_lshlrev_b32 v82, 16, v31
    v_and_b32 v83, 0xffff0000, v31
    v_pk_mul_f32 v[76:77], v[76:77], v[74:75]
    v_pk_mul_f32 v[78:79], v[78:79], v[74:75]
    v_pk_mul_f32 v[80:81], v[80:81], v[74:75]
    v_pk_mul_f32 v[82:83], v[82:83], v[74:75]
    v_cvt_pk_bf16_f32 v28, v76, v77
    v_cvt_pk_bf16_f32 v29, v78, v79
    v_cvt_pk_bf16_f32 v30, v80, v81
    v_cvt_pk_bf16_f32 v31, v82, v83
    s_add_u32 m0, s55, 128064
    s_mov_b64 exec, s[66:67]
    buffer_load_dwordx4 v4, s[8:11], s50 offen lds
    s_mov_b64 exec, -1
    s_add_u32 s50, s50, s49
    s_add_u32 m0, s55, 129120
    s_mov_b64 exec, s[66:67]
    buffer_load_dwordx4 v4, s[8:11], s50 offen lds
    s_mov_b64 exec, -1
    s_add_u32 s50, s50, s49
    s_add_u32 s50, s50, s56
    v_lshlrev_b32 v76, 16, v32
    v_and_b32 v77, 0xffff0000, v32
    v_lshlrev_b32 v78, 16, v33
    v_and_b32 v79, 0xffff0000, v33
    v_lshlrev_b32 v80, 16, v34
    v_and_b32 v81, 0xffff0000, v34
    v_lshlrev_b32 v82, 16, v35
    v_and_b32 v83, 0xffff0000, v35
    v_pk_add_f32 v[76:77], v[76:77], v[72:73]
    v_pk_add_f32 v[78:79], v[78:79], v[72:73]
    v_pk_add_f32 v[80:81], v[80:81], v[72:73]
    v_pk_add_f32 v[82:83], v[82:83], v[72:73]
    v_cvt_pk_bf16_f32 v32, v76, v77
    v_cvt_pk_bf16_f32 v33, v78, v79
    v_cvt_pk_bf16_f32 v34, v80, v81
    v_cvt_pk_bf16_f32 v35, v82, v83
    v_lshlrev_b32 v76, 16, v32
    v_and_b32 v77, 0xffff0000, v32
    v_lshlrev_b32 v78, 16, v33
    v_and_b32 v79, 0xffff0000, v33
    v_lshlrev_b32 v80, 16, v34
    v_and_b32 v81, 0xffff0000, v34
    v_lshlrev_b32 v82, 16, v35
    v_and_b32 v83, 0xffff0000, v35
    v_pk_mul_f32 v[76:77], v[76:77], v[74:75]
    v_pk_mul_f32 v[78:79], v[78:79], v[74:75]
    v_pk_mul_f32 v[80:81], v[80:81], v[74:75]
    v_pk_mul_f32 v[82:83], v[82:83], v[74:75]
    v_cvt_pk_bf16_f32 v32, v76, v77
    v_cvt_pk_bf16_f32 v33, v78, v79
    v_cvt_pk_bf16_f32 v34, v80, v81
    v_cvt_pk_bf16_f32 v35, v82, v83
    v_lshlrev_b32 v76, 16, v36
    v_and_b32 v77, 0xffff0000, v36
    v_lshlrev_b32 v78, 16, v37
    v_and_b32 v79, 0xffff0000, v37
    v_lshlrev_b32 v80, 16, v38
    v_and_b32 v81, 0xffff0000, v38
    v_lshlrev_b32 v82, 16, v39
    v_and_b32 v83, 0xffff0000, v39
    v_pk_add_f32 v[76:77], v[76:77], v[72:73]
    v_pk_add_f32 v[78:79], v[78:79], v[72:73]
    v_pk_add_f32 v[80:81], v[80:81], v[72:73]
    v_pk_add_f32 v[82:83], v[82:83], v[72:73]
    v_cvt_pk_bf16_f32 v36, v76, v77
    v_cvt_pk_bf16_f32 v37, v78, v79
    v_cvt_pk_bf16_f32 v38, v80, v81
    v_cvt_pk_bf16_f32 v39, v82, v83
    v_lshlrev_b32 v76, 16, v36
    v_and_b32 v77, 0xffff0000, v36
    v_lshlrev_b32 v78, 16, v37
    v_and_b32 v79, 0xffff0000, v37
    v_lshlrev_b32 v80, 16, v38
    v_and_b32 v81, 0xffff0000, v38
    v_lshlrev_b32 v82, 16, v39
    v_and_b32 v83, 0xffff0000, v39
    v_pk_mul_f32 v[76:77], v[76:77], v[74:75]
    v_pk_mul_f32 v[78:79], v[78:79], v[74:75]
    v_pk_mul_f32 v[80:81], v[80:81], v[74:75]
    v_pk_mul_f32 v[82:83], v[82:83], v[74:75]
    v_cvt_pk_bf16_f32 v36, v76, v77
    v_cvt_pk_bf16_f32 v37, v78, v79
    v_cvt_pk_bf16_f32 v38, v80, v81
    v_cvt_pk_bf16_f32 v39, v82, v83
    v_lshlrev_b32 v76, 16, v40
    v_and_b32 v77, 0xffff0000, v40
    v_lshlrev_b32 v78, 16, v41
    v_and_b32 v79, 0xffff0000, v41
    v_lshlrev_b32 v80, 16, v42
    v_and_b32 v81, 0xffff0000, v42
    v_lshlrev_b32 v82, 16, v43
    v_and_b32 v83, 0xffff0000, v43
    v_pk_add_f32 v[76:77], v[76:77], v[72:73]
    v_pk_add_f32 v[78:79], v[78:79], v[72:73]
    v_pk_add_f32 v[80:81], v[80:81], v[72:73]
    v_pk_add_f32 v[82:83], v[82:83], v[72:73]
    v_cvt_pk_bf16_f32 v40, v76, v77
    v_cvt_pk_bf16_f32 v41, v78, v79
    v_cvt_pk_bf16_f32 v42, v80, v81
    v_cvt_pk_bf16_f32 v43, v82, v83
    v_lshlrev_b32 v76, 16, v40
    v_and_b32 v77, 0xffff0000, v40
    v_lshlrev_b32 v78, 16, v41
    v_and_b32 v79, 0xffff0000, v41
    v_lshlrev_b32 v80, 16, v42
    v_and_b32 v81, 0xffff0000, v42
    v_lshlrev_b32 v82, 16, v43
    v_and_b32 v83, 0xffff0000, v43
    v_pk_mul_f32 v[76:77], v[76:77], v[74:75]
    v_pk_mul_f32 v[78:79], v[78:79], v[74:75]
    v_pk_mul_f32 v[80:81], v[80:81], v[74:75]
    v_pk_mul_f32 v[82:83], v[82:83], v[74:75]
    v_cvt_pk_bf16_f32 v40, v76, v77
    v_cvt_pk_bf16_f32 v41, v78, v79
    v_cvt_pk_bf16_f32 v42, v80, v81
    v_cvt_pk_bf16_f32 v43, v82, v83
    ds_write_b128 v14, v[16:19] offset:0
    ds_write_b128 v14, v[20:23] offset:16
    ds_write_b128 v14, v[24:27] offset:32
    ds_write_b128 v14, v[28:31] offset:48
    ds_write_b128 v14, v[32:35] offset:64
    ds_write_b128 v14, v[36:39] offset:80
    ds_write_b128 v14, v[40:43] offset:96
    s_mov_b32 s70, 0xbdd2d3e8
    v_mov_b32 v15, 0xc0135761
    s_mov_b32 s71, 0x3fb8aa3b
    s_mov_b32 s72, 0xbfb8aa3b
    v_mov_b32 v12, 0xff800000
    v_mov_b32 v13, 0x7f800000
    v_cmp_eq_u32 s[62:63], 3, v2
    v_cmp_le_u32 s[60:61], 12, v3
    v_cmp_eq_u32 vcc, 12, v3
    v_mov_b32 v8, 0x3f803f80
    s_nop 0
    v_cndmask_b32 v14, 0, v8, vcc
    s_waitcnt lgkmcnt(0)
    v_mov_b32 v64, 0
    v_mov_b32 v65, 0
    v_mov_b32 v66, 0
    v_mov_b32 v67, 0
    v_mov_b32 v68, 0
    v_mov_b32 v69, 0
    v_mov_b32 v70, 0
    v_mov_b32 v71, 0
    v_mov_b32 v72, 0
    v_mov_b32 v73, 0
    v_mov_b32 v74, 0
    v_mov_b32 v75, 0
    v_mov_b32 v76, 0
    v_mov_b32 v77, 0
    v_mov_b32 v78, 0
    v_mov_b32 v79, 0
    v_mov_b32 v80, 0
    v_mov_b32 v81, 0
    v_mov_b32 v82, 0
    v_mov_b32 v83, 0
    v_mov_b32 v84, 0
    v_mov_b32 v85, 0
    v_mov_b32 v86, 0
    v_mov_b32 v87, 0
    v_mov_b32 v88, 0
    v_mov_b32 v89, 0
    v_mov_b32 v90, 0
    v_mov_b32 v91, 0
    v_mov_b32 v92, 0
    v_mov_b32 v93, 0
    v_mov_b32 v94, 0
    v_mov_b32 v95, 0
    v_mov_b32 v96, 0
    v_mov_b32 v97, 0
    v_mov_b32 v98, 0
    v_mov_b32 v99, 0
    v_mov_b32 v100, 0
    v_mov_b32 v101, 0
    v_mov_b32 v102, 0
    v_mov_b32 v103, 0
    v_mov_b32 v104, 0
    v_mov_b32 v105, 0
    v_mov_b32 v106, 0
    v_mov_b32 v107, 0
    v_mov_b32 v108, 0
    v_mov_b32 v109, 0
    v_mov_b32 v110, 0
    v_mov_b32 v111, 0
    v_mov_b32 v112, 0
    v_mov_b32 v113, 0
    v_mov_b32 v114, 0
    v_mov_b32 v115, 0
    v_mov_b32 v116, 0
    v_mov_b32 v117, 0
    v_mov_b32 v118, 0
    v_mov_b32 v119, 0
    v_mov_b32 v120, 0
    v_mov_b32 v121, 0
    v_mov_b32 v122, 0
    v_mov_b32 v123, 0
    v_mov_b32 v124, 0
    v_mov_b32 v125, 0
    v_mov_b32 v126, 0
    v_mov_b32 v127, 0
    s_lshl_b32 s82, s46, 6
    s_lshl_b32 s54, s80, 5
    s_add_u32 s82, s82, s54
    s_cmp_eq_u32 s68, 0
    s_cbranch_scc1 K1_Q
    s_cmp_eq_u32 s68, 1
    s_cbranch_scc1 K1_KV
    s_cmp_eq_u32 s68, 2
    s_cbranch_scc1 K1_Z1
    s_branch K1_Z2
K1_Q:
    s_lshl_b32 s57, s69, 3
    s_lshl_b32 s58, s48, 1
    s_add_u32 s57, s57, s58
    s_mul_i32 s58, s57, 1568
    v_lshlrev_b32 v8, 4, v1
    v_lshrrev_b32 v9, 2, v3
    v_lshl_add_u32 v9, v2, 2, v9
    v_mul_u32_u24 v9, 56, v9
    v_and_b32 v10, 3, v3
    v_lshl_add_u32 v9, v10, 3, v9
    s_lshl_b32 s57, s81, 12
    s_add_u32 s57, s57, 125952
    v_add_u32 v9, s57, v9
    s_waitcnt vmcnt(8)
    s_barrier
    v_add_u32 v7, s52, v6
    ds_read_b128 v[16:19], v5 offset:0
    ds_read_b128 v[20:23], v5 offset:14592
    ds_read_b64_tr_b16 v[32:33], v7 offset:0
    ds_read_b64_tr_b16 v[34:35], v7 offset:4224
    ds_read_b64_tr_b16 v[36:37], v7 offset:32
    ds_read_b64_tr_b16 v[38:39], v7 offset:4256
    ds_read_b64_tr_b16 v[40:41], v7 offset:56
    ds_read_b64_tr_b16 v[42:43], v7 offset:4280
    ds_read_b64_tr_b16 v[44:45], v7 offset:88
    ds_read_b64_tr_b16 v[46:47], v7 offset:4312
    v_add_u32 v5, 64, v5
    s_add_u32 s52, s52, 33792
    s_cmp_eq_u32 s52, 159744
    s_cselect_b32 s52, 58368, s52
    s_mov_b32 s53, 5
K1_LOOP_Q:
    s_waitcnt vmcnt(4) lgkmcnt(0)
    s_barrier
    v_add_u32 v7, s52, v6
    ds_read_b128 v[192:195], v5 offset:0
    ds_read_b128 v[196:199], v5 offset:14592
    ds_read_b64_tr_b16 v[208:209], v7 offset:0
    ds_read_b64_tr_b16 v[210:211], v7 offset:4224
    ds_read_b64_tr_b16 v[212:213], v7 offset:32
    ds_read_b64_tr_b16 v[214:215], v7 offset:4256
    ds_read_b64_tr_b16 v[216:217], v7 offset:56
    ds_read_b64_tr_b16 v[218:219], v7 offset:4280
    ds_read_b64_tr_b16 v[220:221], v7 offset:88
    ds_read_b64_tr_b16 v[222:223], v7 offset:4312
    v_add_u32 v5, 64, v5
    s_add_u32 s52, s52, 33792
    s_cmp_eq_u32 s52, 159744
    s_cselect_b32 s52, 58368, s52
    v_mfma_f32_16x16x32_bf16 v[64:67], v[32:35], v[16:19], v[64:67]
    v_mfma_f32_16x16x32_bf16 v[68:71], v[32:35], v[20:23], v[68:71]
    s_add_u32 s54, s51, s55
    v_mfma_f32_16x16x32_bf16 v[72:75], v[36:39], v[16:19], v[72:75]
    v_mfma_f32_16x16x32_bf16 v[76:79], v[36:39], v[20:23], v[76:79]
    s_add_u32 m0, s54, 0
    s_mov_b64 exec, s[66:67]
    buffer_load_dwordx4 v4, s[8:11], s50 offen lds
    s_mov_b64 exec, -1
    s_add_u32 s50, s50, s49
    v_mfma_f32_16x16x32_bf16 v[80:83], v[40:43], v[16:19], v[80:83]
    v_mfma_f32_16x16x32_bf16 v[84:87], v[40:43], v[20:23], v[84:87]
    s_add_u32 m0, s54, 1056
    s_mov_b64 exec, s[66:67]
    buffer_load_dwordx4 v4, s[8:11], s50 offen lds
    s_mov_b64 exec, -1
    s_add_u32 s50, s50, s49
    v_mfma_f32_16x16x32_bf16 v[88:91], v[44:47], v[16:19], v[88:91]
    v_mfma_f32_16x16x32_bf16 v[92:95], v[44:47], v[20:23], v[92:95]
    s_add_u32 m0, s54, 2112
    s_mov_b64 exec, s[66:67]
    buffer_load_dwordx4 v4, s[8:11], s50 offen lds
    s_mov_b64 exec, -1
    s_add_u32 s50, s50, s49
    s_add_u32 m0, s54, 3168
    s_mov_b64 exec, s[66:67]
    buffer_load_dwordx4 v4, s[8:11], s50 offen lds
    s_mov_b64 exec, -1
    s_add_u32 s50, s50, s49
    s_add_u32 s50, s50, s56
    s_add_u32 s51, s51, 33792
    s_cmp_eq_u32 s51, 159744
    s_cselect_b32 s51, 58368, s51
    s_waitcnt vmcnt(4) lgkmcnt(0)
    s_barrier
    v_add_u32 v7, s52, v6
    ds_read_b128 v[16:19], v5 offset:0
    ds_read_b128 v[20:23], v5 offset:14592
    ds_read_b64_tr_b16 v[32:33], v7 offset:0
    ds_read_b64_tr_b16 v[34:35], v7 offset:4224
    ds_read_b64_tr_b16 v[36:37], v7 offset:32
    ds_read_b64_tr_b16 v[38:39], v7 offset:4256
    ds_read_b64_tr_b16 v[40:41], v7 offset:56
    ds_read_b64_tr_b16 v[42:43], v7 offset:4280
    ds_read_b64_tr_b16 v[44:45], v7 offset:88
    ds_read_b64_tr_b16 v[46:47], v7 offset:4312
    v_add_u32 v5, 64, v5
    s_add_u32 s52, s52, 33792
    s_cmp_eq_u32 s52, 159744
    s_cselect_b32 s52, 58368, s52
    v_mfma_f32_16x16x32_bf16 v[64:67], v[208:211], v[192:195], v[64:67]
    v_mfma_f32_16x16x32_bf16 v[68:71], v[208:211], v[196:199], v[68:71]
    s_add_u32 s54, s51, s55
    v_mfma_f32_16x16x32_bf16 v[72:75], v[212:215], v[192:195], v[72:75]
    v_mfma_f32_16x16x32_bf16 v[76:79], v[212:215], v[196:199], v[76:79]
    s_add_u32 m0, s54, 0
    s_mov_b64 exec, s[66:67]
    buffer_load_dwordx4 v4, s[8:11], s50 offen lds
    s_mov_b64 exec, -1
    s_add_u32 s50, s50, s49
    v_mfma_f32_16x16x32_bf16 v[80:83], v[216:219], v[192:195], v[80:83]
    v_mfma_f32_16x16x32_bf16 v[84:87], v[216:219], v[196:199], v[84:87]
    s_add_u32 m0, s54, 1056
    s_mov_b64 exec, s[66:67]
    buffer_load_dwordx4 v4, s[8:11], s50 offen lds
    s_mov_b64 exec, -1
    s_add_u32 s50, s50, s49
    v_mfma_f32_16x16x32_bf16 v[88:91], v[220:223], v[192:195], v[88:91]
    v_mfma_f32_16x16x32_bf16 v[92:95], v[220:223], v[196:199], v[92:95]
    s_add_u32 m0, s54, 2112
    s_mov_b64 exec, s[66:67]
    buffer_load_dwordx4 v4, s[8:11], s50 offen lds
    s_mov_b64 exec, -1
    s_add_u32 s50, s50, s49
    s_add_u32 m0, s54, 3168
    s_mov_b64 exec, s[66:67]
    buffer_load_dwordx4 v4, s[8:11], s50 offen lds
    s_mov_b64 exec, -1
    s_add_u32 s50, s50, s49
    s_add_u32 s50, s50, s56
    s_add_u32 s51, s51, 33792
    s_cmp_eq_u32 s51, 159744
    s_cselect_b32 s51, 58368, s51
    s_sub_u32 s53, s53, 1
    s_cmp_lg_u32 s53, 0
    s_cbranch_scc1 K1_LOOP_Q
    s_waitcnt vmcnt(4) lgkmcnt(0)
    s_barrier
    v_add_u32 v7, s52, v6
    ds_read_b128 v[192:195], v5 offset:0
    ds_read_b128 v[196:199], v5 offset:14592
    ds_read_b64_tr_b16 v[208:209], v7 offset:0
    ds_read_b64_tr_b16 v[210:211], v7 offset:4224
    ds_read_b64_tr_b16 v[212:213], v7 offset:32
    ds_read_b64_tr_b16 v[214:215], v7 offset:4256
    ds_read_b64_tr_b16 v[216:217], v7 offset:56
    ds_read_b64_tr_b16 v[218:219], v7 offset:4280
    ds_read_b64_tr_b16 v[220:221], v7 offset:88
    ds_read_b64_tr_b16 v[222:223], v7 offset:4312
    v_add_u32 v5, 64, v5
    s_add_u32 s52, s52, 33792
    s_cmp_eq_u32 s52, 159744
    s_cselect_b32 s52, 58368, s52
    v_mfma_f32_16x16x32_bf16 v[64:67], v[32:35], v[16:19], v[64:67]
    v_mfma_f32_16x16x32_bf16 v[68:71], v[32:35], v[20:23], v[68:71]
    s_add_u32 s54, s51, s55
    v_mfma_f32_16x16x32_bf16 v[72:75], v[36:39], v[16:19], v[72:75]
    v_mfma_f32_16x16x32_bf16 v[76:79], v[36:39], v[20:23], v[76:79]
    s_add_u32 m0, s54, 0
    s_mov_b64 exec, s[66:67]
    buffer_load_dwordx4 v4, s[8:11], s50 offen lds
    s_mov_b64 exec, -1
    s_add_u32 s50, s50, s49
    v_mfma_f32_16x16x32_bf16 v[80:83], v[40:43], v[16:19], v[80:83]
    v_mfma_f32_16x16x32_bf16 v[84:87], v[40:43], v[20:23], v[84:87]
    s_add_u32 m0, s54, 1056
    s_mov_b64 exec, s[66:67]
    buffer_load_dwordx4 v4, s[8:11], s50 offen lds
    s_mov_b64 exec, -1
    s_add_u32 s50, s50, s49
    v_mfma_f32_16x16x32_bf16 v[88:91], v[44:47], v[16:19], v[88:91]
    v_mfma_f32_16x16x32_bf16 v[92:95], v[44:47], v[20:23], v[92:95]
    s_add_u32 m0, s54, 2112
    s_mov_b64 exec, s[66:67]
    buffer_load_dwordx4 v4, s[8:11], s50 offen lds
    s_mov_b64 exec, -1
    s_add_u32 s50, s50, s49
    s_add_u32 m0, s54, 3168
    s_mov_b64 exec, s[66:67]
    buffer_load_dwordx4 v4, s[8:11], s50 offen lds
    s_mov_b64 exec, -1
    s_add_u32 s50, s50, s49
    s_add_u32 s50, s50, s56
    s_add_u32 s51, s51, 33792
    s_cmp_eq_u32 s51, 159744
    s_cselect_b32 s51, 58368, s51
    s_waitcnt vmcnt(4) lgkmcnt(0)
    s_barrier
    v_add_u32 v7, s52, v6
    ds_read_b128 v[16:19], v5 offset:0
    ds_read_b128 v[20:23], v5 offset:14592
    ds_read_b64_tr_b16 v[32:33], v7 offset:0
    ds_read_b64_tr_b16 v[34:35], v7 offset:4224
    ds_read_b64_tr_b16 v[36:37], v7 offset:32
    ds_read_b64_tr_b16 v[38:39], v7 offset:4256
    ds_read_b64_tr_b16 v[40:41], v7 offset:56
    ds_read_b64_tr_b16 v[42:43], v7 offset:4280
    ds_read_b64_tr_b16 v[44:45], v7 offset:88
    ds_read_b64_tr_b16 v[46:47], v7 offset:4312
    v_add_u32 v5, 64, v5
    s_add_u32 s52, s52, 33792
    s_cmp_eq_u32 s52, 159744
    s_cselect_b32 s52, 58368, s52
    v_mfma_f32_16x16x32_bf16 v[64:67], v[208:211], v[192:195], v[64:67]
    v_mfma_f32_16x16x32_bf16 v[68:71], v[208:211], v[196:199], v[68:71]
    v_mfma_f32_16x16x32_bf16 v[72:75], v[212:215], v[192:195], v[72:75]
    v_mfma_f32_16x16x32_bf16 v[76:79], v[212:215], v[196:199], v[76:79]
    v_mfma_f32_16x16x32_bf16 v[80:83], v[216:219], v[192:195], v[80:83]
    v_mfma_f32_16x16x32_bf16 v[84:87], v[216:219], v[196:199], v[84:87]
    v_mfma_f32_16x16x32_bf16 v[88:91], v[220:223], v[192:195], v[88:91]
    v_mfma_f32_16x16x32_bf16 v[92:95], v[220:223], v[196:199], v[92:95]
    s_waitcnt vmcnt(0) lgkmcnt(0)
    s_barrier
    v_add_u32 v7, s52, v6
    ds_read_b128 v[192:195], v5 offset:0
    ds_read_b128 v[196:199], v5 offset:14592
    ds_read_b64_tr_b16 v[208:209], v7 offset:0
    ds_read_b64_tr_b16 v[210:211], v7 offset:4224
    ds_read_b64_tr_b16 v[212:213], v7 offset:32
    ds_read_b64_tr_b16 v[214:215], v7 offset:4256
    ds_read_b64_tr_b16 v[216:217], v7 offset:56
    ds_read_b64_tr_b16 v[218:219], v7 offset:4280
    ds_read_b64_tr_b16 v[220:221], v7 offset:88
    ds_read_b64_tr_b16 v[222:223], v7 offset:4312
    v_add_u32 v5, 64, v5
    s_add_u32 s52, s52, 33792
    s_cmp_eq_u32 s52, 159744
    s_cselect_b32 s52, 58368, s52
    v_mfma_f32_16x16x32_bf16 v[64:67], v[32:35], v[16:19], v[64:67]
    v_mfma_f32_16x16x32_bf16 v[68:71], v[32:35], v[20:23], v[68:71]
    v_mfma_f32_16x16x32_bf16 v[72:75], v[36:39], v[16:19], v[72:75]
    v_mfma_f32_16x16x32_bf16 v[76:79], v[36:39], v[20:23], v[76:79]
    v_mfma_f32_16x16x32_bf16 v[80:83], v[40:43], v[16:19], v[80:83]
    v_mfma_f32_16x16x32_bf16 v[84:87], v[40:43], v[20:23], v[84:87]
    v_mfma_f32_16x16x32_bf16 v[88:91], v[44:47], v[16:19], v[88:91]
    v_mfma_f32_16x16x32_bf16 v[92:95], v[44:47], v[20:23], v[92:95]
    s_lshl_b32 s57, s81, 12
    s_add_u32 s57, s57, 125952
    s_add_u32 m0, s57, 0
    s_nop 0
    buffer_load_dwordx4 v8, s[20:23], s58 offen lds
    s_add_u32 s58, s58, 1024
    s_add_u32 m0, s57, 1024
    s_nop 0
    buffer_load_dwordx4 v8, s[20:23], s58 offen lds
    s_add_u32 s58, s58, 1024
    s_add_u32 m0, s57, 2048
    s_nop 0
    buffer_load_dwordx4 v8, s[20:23], s58 offen lds
    s_add_u32 s58, s58, 1024
    s_add_u32 m0, s57, 3072
    s_nop 0
    buffer_load_dwordx4 v8, s[20:23], s58 offen lds
    s_add_u32 s58, s58, 1024
    s_waitcnt lgkmcnt(0)
    v_mfma_f32_16x16x32_bf16 v[64:67], v[208:211], v[192:195], v[64:67]
    v_mfma_f32_16x16x32_bf16 v[68:71], v[208:211], v[196:199], v[68:71]
    v_mfma_f32_16x16x32_bf16 v[72:75], v[212:215], v[192:195], v[72:75]
    v_mfma_f32_16x16x32_bf16 v[76:79], v[212:215], v[196:199], v[76:79]
    v_mfma_f32_16x16x32_bf16 v[80:83], v[216:219], v[192:195], v[80:83]
    v_mfma_f32_16x16x32_bf16 v[84:87], v[216:219], v[196:199], v[84:87]
    v_mfma_f32_16x16x32_bf16 v[88:91], v[220:223], v[192:195], v[88:91]
    v_mfma_f32_16x16x32_bf16 v[92:95], v[220:223], v[196:199], v[92:95]
    s_waitcnt vmcnt(0)
    ds_read_b64_tr_b16 v[192:193], v9 offset:0
    ds_read_b64_tr_b16 v[194:195], v9 offset:896
    ds_read_b64_tr_b16 v[196:197], v9 offset:32
    ds_read_b64_tr_b16 v[198:199], v9 offset:928
    ds_read_b64_tr_b16 v[200:201], v9 offset:1568
    ds_read_b64_tr_b16 v[202:203], v9 offset:2464
    ds_read_b64_tr_b16 v[204:205], v9 offset:1600
    ds_read_b64_tr_b16 v[206:207], v9 offset:2496
    s_waitcnt lgkmcnt(0)
    v_cndmask_b32 v194, v194, 0, s[62:63]
    v_cndmask_b32 v195, v195, 0, s[62:63]
    v_cndmask_b32 v198, v198, 0, s[62:63]
    v_cndmask_b32 v199, v199, 0, s[62:63]
    v_cndmask_b32 v202, v202, 0, s[62:63]
    v_cndmask_b32 v203, v203, 0, s[62:63]
    v_cndmask_b32 v206, v206, 0, s[62:63]
    v_cndmask_b32 v207, v207, 0, s[62:63]
    s_nop 1
    s_barrier
    s_add_u32 s16, s42, 14680064
    s_addc_u32 s17, s43, 0
    s_mov_b32 s18, 4194304
    s_mov_b32 s19, 0x00020000
    v_add_u32 v8, s82, v3
    v_lshlrev_b32 v8, 11, v8
    v_lshl_add_u32 v8, v2, 4, v8
    s_lshl_b32 s54, s48, 8
    s_lshl_b32 s55, s69, 10
    s_add_u32 s54, s54, s55
    v_add_u32 v8, s54, v8
    v_cvt_pk_bf16_f32 v16, v64, v65
    v_cvt_pk_bf16_f32 v17, v66, v67
    v_cvt_pk_bf16_f32 v18, v72, v73
    v_cvt_pk_bf16_f32 v19, v74, v75
    s_nop 1
    v_mfma_f32_16x16x32_bf16 v[20:23], v[192:195], v[16:19], 0
    v_mfma_f32_16x16x32_bf16 v[24:27], v[196:199], v[16:19], 0
    s_nop 6
    v_cvt_pk_bf16_f32 v28, v20, v21
    v_lshlrev_b32 v20, 16, v28
    v_and_b32 v21, 0xffff0000, v28
    v_cvt_pk_bf16_f32 v28, v22, v23
    v_lshlrev_b32 v22, 16, v28
    v_and_b32 v23, 0xffff0000, v28
    v_cvt_pk_bf16_f32 v28, v24, v25
    v_lshlrev_b32 v24, 16, v28
    v_and_b32 v25, 0xffff0000, v28
    v_cvt_pk_bf16_f32 v28, v26, v27
    v_lshlrev_b32 v26, 16, v28
    v_and_b32 v27, 0xffff0000, v28
    v_cndmask_b32 v32, v24, v12, s[62:63]
    v_cndmask_b32 v36, v24, v13, s[62:63]
    v_cndmask_b32 v33, v25, v12, s[62:63]
    v_cndmask_b32 v37, v25, v13, s[62:63]
    v_cndmask_b32 v34, v26, v12, s[62:63]
    v_cndmask_b32 v38, v26, v13, s[62:63]
    v_cndmask_b32 v35, v27, v12, s[62:63]
    v_cndmask_b32 v39, v27, v13, s[62:63]
    v_max3_f32 v29, v20, v21, v22
    v_min3_f32 v30, v20, v21, v22
    v_max3_f32 v29, v29, v23, v32
    v_min3_f32 v30, v30, v23, v36
    v_max3_f32 v29, v29, v33, v34
    v_min3_f32 v30, v30, v37, v38
    v_max_f32 v29, v29, v35
    v_min_f32 v30, v30, v39
    v_mov_b32 v31, v29
    s_nop 1
    v_permlane32_swap_b32 v29, v31
    v_max_f32 v29, v29, v31
    v_mov_b32 v31, v29
    s_nop 1
    v_permlane16_swap_b32 v29, v31
    v_max_f32 v29, v29, v31
    v_mov_b32 v31, v30
    s_nop 1
    v_permlane32_swap_b32 v30, v31
    v_min_f32 v30, v30, v31
    v_mov_b32 v31, v30
    s_nop 1
    v_permlane16_swap_b32 v30, v31
    v_min_f32 v30, v30, v31
    v_mul_f32 v29, s72, v29
    v_mul_f32 v30, s71, v30
    v_fma_f32 v40, v20, s71, v29
    v_fma_f32 v44, v32, s71, v29
    v_fma_f32 v48, v20, s72, v30
    v_fma_f32 v52, v36, s72, v30
    v_fma_f32 v41, v21, s71, v29
    v_fma_f32 v45, v33, s71, v29
    v_fma_f32 v49, v21, s72, v30
    v_fma_f32 v53, v37, s72, v30
    v_fma_f32 v42, v22, s71, v29
    v_fma_f32 v46, v34, s71, v29
    v_fma_f32 v50, v22, s72, v30
    v_fma_f32 v54, v38, s72, v30
    v_fma_f32 v43, v23, s71, v29
    v_fma_f32 v47, v35, s71, v29
    v_fma_f32 v51, v23, s72, v30
    v_fma_f32 v55, v39, s72, v30
    v_exp_f32 v40, v40
    v_exp_f32 v41, v41
    v_exp_f32 v42, v42
    v_exp_f32 v43, v43
    v_exp_f32 v44, v44
    v_exp_f32 v45, v45
    v_exp_f32 v46, v46
    v_exp_f32 v47, v47
    v_exp_f32 v48, v48
    v_exp_f32 v49, v49
    v_exp_f32 v50, v50
    v_exp_f32 v51, v51
    v_exp_f32 v52, v52
    v_exp_f32 v53, v53
    v_exp_f32 v54, v54
    v_exp_f32 v55, v55
    v_add_f32 v29, v40, v41
    v_add_f32 v30, v48, v49
    v_add_f32 v29, v29, v42
    v_add_f32 v30, v30, v50
    v_add_f32 v29, v29, v43
    v_add_f32 v30, v30, v51
    v_add_f32 v29, v29, v44
    v_add_f32 v30, v30, v52
    v_add_f32 v29, v29, v45
    v_add_f32 v30, v30, v53
    v_add_f32 v29, v29, v46
    v_add_f32 v30, v30, v54
    v_add_f32 v29, v29, v47
    v_add_f32 v30, v30, v55
    v_mov_b32 v31, v29
    s_nop 1
    v_permlane32_swap_b32 v29, v31
    v_add_f32 v29, v29, v31
    v_mov_b32 v31, v29
    s_nop 1
    v_permlane16_swap_b32 v29, v31
    v_add_f32 v29, v29, v31
    v_mov_b32 v31, v30
    s_nop 1
    v_permlane32_swap_b32 v30, v31
    v_add_f32 v30, v30, v31
    v_mov_b32 v31, v30
    s_nop 1
    v_permlane16_swap_b32 v30, v31
    v_add_f32 v30, v30, v31
    v_rcp_f32 v29, v29
    v_rcp_f32 v30, v30
    v_mul_f32 v40, v40, v29
    v_mul_f32 v48, v48, v30
    v_mul_f32 v41, v41, v29
    v_mul_f32 v49, v49, v30
    v_mul_f32 v42, v42, v29
    v_mul_f32 v50, v50, v30
    v_mul_f32 v43, v43, v29
    v_mul_f32 v51, v51, v30
    v_mul_f32 v44, v44, v29
    v_mul_f32 v52, v52, v30
    v_mul_f32 v45, v45, v29
    v_mul_f32 v53, v53, v30
    v_mul_f32 v46, v46, v29
    v_mul_f32 v54, v54, v30
    v_mul_f32 v47, v47, v29
    v_mul_f32 v55, v55, v30
    v_cvt_pk_bf16_f32 v56, v40, v41
    v_cvt_pk_bf16_f32 v57, v42, v43
    v_cvt_pk_bf16_f32 v58, v44, v45
    v_cvt_pk_bf16_f32 v59, v46, v47
    v_cvt_pk_bf16_f32 v60, v48, v49
    v_cvt_pk_bf16_f32 v61, v50, v51
    v_cvt_pk_bf16_f32 v62, v52, v53
    v_cvt_pk_bf16_f32 v63, v54, v55
    s_mov_b32 s54, 0
    buffer_store_dwordx4 v[56:59], v8, s[16:19], s54 offen offset:0
    buffer_store_dwordx4 v[60:63], v8, s[16:19], s54 offen offset:64
    v_cvt_pk_bf16_f32 v16, v68, v69
    v_cvt_pk_bf16_f32 v17, v70, v71
    v_cvt_pk_bf16_f32 v18, v76, v77
    v_cvt_pk_bf16_f32 v19, v78, v79
    s_nop 1
    v_mfma_f32_16x16x32_bf16 v[20:23], v[192:195], v[16:19], 0
    v_mfma_f32_16x16x32_bf16 v[24:27], v[196:199], v[16:19], 0
    s_nop 6
    v_cvt_pk_bf16_f32 v28, v20, v21
    v_lshlrev_b32 v20, 16, v28
    v_and_b32 v21, 0xffff0000, v28
    v_cvt_pk_bf16_f32 v28, v22, v23
    v_lshlrev_b32 v22, 16, v28
    v_and_b32 v23, 0xffff0000, v28
    v_cvt_pk_bf16_f32 v28, v24, v25
    v_lshlrev_b32 v24, 16, v28
    v_and_b32 v25, 0xffff0000, v28
    v_cvt_pk_bf16_f32 v28, v26, v27
    v_lshlrev_b32 v26, 16, v28
    v_and_b32 v27, 0xffff0000, v28
    v_cndmask_b32 v32, v24, v12, s[62:63]
    v_cndmask_b32 v36, v24, v13, s[62:63]
    v_cndmask_b32 v33, v25, v12, s[62:63]
    v_cndmask_b32 v37, v25, v13, s[62:63]
    v_cndmask_b32 v34, v26, v12, s[62:63]
    v_cndmask_b32 v38, v26, v13, s[62:63]
    v_cndmask_b32 v35, v27, v12, s[62:63]
    v_cndmask_b32 v39, v27, v13, s[62:63]
    v_max3_f32 v29, v20, v21, v22
    v_min3_f32 v30, v20, v21, v22
    v_max3_f32 v29, v29, v23, v32
    v_min3_f32 v30, v30, v23, v36
    v_max3_f32 v29, v29, v33, v34
    v_min3_f32 v30, v30, v37, v38
    v_max_f32 v29, v29, v35
    v_min_f32 v30, v30, v39
    v_mov_b32 v31, v29
    s_nop 1
    v_permlane32_swap_b32 v29, v31
    v_max_f32 v29, v29, v31
    v_mov_b32 v31, v29
    s_nop 1
    v_permlane16_swap_b32 v29, v31
    v_max_f32 v29, v29, v31
    v_mov_b32 v31, v30
    s_nop 1
    v_permlane32_swap_b32 v30, v31
    v_min_f32 v30, v30, v31
    v_mov_b32 v31, v30
    s_nop 1
    v_permlane16_swap_b32 v30, v31
    v_min_f32 v30, v30, v31
    v_mul_f32 v29, s72, v29
    v_mul_f32 v30, s71, v30
    v_fma_f32 v40, v20, s71, v29
    v_fma_f32 v44, v32, s71, v29
    v_fma_f32 v48, v20, s72, v30
    v_fma_f32 v52, v36, s72, v30
    v_fma_f32 v41, v21, s71, v29
    v_fma_f32 v45, v33, s71, v29
    v_fma_f32 v49, v21, s72, v30
    v_fma_f32 v53, v37, s72, v30
    v_fma_f32 v42, v22, s71, v29
    v_fma_f32 v46, v34, s71, v29
    v_fma_f32 v50, v22, s72, v30
    v_fma_f32 v54, v38, s72, v30
    v_fma_f32 v43, v23, s71, v29
    v_fma_f32 v47, v35, s71, v29
    v_fma_f32 v51, v23, s72, v30
    v_fma_f32 v55, v39, s72, v30
    v_exp_f32 v40, v40
    v_exp_f32 v41, v41
    v_exp_f32 v42, v42
    v_exp_f32 v43, v43
    v_exp_f32 v44, v44
    v_exp_f32 v45, v45
    v_exp_f32 v46, v46
    v_exp_f32 v47, v47
    v_exp_f32 v48, v48
    v_exp_f32 v49, v49
    v_exp_f32 v50, v50
    v_exp_f32 v51, v51
    v_exp_f32 v52, v52
    v_exp_f32 v53, v53
    v_exp_f32 v54, v54
    v_exp_f32 v55, v55
    v_add_f32 v29, v40, v41
    v_add_f32 v30, v48, v49
    v_add_f32 v29, v29, v42
    v_add_f32 v30, v30, v50
    v_add_f32 v29, v29, v43
    v_add_f32 v30, v30, v51
    v_add_f32 v29, v29, v44
    v_add_f32 v30, v30, v52
    v_add_f32 v29, v29, v45
    v_add_f32 v30, v30, v53
    v_add_f32 v29, v29, v46
    v_add_f32 v30, v30, v54
    v_add_f32 v29, v29, v47
    v_add_f32 v30, v30, v55
    v_mov_b32 v31, v29
    s_nop 1
    v_permlane32_swap_b32 v29, v31
    v_add_f32 v29, v29, v31
    v_mov_b32 v31, v29
    s_nop 1
    v_permlane16_swap_b32 v29, v31
    v_add_f32 v29, v29, v31
    v_mov_b32 v31, v30
    s_nop 1
    v_permlane32_swap_b32 v30, v31
    v_add_f32 v30, v30, v31
    v_mov_b32 v31, v30
    s_nop 1
    v_permlane16_swap_b32 v30, v31
    v_add_f32 v30, v30, v31
    v_rcp_f32 v29, v29
    v_rcp_f32 v30, v30
    v_mul_f32 v40, v40, v29
    v_mul_f32 v48, v48, v30
    v_mul_f32 v41, v41, v29
    v_mul_f32 v49, v49, v30
    v_mul_f32 v42, v42, v29
    v_mul_f32 v50, v50, v30
    v_mul_f32 v43, v43, v29
    v_mul_f32 v51, v51, v30
    v_mul_f32 v44, v44, v29
    v_mul_f32 v52, v52, v30
    v_mul_f32 v45, v45, v29
    v_mul_f32 v53, v53, v30
    v_mul_f32 v46, v46, v29
    v_mul_f32 v54, v54, v30
    v_mul_f32 v47, v47, v29
    v_mul_f32 v55, v55, v30
    v_cvt_pk_bf16_f32 v56, v40, v41
    v_cvt_pk_bf16_f32 v57, v42, v43
    v_cvt_pk_bf16_f32 v58, v44, v45
    v_cvt_pk_bf16_f32 v59, v46, v47
    v_cvt_pk_bf16_f32 v60, v48, v49
    v_cvt_pk_bf16_f32 v61, v50, v51
    v_cvt_pk_bf16_f32 v62, v52, v53
    v_cvt_pk_bf16_f32 v63, v54, v55
    s_mov_b32 s54, 32768
    buffer_store_dwordx4 v[56:59], v8, s[16:19], s54 offen offset:0
    buffer_store_dwordx4 v[60:63], v8, s[16:19], s54 offen offset:64
    v_cvt_pk_bf16_f32 v16, v80, v81
    v_cvt_pk_bf16_f32 v17, v82, v83
    v_cvt_pk_bf16_f32 v18, v88, v89
    v_cvt_pk_bf16_f32 v19, v90, v91
    s_nop 1
    v_mfma_f32_16x16x32_bf16 v[20:23], v[200:203], v[16:19], 0
    v_mfma_f32_16x16x32_bf16 v[24:27], v[204:207], v[16:19], 0
    s_nop 6
    v_cvt_pk_bf16_f32 v28, v20, v21
    v_lshlrev_b32 v20, 16, v28
    v_and_b32 v21, 0xffff0000, v28
    v_cvt_pk_bf16_f32 v28, v22, v23
    v_lshlrev_b32 v22, 16, v28
    v_and_b32 v23, 0xffff0000, v28
    v_cvt_pk_bf16_f32 v28, v24, v25
    v_lshlrev_b32 v24, 16, v28
    v_and_b32 v25, 0xffff0000, v28
    v_cvt_pk_bf16_f32 v28, v26, v27
    v_lshlrev_b32 v26, 16, v28
    v_and_b32 v27, 0xffff0000, v28
    v_cndmask_b32 v32, v24, v12, s[62:63]
    v_cndmask_b32 v36, v24, v13, s[62:63]
    v_cndmask_b32 v33, v25, v12, s[62:63]
    v_cndmask_b32 v37, v25, v13, s[62:63]
    v_cndmask_b32 v34, v26, v12, s[62:63]
    v_cndmask_b32 v38, v26, v13, s[62:63]
    v_cndmask_b32 v35, v27, v12, s[62:63]
    v_cndmask_b32 v39, v27, v13, s[62:63]
    v_max3_f32 v29, v20, v21, v22
    v_min3_f32 v30, v20, v21, v22
    v_max3_f32 v29, v29, v23, v32
    v_min3_f32 v30, v30, v23, v36
    v_max3_f32 v29, v29, v33, v34
    v_min3_f32 v30, v30, v37, v38
    v_max_f32 v29, v29, v35
    v_min_f32 v30, v30, v39
    v_mov_b32 v31, v29
    s_nop 1
    v_permlane32_swap_b32 v29, v31
    v_max_f32 v29, v29, v31
    v_mov_b32 v31, v29
    s_nop 1
    v_permlane16_swap_b32 v29, v31
    v_max_f32 v29, v29, v31
    v_mov_b32 v31, v30
    s_nop 1
    v_permlane32_swap_b32 v30, v31
    v_min_f32 v30, v30, v31
    v_mov_b32 v31, v30
    s_nop 1
    v_permlane16_swap_b32 v30, v31
    v_min_f32 v30, v30, v31
    v_mul_f32 v29, s72, v29
    v_mul_f32 v30, s71, v30
    v_fma_f32 v40, v20, s71, v29
    v_fma_f32 v44, v32, s71, v29
    v_fma_f32 v48, v20, s72, v30
    v_fma_f32 v52, v36, s72, v30
    v_fma_f32 v41, v21, s71, v29
    v_fma_f32 v45, v33, s71, v29
    v_fma_f32 v49, v21, s72, v30
    v_fma_f32 v53, v37, s72, v30
    v_fma_f32 v42, v22, s71, v29
    v_fma_f32 v46, v34, s71, v29
    v_fma_f32 v50, v22, s72, v30
    v_fma_f32 v54, v38, s72, v30
    v_fma_f32 v43, v23, s71, v29
    v_fma_f32 v47, v35, s71, v29
    v_fma_f32 v51, v23, s72, v30
    v_fma_f32 v55, v39, s72, v30
    v_exp_f32 v40, v40
    v_exp_f32 v41, v41
    v_exp_f32 v42, v42
    v_exp_f32 v43, v43
    v_exp_f32 v44, v44
    v_exp_f32 v45, v45
    v_exp_f32 v46, v46
    v_exp_f32 v47, v47
    v_exp_f32 v48, v48
    v_exp_f32 v49, v49
    v_exp_f32 v50, v50
    v_exp_f32 v51, v51
    v_exp_f32 v52, v52
    v_exp_f32 v53, v53
    v_exp_f32 v54, v54
    v_exp_f32 v55, v55
    v_add_f32 v29, v40, v41
    v_add_f32 v30, v48, v49
    v_add_f32 v29, v29, v42
    v_add_f32 v30, v30, v50
    v_add_f32 v29, v29, v43
    v_add_f32 v30, v30, v51
    v_add_f32 v29, v29, v44
    v_add_f32 v30, v30, v52
    v_add_f32 v29, v29, v45
    v_add_f32 v30, v30, v53
    v_add_f32 v29, v29, v46
    v_add_f32 v30, v30, v54
    v_add_f32 v29, v29, v47
    v_add_f32 v30, v30, v55
    v_mov_b32 v31, v29
    s_nop 1
    v_permlane32_swap_b32 v29, v31
    v_add_f32 v29, v29, v31
    v_mov_b32 v31, v29
    s_nop 1
    v_permlane16_swap_b32 v29, v31
    v_add_f32 v29, v29, v31
    v_mov_b32 v31, v30
    s_nop 1
    v_permlane32_swap_b32 v30, v31
    v_add_f32 v30, v30, v31
    v_mov_b32 v31, v30
    s_nop 1
    v_permlane16_swap_b32 v30, v31
    v_add_f32 v30, v30, v31
    v_rcp_f32 v29, v29
    v_rcp_f32 v30, v30
    v_mul_f32 v40, v40, v29
    v_mul_f32 v48, v48, v30
    v_mul_f32 v41, v41, v29
    v_mul_f32 v49, v49, v30
    v_mul_f32 v42, v42, v29
    v_mul_f32 v50, v50, v30
    v_mul_f32 v43, v43, v29
    v_mul_f32 v51, v51, v30
    v_mul_f32 v44, v44, v29
    v_mul_f32 v52, v52, v30
    v_mul_f32 v45, v45, v29
    v_mul_f32 v53, v53, v30
    v_mul_f32 v46, v46, v29
    v_mul_f32 v54, v54, v30
    v_mul_f32 v47, v47, v29
    v_mul_f32 v55, v55, v30
    v_cvt_pk_bf16_f32 v56, v40, v41
    v_cvt_pk_bf16_f32 v57, v42, v43
    v_cvt_pk_bf16_f32 v58, v44, v45
    v_cvt_pk_bf16_f32 v59, v46, v47
    v_cvt_pk_bf16_f32 v60, v48, v49
    v_cvt_pk_bf16_f32 v61, v50, v51
    v_cvt_pk_bf16_f32 v62, v52, v53
    v_cvt_pk_bf16_f32 v63, v54, v55
    s_mov_b32 s54, 0
    buffer_store_dwordx4 v[56:59], v8, s[16:19], s54 offen offset:128
    buffer_store_dwordx4 v[60:63], v8, s[16:19], s54 offen offset:192
    v_cvt_pk_bf16_f32 v16, v84, v85
    v_cvt_pk_bf16_f32 v17, v86, v87
    v_cvt_pk_bf16_f32 v18, v92, v93
    v_cvt_pk_bf16_f32 v19, v94, v95
    s_nop 1
    v_mfma_f32_16x16x32_bf16 v[20:23], v[200:203], v[16:19], 0
    v_mfma_f32_16x16x32_bf16 v[24:27], v[204:207], v[16:19], 0
    s_nop 6
    v_cvt_pk_bf16_f32 v28, v20, v21
    v_lshlrev_b32 v20, 16, v28
    v_and_b32 v21, 0xffff0000, v28
    v_cvt_pk_bf16_f32 v28, v22, v23
    v_lshlrev_b32 v22, 16, v28
    v_and_b32 v23, 0xffff0000, v28
    v_cvt_pk_bf16_f32 v28, v24, v25
    v_lshlrev_b32 v24, 16, v28
    v_and_b32 v25, 0xffff0000, v28
    v_cvt_pk_bf16_f32 v28, v26, v27
    v_lshlrev_b32 v26, 16, v28
    v_and_b32 v27, 0xffff0000, v28
    v_cndmask_b32 v32, v24, v12, s[62:63]
    v_cndmask_b32 v36, v24, v13, s[62:63]
    v_cndmask_b32 v33, v25, v12, s[62:63]
    v_cndmask_b32 v37, v25, v13, s[62:63]
    v_cndmask_b32 v34, v26, v12, s[62:63]
    v_cndmask_b32 v38, v26, v13, s[62:63]
    v_cndmask_b32 v35, v27, v12, s[62:63]
    v_cndmask_b32 v39, v27, v13, s[62:63]
    v_max3_f32 v29, v20, v21, v22
    v_min3_f32 v30, v20, v21, v22
    v_max3_f32 v29, v29, v23, v32
    v_min3_f32 v30, v30, v23, v36
    v_max3_f32 v29, v29, v33, v34
    v_min3_f32 v30, v30, v37, v38
    v_max_f32 v29, v29, v35
    v_min_f32 v30, v30, v39
    v_mov_b32 v31, v29
    s_nop 1
    v_permlane32_swap_b32 v29, v31
    v_max_f32 v29, v29, v31
    v_mov_b32 v31, v29
    s_nop 1
    v_permlane16_swap_b32 v29, v31
    v_max_f32 v29, v29, v31
    v_mov_b32 v31, v30
    s_nop 1
    v_permlane32_swap_b32 v30, v31
    v_min_f32 v30, v30, v31
    v_mov_b32 v31, v30
    s_nop 1
    v_permlane16_swap_b32 v30, v31
    v_min_f32 v30, v30, v31
    v_mul_f32 v29, s72, v29
    v_mul_f32 v30, s71, v30
    v_fma_f32 v40, v20, s71, v29
    v_fma_f32 v44, v32, s71, v29
    v_fma_f32 v48, v20, s72, v30
    v_fma_f32 v52, v36, s72, v30
    v_fma_f32 v41, v21, s71, v29
    v_fma_f32 v45, v33, s71, v29
    v_fma_f32 v49, v21, s72, v30
    v_fma_f32 v53, v37, s72, v30
    v_fma_f32 v42, v22, s71, v29
    v_fma_f32 v46, v34, s71, v29
    v_fma_f32 v50, v22, s72, v30
    v_fma_f32 v54, v38, s72, v30
    v_fma_f32 v43, v23, s71, v29
    v_fma_f32 v47, v35, s71, v29
    v_fma_f32 v51, v23, s72, v30
    v_fma_f32 v55, v39, s72, v30
    v_exp_f32 v40, v40
    v_exp_f32 v41, v41
    v_exp_f32 v42, v42
    v_exp_f32 v43, v43
    v_exp_f32 v44, v44
    v_exp_f32 v45, v45
    v_exp_f32 v46, v46
    v_exp_f32 v47, v47
    v_exp_f32 v48, v48
    v_exp_f32 v49, v49
    v_exp_f32 v50, v50
    v_exp_f32 v51, v51
    v_exp_f32 v52, v52
    v_exp_f32 v53, v53
    v_exp_f32 v54, v54
    v_exp_f32 v55, v55
    v_add_f32 v29, v40, v41
    v_add_f32 v30, v48, v49
    v_add_f32 v29, v29, v42
    v_add_f32 v30, v30, v50
    v_add_f32 v29, v29, v43
    v_add_f32 v30, v30, v51
    v_add_f32 v29, v29, v44
    v_add_f32 v30, v30, v52
    v_add_f32 v29, v29, v45
    v_add_f32 v30, v30, v53
    v_add_f32 v29, v29, v46
    v_add_f32 v30, v30, v54
    v_add_f32 v29, v29, v47
    v_add_f32 v30, v30, v55
    v_mov_b32 v31, v29
    s_nop 1
    v_permlane32_swap_b32 v29, v31
    v_add_f32 v29, v29, v31
    v_mov_b32 v31, v29
    s_nop 1
    v_permlane16_swap_b32 v29, v31
    v_add_f32 v29, v29, v31
    v_mov_b32 v31, v30
    s_nop 1
    v_permlane32_swap_b32 v30, v31
    v_add_f32 v30, v30, v31
    v_mov_b32 v31, v30
    s_nop 1
    v_permlane16_swap_b32 v30, v31
    v_add_f32 v30, v30, v31
    v_rcp_f32 v29, v29
    v_rcp_f32 v30, v30
    v_mul_f32 v40, v40, v29
    v_mul_f32 v48, v48, v30
    v_mul_f32 v41, v41, v29
    v_mul_f32 v49, v49, v30
    v_mul_f32 v42, v42, v29
    v_mul_f32 v50, v50, v30
    v_mul_f32 v43, v43, v29
    v_mul_f32 v51, v51, v30
    v_mul_f32 v44, v44, v29
    v_mul_f32 v52, v52, v30
    v_mul_f32 v45, v45, v29
    v_mul_f32 v53, v53, v30
    v_mul_f32 v46, v46, v29
    v_mul_f32 v54, v54, v30
    v_mul_f32 v47, v47, v29
    v_mul_f32 v55, v55, v30
    v_cvt_pk_bf16_f32 v56, v40, v41
    v_cvt_pk_bf16_f32 v57, v42, v43
    v_cvt_pk_bf16_f32 v58, v44, v45
    v_cvt_pk_bf16_f32 v59, v46, v47
    v_cvt_pk_bf16_f32 v60, v48, v49
    v_cvt_pk_bf16_f32 v61, v50, v51
    v_cvt_pk_bf16_f32 v62, v52, v53
    v_cvt_pk_bf16_f32 v63, v54, v55
    s_mov_b32 s54, 32768
    buffer_store_dwordx4 v[56:59], v8, s[16:19], s54 offen offset:128
    buffer_store_dwordx4 v[60:63], v8, s[16:19], s54 offen offset:192
    s_nop 1
    s_branch K1_END
K1_KV:
    s_lshl_b32 s57, s69, 3
    s_lshl_b32 s58, s48, 1
    s_add_u32 s57, s57, s58
    s_mul_i32 s58, s57, 1568
    v_lshlrev_b32 v8, 4, v1
    v_lshrrev_b32 v9, 2, v3
    v_lshl_add_u32 v9, v2, 2, v9
    v_mul_u32_u24 v9, 56, v9
    v_and_b32 v10, 3, v3
    v_lshl_add_u32 v9, v10, 3, v9
    s_lshl_b32 s57, s81, 12
    s_add_u32 s57, s57, 125952
    v_add_u32 v9, s57, v9
    s_waitcnt vmcnt(8)
    s_barrier
    v_add_u32 v7, s52, v6
    ds_read_b128 v[16:19], v5 offset:0
    ds_read_b128 v[20:23], v5 offset:14592
    ds_read_b64_tr_b16 v[32:33], v7 offset:0
    ds_read_b64_tr_b16 v[34:35], v7 offset:4224
    ds_read_b64_tr_b16 v[36:37], v7 offset:32
    ds_read_b64_tr_b16 v[38:39], v7 offset:4256
    ds_read_b64_tr_b16 v[40:41], v7 offset:56
    ds_read_b64_tr_b16 v[42:43], v7 offset:4280
    ds_read_b64_tr_b16 v[44:45], v7 offset:88
    ds_read_b64_tr_b16 v[46:47], v7 offset:4312
    ds_read_b64_tr_b16 v[48:49], v7 offset:448
    ds_read_b64_tr_b16 v[50:51], v7 offset:4672
    ds_read_b64_tr_b16 v[52:53], v7 offset:480
    ds_read_b64_tr_b16 v[54:55], v7 offset:4704
    ds_read_b64_tr_b16 v[56:57], v7 offset:504
    ds_read_b64_tr_b16 v[58:59], v7 offset:4728
    ds_read_b64_tr_b16 v[60:61], v7 offset:536
    ds_read_b64_tr_b16 v[62:63], v7 offset:4760
    v_add_u32 v5, 64, v5
    s_add_u32 s52, s52, 33792
    s_cmp_eq_u32 s52, 159744
    s_cselect_b32 s52, 58368, s52
    s_mov_b32 s53, 5
K1_LOOP_KV:
    s_waitcnt vmcnt(4) lgkmcnt(0)
    s_barrier
    v_add_u32 v7, s52, v6
    ds_read_b128 v[192:195], v5 offset:0
    ds_read_b128 v[196:199], v5 offset:14592
    ds_read_b64_tr_b16 v[208:209], v7 offset:0
    ds_read_b64_tr_b16 v[210:211], v7 offset:4224
    ds_read_b64_tr_b16 v[212:213], v7 offset:32
    ds_read_b64_tr_b16 v[214:215], v7 offset:4256
    ds_read_b64_tr_b16 v[216:217], v7 offset:56
    ds_read_b64_tr_b16 v[218:219], v7 offset:4280
    ds_read_b64_tr_b16 v[220:221], v7 offset:88
    ds_read_b64_tr_b16 v[222:223], v7 offset:4312
    ds_read_b64_tr_b16 v[224:225], v7 offset:448
    ds_read_b64_tr_b16 v[226:227], v7 offset:4672
    ds_read_b64_tr_b16 v[228:229], v7 offset:480
    ds_read_b64_tr_b16 v[230:231], v7 offset:4704
    ds_read_b64_tr_b16 v[232:233], v7 offset:504
    ds_read_b64_tr_b16 v[234:235], v7 offset:4728
    ds_read_b64_tr_b16 v[236:237], v7 offset:536
    ds_read_b64_tr_b16 v[238:239], v7 offset:4760
    v_add_u32 v5, 64, v5
    s_add_u32 s52, s52, 33792
    s_cmp_eq_u32 s52, 159744
    s_cselect_b32 s52, 58368, s52
    v_mfma_f32_16x16x32_bf16 v[64:67], v[32:35], v[16:19], v[64:67]
    v_mfma_f32_16x16x32_bf16 v[68:71], v[32:35], v[20:23], v[68:71]
    s_add_u32 s54, s51, s55
    v_mfma_f32_16x16x32_bf16 v[72:75], v[36:39], v[16:19], v[72:75]
    v_mfma_f32_16x16x32_bf16 v[76:79], v[36:39], v[20:23], v[76:79]
    s_add_u32 m0, s54, 0
    s_mov_b64 exec, s[66:67]
    buffer_load_dwordx4 v4, s[8:11], s50 offen lds
    s_mov_b64 exec, -1
    s_add_u32 s50, s50, s49
    v_mfma_f32_16x16x32_bf16 v[80:83], v[40:43], v[16:19], v[80:83]
    v_mfma_f32_16x16x32_bf16 v[84:87], v[40:43], v[20:23], v[84:87]
    s_add_u32 m0, s54, 1056
    s_mov_b64 exec, s[66:67]
    buffer_load_dwordx4 v4, s[8:11], s50 offen lds
    s_mov_b64 exec, -1
    s_add_u32 s50, s50, s49
    v_mfma_f32_16x16x32_bf16 v[88:91], v[44:47], v[16:19], v[88:91]
    v_mfma_f32_16x16x32_bf16 v[92:95], v[44:47], v[20:23], v[92:95]
    s_add_u32 m0, s54, 2112
    s_mov_b64 exec, s[66:67]
    buffer_load_dwordx4 v4, s[8:11], s50 offen lds
    s_mov_b64 exec, -1
    s_add_u32 s50, s50, s49
    v_mfma_f32_16x16x32_bf16 v[96:99], v[16:19], v[48:51], v[96:99]
    v_mfma_f32_16x16x32_bf16 v[100:103], v[20:23], v[48:51], v[100:103]
    s_add_u32 m0, s54, 3168
    s_mov_b64 exec, s[66:67]
    buffer_load_dwordx4 v4, s[8:11], s50 offen lds
    s_mov_b64 exec, -1
    s_add_u32 s50, s50, s49
    v_mfma_f32_16x16x32_bf16 v[104:107], v[16:19], v[52:55], v[104:107]
    v_mfma_f32_16x16x32_bf16 v[108:111], v[20:23], v[52:55], v[108:111]
    s_add_u32 s50, s50, s56
    s_add_u32 s51, s51, 33792
    s_cmp_eq_u32 s51, 159744
    s_cselect_b32 s51, 58368, s51
    v_mfma_f32_16x16x32_bf16 v[112:115], v[16:19], v[56:59], v[112:115]
    v_mfma_f32_16x16x32_bf16 v[116:119], v[20:23], v[56:59], v[116:119]
    v_mfma_f32_16x16x32_bf16 v[120:123], v[16:19], v[60:63], v[120:123]
    v_mfma_f32_16x16x32_bf16 v[124:127], v[20:23], v[60:63], v[124:127]
    s_waitcnt vmcnt(4) lgkmcnt(0)
    s_barrier
    v_add_u32 v7, s52, v6
    ds_read_b128 v[16:19], v5 offset:0
    ds_read_b128 v[20:23], v5 offset:14592
    ds_read_b64_tr_b16 v[32:33], v7 offset:0
    ds_read_b64_tr_b16 v[34:35], v7 offset:4224
    ds_read_b64_tr_b16 v[36:37], v7 offset:32
    ds_read_b64_tr_b16 v[38:39], v7 offset:4256
    ds_read_b64_tr_b16 v[40:41], v7 offset:56
    ds_read_b64_tr_b16 v[42:43], v7 offset:4280
    ds_read_b64_tr_b16 v[44:45], v7 offset:88
    ds_read_b64_tr_b16 v[46:47], v7 offset:4312
    ds_read_b64_tr_b16 v[48:49], v7 offset:448
    ds_read_b64_tr_b16 v[50:51], v7 offset:4672
    ds_read_b64_tr_b16 v[52:53], v7 offset:480
    ds_read_b64_tr_b16 v[54:55], v7 offset:4704
    ds_read_b64_tr_b16 v[56:57], v7 offset:504
    ds_read_b64_tr_b16 v[58:59], v7 offset:4728
    ds_read_b64_tr_b16 v[60:61], v7 offset:536
    ds_read_b64_tr_b16 v[62:63], v7 offset:4760
    v_add_u32 v5, 64, v5
    s_add_u32 s52, s52, 33792
    s_cmp_eq_u32 s52, 159744
    s_cselect_b32 s52, 58368, s52
    v_mfma_f32_16x16x32_bf16 v[64:67], v[208:211], v[192:195], v[64:67]
    v_mfma_f32_16x16x32_bf16 v[68:71], v[208:211], v[196:199], v[68:71]
    s_add_u32 s54, s51, s55
    v_mfma_f32_16x16x32_bf16 v[72:75], v[212:215], v[192:195], v[72:75]
    v_mfma_f32_16x16x32_bf16 v[76:79], v[212:215], v[196:199], v[76:79]
    s_add_u32 m0, s54, 0
    s_mov_b64 exec, s[66:67]
    buffer_load_dwordx4 v4, s[8:11], s50 offen lds
    s_mov_b64 exec, -1
    s_add_u32 s50, s50, s49
    v_mfma_f32_16x16x32_bf16 v[80:83], v[216:219], v[192:195], v[80:83]
    v_mfma_f32_16x16x32_bf16 v[84:87], v[216:219], v[196:199], v[84:87]
    s_add_u32 m0, s54, 1056
    s_mov_b64 exec, s[66:67]
    buffer_load_dwordx4 v4, s[8:11], s50 offen lds
    s_mov_b64 exec, -1
    s_add_u32 s50, s50, s49
    v_mfma_f32_16x16x32_bf16 v[88:91], v[220:223], v[192:195], v[88:91]
    v_mfma_f32_16x16x32_bf16 v[92:95], v[220:223], v[196:199], v[92:95]
    s_add_u32 m0, s54, 2112
    s_mov_b64 exec, s[66:67]
    buffer_load_dwordx4 v4, s[8:11], s50 offen lds
    s_mov_b64 exec, -1
    s_add_u32 s50, s50, s49
    v_mfma_f32_16x16x32_bf16 v[96:99], v[192:195], v[224:227], v[96:99]
    v_mfma_f32_16x16x32_bf16 v[100:103], v[196:199], v[224:227], v[100:103]
    s_add_u32 m0, s54, 3168
    s_mov_b64 exec, s[66:67]
    buffer_load_dwordx4 v4, s[8:11], s50 offen lds
    s_mov_b64 exec, -1
    s_add_u32 s50, s50, s49
    v_mfma_f32_16x16x32_bf16 v[104:107], v[192:195], v[228:231], v[104:107]
    v_mfma_f32_16x16x32_bf16 v[108:111], v[196:199], v[228:231], v[108:111]
    s_add_u32 s50, s50, s56
    s_add_u32 s51, s51, 33792
    s_cmp_eq_u32 s51, 159744
    s_cselect_b32 s51, 58368, s51
    v_mfma_f32_16x16x32_bf16 v[112:115], v[192:195], v[232:235], v[112:115]
    v_mfma_f32_16x16x32_bf16 v[116:119], v[196:199], v[232:235], v[116:119]
    v_mfma_f32_16x16x32_bf16 v[120:123], v[192:195], v[236:239], v[120:123]
    v_mfma_f32_16x16x32_bf16 v[124:127], v[196:199], v[236:239], v[124:127]
    s_sub_u32 s53, s53, 1
    s_cmp_lg_u32 s53, 0
    s_cbranch_scc1 K1_LOOP_KV
    s_waitcnt vmcnt(4) lgkmcnt(0)
    s_barrier
    v_add_u32 v7, s52, v6
    ds_read_b128 v[192:195], v5 offset:0
    ds_read_b128 v[196:199], v5 offset:14592
    ds_read_b64_tr_b16 v[208:209], v7 offset:0
    ds_read_b64_tr_b16 v[210:211], v7 offset:4224
    ds_read_b64_tr_b16 v[212:213], v7 offset:32
    ds_read_b64_tr_b16 v[214:215], v7 offset:4256
    ds_read_b64_tr_b16 v[216:217], v7 offset:56
    ds_read_b64_tr_b16 v[218:219], v7 offset:4280
    ds_read_b64_tr_b16 v[220:221], v7 offset:88
    ds_read_b64_tr_b16 v[222:223], v7 offset:4312
    ds_read_b64_tr_b16 v[224:225], v7 offset:448
    ds_read_b64_tr_b16 v[226:227], v7 offset:4672
    ds_read_b64_tr_b16 v[228:229], v7 offset:480
    ds_read_b64_tr_b16 v[230:231], v7 offset:4704
    ds_read_b64_tr_b16 v[232:233], v7 offset:504
    ds_read_b64_tr_b16 v[234:235], v7 offset:4728
    ds_read_b64_tr_b16 v[236:237], v7 offset:536
    ds_read_b64_tr_b16 v[238:239], v7 offset:4760
    v_add_u32 v5, 64, v5
    s_add_u32 s52, s52, 33792
    s_cmp_eq_u32 s52, 159744
    s_cselect_b32 s52, 58368, s52
    v_mfma_f32_16x16x32_bf16 v[64:67], v[32:35], v[16:19], v[64:67]
    v_mfma_f32_16x16x32_bf16 v[68:71], v[32:35], v[20:23], v[68:71]
    s_add_u32 s54, s51, s55
    v_mfma_f32_16x16x32_bf16 v[72:75], v[36:39], v[16:19], v[72:75]
    v_mfma_f32_16x16x32_bf16 v[76:79], v[36:39], v[20:23], v[76:79]
    s_add_u32 m0, s54, 0
    s_mov_b64 exec, s[66:67]
    buffer_load_dwordx4 v4, s[8:11], s50 offen lds
    s_mov_b64 exec, -1
    s_add_u32 s50, s50, s49
    v_mfma_f32_16x16x32_bf16 v[80:83], v[40:43], v[16:19], v[80:83]
    v_mfma_f32_16x16x32_bf16 v[84:87], v[40:43], v[20:23], v[84:87]
    s_add_u32 m0, s54, 1056
    s_mov_b64 exec, s[66:67]
    buffer_load_dwordx4 v4, s[8:11], s50 offen lds
    s_mov_b64 exec, -1
    s_add_u32 s50, s50, s49
    v_mfma_f32_16x16x32_bf16 v[88:91], v[44:47], v[16:19], v[88:91]
    v_mfma_f32_16x16x32_bf16 v[92:95], v[44:47], v[20:23], v[92:95]
    s_add_u32 m0, s54, 2112
    s_mov_b64 exec, s[66:67]
    buffer_load_dwordx4 v4, s[8:11], s50 offen lds
    s_mov_b64 exec, -1
    s_add_u32 s50, s50, s49
    v_mfma_f32_16x16x32_bf16 v[96:99], v[16:19], v[48:51], v[96:99]
    v_mfma_f32_16x16x32_bf16 v[100:103], v[20:23], v[48:51], v[100:103]
    s_add_u32 m0, s54, 3168
    s_mov_b64 exec, s[66:67]
    buffer_load_dwordx4 v4, s[8:11], s50 offen lds
    s_mov_b64 exec, -1
    s_add_u32 s50, s50, s49
    v_mfma_f32_16x16x32_bf16 v[104:107], v[16:19], v[52:55], v[104:107]
    v_mfma_f32_16x16x32_bf16 v[108:111], v[20:23], v[52:55], v[108:111]
    s_add_u32 s50, s50, s56
    s_add_u32 s51, s51, 33792
    s_cmp_eq_u32 s51, 159744
    s_cselect_b32 s51, 58368, s51
    v_mfma_f32_16x16x32_bf16 v[112:115], v[16:19], v[56:59], v[112:115]
    v_mfma_f32_16x16x32_bf16 v[116:119], v[20:23], v[56:59], v[116:119]
    v_mfma_f32_16x16x32_bf16 v[120:123], v[16:19], v[60:63], v[120:123]
    v_mfma_f32_16x16x32_bf16 v[124:127], v[20:23], v[60:63], v[124:127]
    s_waitcnt vmcnt(4) lgkmcnt(0)
    s_barrier
    v_add_u32 v7, s52, v6
    ds_read_b128 v[16:19], v5 offset:0
    ds_read_b128 v[20:23], v5 offset:14592
    ds_read_b64_tr_b16 v[32:33], v7 offset:0
    ds_read_b64_tr_b16 v[34:35], v7 offset:4224
    ds_read_b64_tr_b16 v[36:37], v7 offset:32
    ds_read_b64_tr_b16 v[38:39], v7 offset:4256
    ds_read_b64_tr_b16 v[40:41], v7 offset:56
    ds_read_b64_tr_b16 v[42:43], v7 offset:4280
    ds_read_b64_tr_b16 v[44:45], v7 offset:88
    ds_read_b64_tr_b16 v[46:47], v7 offset:4312
    ds_read_b64_tr_b16 v[48:49], v7 offset:448
    ds_read_b64_tr_b16 v[50:51], v7 offset:4672
    ds_read_b64_tr_b16 v[52:53], v7 offset:480
    ds_read_b64_tr_b16 v[54:55], v7 offset:4704
    ds_read_b64_tr_b16 v[56:57], v7 offset:504
    ds_read_b64_tr_b16 v[58:59], v7 offset:4728
    ds_read_b64_tr_b16 v[60:61], v7 offset:536
    ds_read_b64_tr_b16 v[62:63], v7 offset:4760
    v_add_u32 v5, 64, v5
    s_add_u32 s52, s52, 33792
    s_cmp_eq_u32 s52, 159744
    s_cselect_b32 s52, 58368, s52
    v_mfma_f32_16x16x32_bf16 v[64:67], v[208:211], v[192:195], v[64:67]
    v_mfma_f32_16x16x32_bf16 v[68:71], v[208:211], v[196:199], v[68:71]
    v_mfma_f32_16x16x32_bf16 v[72:75], v[212:215], v[192:195], v[72:75]
    v_mfma_f32_16x16x32_bf16 v[76:79], v[212:215], v[196:199], v[76:79]
    v_mfma_f32_16x16x32_bf16 v[80:83], v[216:219], v[192:195], v[80:83]
    v_mfma_f32_16x16x32_bf16 v[84:87], v[216:219], v[196:199], v[84:87]
    v_mfma_f32_16x16x32_bf16 v[88:91], v[220:223], v[192:195], v[88:91]
    v_mfma_f32_16x16x32_bf16 v[92:95], v[220:223], v[196:199], v[92:95]
    v_mfma_f32_16x16x32_bf16 v[96:99], v[192:195], v[224:227], v[96:99]
    v_mfma_f32_16x16x32_bf16 v[100:103], v[196:199], v[224:227], v[100:103]
    v_mfma_f32_16x16x32_bf16 v[104:107], v[192:195], v[228:231], v[104:107]
    v_mfma_f32_16x16x32_bf16 v[108:111], v[196:199], v[228:231], v[108:111]
    v_mfma_f32_16x16x32_bf16 v[112:115], v[192:195], v[232:235], v[112:115]
    v_mfma_f32_16x16x32_bf16 v[116:119], v[196:199], v[232:235], v[116:119]
    v_mfma_f32_16x16x32_bf16 v[120:123], v[192:195], v[236:239], v[120:123]
    v_mfma_f32_16x16x32_bf16 v[124:127], v[196:199], v[236:239], v[124:127]
    s_waitcnt vmcnt(0) lgkmcnt(0)
    s_barrier
    v_add_u32 v7, s52, v6
    ds_read_b128 v[192:195], v5 offset:0
    ds_read_b128 v[196:199], v5 offset:14592
    ds_read_b64_tr_b16 v[208:209], v7 offset:0
    ds_read_b64_tr_b16 v[210:211], v7 offset:4224
    ds_read_b64_tr_b16 v[212:213], v7 offset:32
    ds_read_b64_tr_b16 v[214:215], v7 offset:4256
    ds_read_b64_tr_b16 v[216:217], v7 offset:56
    ds_read_b64_tr_b16 v[218:219], v7 offset:4280
    ds_read_b64_tr_b16 v[220:221], v7 offset:88
    ds_read_b64_tr_b16 v[222:223], v7 offset:4312
    ds_read_b64_tr_b16 v[224:225], v7 offset:448
    ds_read_b64_tr_b16 v[226:227], v7 offset:4672
    ds_read_b64_tr_b16 v[228:229], v7 offset:480
    ds_read_b64_tr_b16 v[230:231], v7 offset:4704
    ds_read_b64_tr_b16 v[232:233], v7 offset:504
    ds_read_b64_tr_b16 v[234:235], v7 offset:4728
    ds_read_b64_tr_b16 v[236:237], v7 offset:536
    ds_read_b64_tr_b16 v[238:239], v7 offset:4760
    v_add_u32 v5, 64, v5
    s_add_u32 s52, s52, 33792
    s_cmp_eq_u32 s52, 159744
    s_cselect_b32 s52, 58368, s52
    v_mfma_f32_16x16x32_bf16 v[64:67], v[32:35], v[16:19], v[64:67]
    v_mfma_f32_16x16x32_bf16 v[68:71], v[32:35], v[20:23], v[68:71]
    v_mfma_f32_16x16x32_bf16 v[72:75], v[36:39], v[16:19], v[72:75]
    v_mfma_f32_16x16x32_bf16 v[76:79], v[36:39], v[20:23], v[76:79]
    v_mfma_f32_16x16x32_bf16 v[80:83], v[40:43], v[16:19], v[80:83]
    v_mfma_f32_16x16x32_bf16 v[84:87], v[40:43], v[20:23], v[84:87]
    v_mfma_f32_16x16x32_bf16 v[88:91], v[44:47], v[16:19], v[88:91]
    v_mfma_f32_16x16x32_bf16 v[92:95], v[44:47], v[20:23], v[92:95]
    v_mfma_f32_16x16x32_bf16 v[96:99], v[16:19], v[48:51], v[96:99]
    v_mfma_f32_16x16x32_bf16 v[100:103], v[20:23], v[48:51], v[100:103]
    v_mfma_f32_16x16x32_bf16 v[104:107], v[16:19], v[52:55], v[104:107]
    v_mfma_f32_16x16x32_bf16 v[108:111], v[20:23], v[52:55], v[108:111]
    v_mfma_f32_16x16x32_bf16 v[112:115], v[16:19], v[56:59], v[112:115]
    v_mfma_f32_16x16x32_bf16 v[116:119], v[20:23], v[56:59], v[116:119]
    v_mfma_f32_16x16x32_bf16 v[120:123], v[16:19], v[60:63], v[120:123]
    v_mfma_f32_16x16x32_bf16 v[124:127], v[20:23], v[60:63], v[124:127]
    s_lshl_b32 s57, s81, 12
    s_add_u32 s57, s57, 125952
    s_add_u32 m0, s57, 0
    s_nop 0
    buffer_load_dwordx4 v8, s[20:23], s58 offen lds
    s_add_u32 s58, s58, 1024
    s_add_u32 m0, s57, 1024
    s_nop 0
    buffer_load_dwordx4 v8, s[20:23], s58 offen lds
    s_add_u32 s58, s58, 1024
    s_add_u32 m0, s57, 2048
    s_nop 0
    buffer_load_dwordx4 v8, s[20:23], s58 offen lds
    s_add_u32 s58, s58, 1024
    s_add_u32 m0, s57, 3072
    s_nop 0
    buffer_load_dwordx4 v8, s[20:23], s58 offen lds
    s_add_u32 s58, s58, 1024
    s_waitcnt lgkmcnt(0)
    v_mfma_f32_16x16x32_bf16 v[64:67], v[208:211], v[192:195], v[64:67]
    v_mfma_f32_16x16x32_bf16 v[68:71], v[208:211], v[196:199], v[68:71]
    v_mfma_f32_16x16x32_bf16 v[72:75], v[212:215], v[192:195], v[72:75]
    v_mfma_f32_16x16x32_bf16 v[76:79], v[212:215], v[196:199], v[76:79]
    v_mfma_f32_16x16x32_bf16 v[80:83], v[216:219], v[192:195], v[80:83]
    v_mfma_f32_16x16x32_bf16 v[84:87], v[216:219], v[196:199], v[84:87]
    v_mfma_f32_16x16x32_bf16 v[88:91], v[220:223], v[192:195], v[88:91]
    v_mfma_f32_16x16x32_bf16 v[92:95], v[220:223], v[196:199], v[92:95]
    v_mfma_f32_16x16x32_bf16 v[96:99], v[192:195], v[224:227], v[96:99]
    v_mfma_f32_16x16x32_bf16 v[100:103], v[196:199], v[224:227], v[100:103]
    v_mfma_f32_16x16x32_bf16 v[104:107], v[192:195], v[228:231], v[104:107]
    v_mfma_f32_16x16x32_bf16 v[108:111], v[196:199], v[228:231], v[108:111]
    v_mfma_f32_16x16x32_bf16 v[112:115], v[192:195], v[232:235], v[112:115]
    v_mfma_f32_16x16x32_bf16 v[116:119], v[196:199], v[232:235], v[116:119]
    v_mfma_f32_16x16x32_bf16 v[120:123], v[192:195], v[236:239], v[120:123]
    v_mfma_f32_16x16x32_bf16 v[124:127], v[196:199], v[236:239], v[124:127]
    s_waitcnt vmcnt(0)
    ds_read_b64_tr_b16 v[192:193], v9 offset:0
    ds_read_b64_tr_b16 v[194:195], v9 offset:896
    ds_read_b64_tr_b16 v[196:197], v9 offset:32
    ds_read_b64_tr_b16 v[198:199], v9 offset:928
    ds_read_b64_tr_b16 v[200:201], v9 offset:1568
    ds_read_b64_tr_b16 v[202:203], v9 offset:2464
    ds_read_b64_tr_b16 v[204:205], v9 offset:1600
    ds_read_b64_tr_b16 v[206:207], v9 offset:2496
    s_waitcnt lgkmcnt(0)
    v_cndmask_b32 v194, v194, 0, s[62:63]
    v_cndmask_b32 v195, v195, 0, s[62:63]
    v_cndmask_b32 v198, v198, 0, s[62:63]
    v_cndmask_b32 v199, v199, 0, s[62:63]
    v_cndmask_b32 v202, v202, 0, s[62:63]
    v_cndmask_b32 v203, v203, 0, s[62:63]
    v_cndmask_b32 v206, v206, 0, s[62:63]
    v_cndmask_b32 v207, v207, 0, s[62:63]
    s_nop 1
    s_barrier
    s_add_u32 s16, s42, 18874368
    s_addc_u32 s17, s43, 0
    s_mov_b32 s18, 4194304
    s_mov_b32 s19, 0x00020000
    s_mul_i32 s54, s48, 18432
    s_mul_i32 s55, s80, 4608
    s_add_u32 s55, s55, s54
    v_mul_u32_u24 v8, 144, v3
    v_lshl_add_u32 v8, v2, 3, v8
    v_add_u32 v8, s55, v8
    v_lshrrev_b32 v9, 2, v3
    v_lshl_add_u32 v9, v2, 2, v9
    v_mul_u32_u24 v9, 144, v9
    v_and_b32 v10, 3, v3
    v_lshl_add_u32 v9, v10, 3, v9
    s_mul_i32 s55, s80, 9216
    s_add_u32 s55, s55, s54
    v_add_u32 v9, s55, v9
    s_lshl_b32 s54, s48, 13
    s_lshl_b32 s55, s80, 10
    s_add_u32 s54, s54, s55
    s_add_u32 s54, s54, 73728
    v_lshlrev_b32 v11, 4, v1
    v_add_u32 v10, s54, v11
    v_cvt_pk_bf16_f32 v16, v96, v97
    v_cvt_pk_bf16_f32 v17, v98, v99
    v_cvt_pk_bf16_f32 v18, v100, v101
    v_cvt_pk_bf16_f32 v19, v102, v103
    ds_write_b128 v10, v[16:19] offset:0
    v_cvt_pk_bf16_f32 v20, v104, v105
    v_cvt_pk_bf16_f32 v21, v106, v107
    v_cvt_pk_bf16_f32 v22, v108, v109
    v_cvt_pk_bf16_f32 v23, v110, v111
    v_cndmask_b32 v20, v20, v14, s[60:61]
    v_cndmask_b32 v21, v21, v14, s[60:61]
    v_cndmask_b32 v22, v22, v14, s[60:61]
    v_cndmask_b32 v23, v23, v14, s[60:61]
    ds_write_b128 v10, v[20:23] offset:2048
    v_cvt_pk_bf16_f32 v24, v112, v113
    v_cvt_pk_bf16_f32 v25, v114, v115
    v_cvt_pk_bf16_f32 v26, v116, v117
    v_cvt_pk_bf16_f32 v27, v118, v119
    ds_write_b128 v10, v[24:27] offset:4096
    v_cvt_pk_bf16_f32 v28, v120, v121
    v_cvt_pk_bf16_f32 v29, v122, v123
    v_cvt_pk_bf16_f32 v30, v124, v125
    v_cvt_pk_bf16_f32 v31, v126, v127
    v_cndmask_b32 v28, v28, v14, s[60:61]
    v_cndmask_b32 v29, v29, v14, s[60:61]
    v_cndmask_b32 v30, v30, v14, s[60:61]
    v_cndmask_b32 v31, v31, v14, s[60:61]
    ds_write_b128 v10, v[28:31] offset:6144
    v_cvt_pk_bf16_f32 v16, v64, v65
    v_cvt_pk_bf16_f32 v17, v66, v67
    v_cvt_pk_bf16_f32 v18, v72, v73
    v_cvt_pk_bf16_f32 v19, v74, v75
    s_nop 1
    v_mfma_f32_16x16x32_bf16 v[20:23], v[192:195], v[16:19], 0
    v_mfma_f32_16x16x32_bf16 v[24:27], v[196:199], v[16:19], 0
    s_nop 6
    v_cvt_pk_bf16_f32 v28, v20, v21
    v_lshlrev_b32 v20, 16, v28
    v_and_b32 v21, 0xffff0000, v28
    v_cvt_pk_bf16_f32 v28, v22, v23
    v_lshlrev_b32 v22, 16, v28
    v_and_b32 v23, 0xffff0000, v28
    v_cvt_pk_bf16_f32 v28, v24, v25
    v_lshlrev_b32 v24, 16, v28
    v_and_b32 v25, 0xffff0000, v28
    v_cvt_pk_bf16_f32 v28, v26, v27
    v_lshlrev_b32 v26, 16, v28
    v_and_b32 v27, 0xffff0000, v28
    v_cndmask_b32 v32, v24, v12, s[62:63]
    v_cndmask_b32 v36, v24, v13, s[62:63]
    v_cndmask_b32 v33, v25, v12, s[62:63]
    v_cndmask_b32 v37, v25, v13, s[62:63]
    v_cndmask_b32 v34, v26, v12, s[62:63]
    v_cndmask_b32 v38, v26, v13, s[62:63]
    v_cndmask_b32 v35, v27, v12, s[62:63]
    v_cndmask_b32 v39, v27, v13, s[62:63]
    v_max3_f32 v29, v20, v21, v22
    v_min3_f32 v30, v20, v21, v22
    v_max3_f32 v29, v29, v23, v32
    v_min3_f32 v30, v30, v23, v36
    v_max3_f32 v29, v29, v33, v34
    v_min3_f32 v30, v30, v37, v38
    v_max_f32 v29, v29, v35
    v_min_f32 v30, v30, v39
    v_mov_b32 v31, v29
    s_nop 1
    v_permlane32_swap_b32 v29, v31
    v_max_f32 v29, v29, v31
    v_mov_b32 v31, v29
    s_nop 1
    v_permlane16_swap_b32 v29, v31
    v_max_f32 v29, v29, v31
    v_mov_b32 v31, v30
    s_nop 1
    v_permlane32_swap_b32 v30, v31
    v_min_f32 v30, v30, v31
    v_mov_b32 v31, v30
    s_nop 1
    v_permlane16_swap_b32 v30, v31
    v_min_f32 v30, v30, v31
    v_mul_f32 v29, s72, v29
    v_mul_f32 v30, s71, v30
    v_fma_f32 v40, v20, s71, v29
    v_fma_f32 v44, v32, s71, v29
    v_fma_f32 v48, v20, s72, v30
    v_fma_f32 v52, v36, s72, v30
    v_fma_f32 v41, v21, s71, v29
    v_fma_f32 v45, v33, s71, v29
    v_fma_f32 v49, v21, s72, v30
    v_fma_f32 v53, v37, s72, v30
    v_fma_f32 v42, v22, s71, v29
    v_fma_f32 v46, v34, s71, v29
    v_fma_f32 v50, v22, s72, v30
    v_fma_f32 v54, v38, s72, v30
    v_fma_f32 v43, v23, s71, v29
    v_fma_f32 v47, v35, s71, v29
    v_fma_f32 v51, v23, s72, v30
    v_fma_f32 v55, v39, s72, v30
    v_exp_f32 v40, v40
    v_exp_f32 v41, v41
    v_exp_f32 v42, v42
    v_exp_f32 v43, v43
    v_exp_f32 v44, v44
    v_exp_f32 v45, v45
    v_exp_f32 v46, v46
    v_exp_f32 v47, v47
    v_exp_f32 v48, v48
    v_exp_f32 v49, v49
    v_exp_f32 v50, v50
    v_exp_f32 v51, v51
    v_exp_f32 v52, v52
    v_exp_f32 v53, v53
    v_exp_f32 v54, v54
    v_exp_f32 v55, v55
    v_add_f32 v29, v40, v41
    v_add_f32 v30, v48, v49
    v_add_f32 v29, v29, v42
    v_add_f32 v30, v30, v50
    v_add_f32 v29, v29, v43
    v_add_f32 v30, v30, v51
    v_add_f32 v29, v29, v44
    v_add_f32 v30, v30, v52
    v_add_f32 v29, v29, v45
    v_add_f32 v30, v30, v53
    v_add_f32 v29, v29, v46
    v_add_f32 v30, v30, v54
    v_add_f32 v29, v29, v47
    v_add_f32 v30, v30, v55
    v_mov_b32 v31, v29
    s_nop 1
    v_permlane32_swap_b32 v29, v31
    v_add_f32 v29, v29, v31
    v_mov_b32 v31, v29
    s_nop 1
    v_permlane16_swap_b32 v29, v31
    v_add_f32 v29, v29, v31
    v_mov_b32 v31, v30
    s_nop 1
    v_permlane32_swap_b32 v30, v31
    v_add_f32 v30, v30, v31
    v_mov_b32 v31, v30
    s_nop 1
    v_permlane16_swap_b32 v30, v31
    v_add_f32 v30, v30, v31
    v_rcp_f32 v29, v29
    v_rcp_f32 v30, v30
    v_mul_f32 v40, v40, v29
    v_mul_f32 v48, v48, v30
    v_mul_f32 v41, v41, v29
    v_mul_f32 v49, v49, v30
    v_mul_f32 v42, v42, v29
    v_mul_f32 v50, v50, v30
    v_mul_f32 v43, v43, v29
    v_mul_f32 v51, v51, v30
    v_mul_f32 v44, v44, v29
    v_mul_f32 v52, v52, v30
    v_mul_f32 v45, v45, v29
    v_mul_f32 v53, v53, v30
    v_mul_f32 v46, v46, v29
    v_mul_f32 v54, v54, v30
    v_mul_f32 v47, v47, v29
    v_mul_f32 v55, v55, v30
    v_cvt_pk_bf16_f32 v56, v40, v41
    v_cvt_pk_bf16_f32 v57, v42, v43
    v_cvt_pk_bf16_f32 v58, v44, v45
    v_cvt_pk_bf16_f32 v59, v46, v47
    v_cvt_pk_bf16_f32 v60, v48, v49
    v_cvt_pk_bf16_f32 v61, v50, v51
    v_cvt_pk_bf16_f32 v62, v52, v53
    v_cvt_pk_bf16_f32 v63, v54, v55
    ds_write_b64 v8, v[56:57] offset:0
    ds_write_b64 v8, v[58:59] offset:32
    ds_write_b64 v8, v[60:61] offset:64
    ds_write_b64 v8, v[62:63] offset:96
    v_cvt_pk_bf16_f32 v16, v68, v69
    v_cvt_pk_bf16_f32 v17, v70, v71
    v_cvt_pk_bf16_f32 v18, v76, v77
    v_cvt_pk_bf16_f32 v19, v78, v79
    s_nop 1
    v_mfma_f32_16x16x32_bf16 v[20:23], v[192:195], v[16:19], 0
    v_mfma_f32_16x16x32_bf16 v[24:27], v[196:199], v[16:19], 0
    s_nop 6
    v_cvt_pk_bf16_f32 v28, v20, v21
    v_lshlrev_b32 v20, 16, v28
    v_and_b32 v21, 0xffff0000, v28
    v_cvt_pk_bf16_f32 v28, v22, v23
    v_lshlrev_b32 v22, 16, v28
    v_and_b32 v23, 0xffff0000, v28
    v_cvt_pk_bf16_f32 v28, v24, v25
    v_lshlrev_b32 v24, 16, v28
    v_and_b32 v25, 0xffff0000, v28
    v_cvt_pk_bf16_f32 v28, v26, v27
    v_lshlrev_b32 v26, 16, v28
    v_and_b32 v27, 0xffff0000, v28
    v_cndmask_b32 v32, v24, v12, s[62:63]
    v_cndmask_b32 v36, v24, v13, s[62:63]
    v_cndmask_b32 v33, v25, v12, s[62:63]
    v_cndmask_b32 v37, v25, v13, s[62:63]
    v_cndmask_b32 v34, v26, v12, s[62:63]
    v_cndmask_b32 v38, v26, v13, s[62:63]
    v_cndmask_b32 v35, v27, v12, s[62:63]
    v_cndmask_b32 v39, v27, v13, s[62:63]
    v_max3_f32 v29, v20, v21, v22
    v_min3_f32 v30, v20, v21, v22
    v_max3_f32 v29, v29, v23, v32
    v_min3_f32 v30, v30, v23, v36
    v_max3_f32 v29, v29, v33, v34
    v_min3_f32 v30, v30, v37, v38
    v_max_f32 v29, v29, v35
    v_min_f32 v30, v30, v39
    v_mov_b32 v31, v29
    s_nop 1
    v_permlane32_swap_b32 v29, v31
    v_max_f32 v29, v29, v31
    v_mov_b32 v31, v29
    s_nop 1
    v_permlane16_swap_b32 v29, v31
    v_max_f32 v29, v29, v31
    v_mov_b32 v31, v30
    s_nop 1
    v_permlane32_swap_b32 v30, v31
    v_min_f32 v30, v30, v31
    v_mov_b32 v31, v30
    s_nop 1
    v_permlane16_swap_b32 v30, v31
    v_min_f32 v30, v30, v31
    v_mul_f32 v29, s72, v29
    v_mul_f32 v30, s71, v30
    v_fma_f32 v40, v20, s71, v29
    v_fma_f32 v44, v32, s71, v29
    v_fma_f32 v48, v20, s72, v30
    v_fma_f32 v52, v36, s72, v30
    v_fma_f32 v41, v21, s71, v29
    v_fma_f32 v45, v33, s71, v29
    v_fma_f32 v49, v21, s72, v30
    v_fma_f32 v53, v37, s72, v30
    v_fma_f32 v42, v22, s71, v29
    v_fma_f32 v46, v34, s71, v29
    v_fma_f32 v50, v22, s72, v30
    v_fma_f32 v54, v38, s72, v30
    v_fma_f32 v43, v23, s71, v29
    v_fma_f32 v47, v35, s71, v29
    v_fma_f32 v51, v23, s72, v30
    v_fma_f32 v55, v39, s72, v30
    v_exp_f32 v40, v40
    v_exp_f32 v41, v41
    v_exp_f32 v42, v42
    v_exp_f32 v43, v43
    v_exp_f32 v44, v44
    v_exp_f32 v45, v45
    v_exp_f32 v46, v46
    v_exp_f32 v47, v47
    v_exp_f32 v48, v48
    v_exp_f32 v49, v49
    v_exp_f32 v50, v50
    v_exp_f32 v51, v51
    v_exp_f32 v52, v52
    v_exp_f32 v53, v53
    v_exp_f32 v54, v54
    v_exp_f32 v55, v55
    v_add_f32 v29, v40, v41
    v_add_f32 v30, v48, v49
    v_add_f32 v29, v29, v42
    v_add_f32 v30, v30, v50
    v_add_f32 v29, v29, v43
    v_add_f32 v30, v30, v51
    v_add_f32 v29, v29, v44
    v_add_f32 v30, v30, v52
    v_add_f32 v29, v29, v45
    v_add_f32 v30, v30, v53
    v_add_f32 v29, v29, v46
    v_add_f32 v30, v30, v54
    v_add_f32 v29, v29, v47
    v_add_f32 v30, v30, v55
    v_mov_b32 v31, v29
    s_nop 1
    v_permlane32_swap_b32 v29, v31
    v_add_f32 v29, v29, v31
    v_mov_b32 v31, v29
    s_nop 1
    v_permlane16_swap_b32 v29, v31
    v_add_f32 v29, v29, v31
    v_mov_b32 v31, v30
    s_nop 1
    v_permlane32_swap_b32 v30, v31
    v_add_f32 v30, v30, v31
    v_mov_b32 v31, v30
    s_nop 1
    v_permlane16_swap_b32 v30, v31
    v_add_f32 v30, v30, v31
    v_rcp_f32 v29, v29
    v_rcp_f32 v30, v30
    v_mul_f32 v40, v40, v29
    v_mul_f32 v48, v48, v30
    v_mul_f32 v41, v41, v29
    v_mul_f32 v49, v49, v30
    v_mul_f32 v42, v42, v29
    v_mul_f32 v50, v50, v30
    v_mul_f32 v43, v43, v29
    v_mul_f32 v51, v51, v30
    v_mul_f32 v44, v44, v29
    v_mul_f32 v52, v52, v30
    v_mul_f32 v45, v45, v29
    v_mul_f32 v53, v53, v30
    v_mul_f32 v46, v46, v29
    v_mul_f32 v54, v54, v30
    v_mul_f32 v47, v47, v29
    v_mul_f32 v55, v55, v30
    v_cvt_pk_bf16_f32 v56, v40, v41
    v_cvt_pk_bf16_f32 v57, v42, v43
    v_cvt_pk_bf16_f32 v58, v44, v45
    v_cvt_pk_bf16_f32 v59, v46, v47
    v_cvt_pk_bf16_f32 v60, v48, v49
    v_cvt_pk_bf16_f32 v61, v50, v51
    v_cvt_pk_bf16_f32 v62, v52, v53
    v_cvt_pk_bf16_f32 v63, v54, v55
    ds_write_b64 v8, v[56:57] offset:2304
    ds_write_b64 v8, v[58:59] offset:2336
    ds_write_b64 v8, v[60:61] offset:2368
    ds_write_b64 v8, v[62:63] offset:2400
    v_cvt_pk_bf16_f32 v16, v80, v81
    v_cvt_pk_bf16_f32 v17, v82, v83
    v_cvt_pk_bf16_f32 v18, v88, v89
    v_cvt_pk_bf16_f32 v19, v90, v91
    s_nop 1
    v_mfma_f32_16x16x32_bf16 v[20:23], v[200:203], v[16:19], 0
    v_mfma_f32_16x16x32_bf16 v[24:27], v[204:207], v[16:19], 0
    s_nop 6
    v_cvt_pk_bf16_f32 v28, v20, v21
    v_lshlrev_b32 v20, 16, v28
    v_and_b32 v21, 0xffff0000, v28
    v_cvt_pk_bf16_f32 v28, v22, v23
    v_lshlrev_b32 v22, 16, v28
    v_and_b32 v23, 0xffff0000, v28
    v_cvt_pk_bf16_f32 v28, v24, v25
    v_lshlrev_b32 v24, 16, v28
    v_and_b32 v25, 0xffff0000, v28
    v_cvt_pk_bf16_f32 v28, v26, v27
    v_lshlrev_b32 v26, 16, v28
    v_and_b32 v27, 0xffff0000, v28
    v_cndmask_b32 v32, v24, v12, s[62:63]
    v_cndmask_b32 v36, v24, v13, s[62:63]
    v_cndmask_b32 v33, v25, v12, s[62:63]
    v_cndmask_b32 v37, v25, v13, s[62:63]
    v_cndmask_b32 v34, v26, v12, s[62:63]
    v_cndmask_b32 v38, v26, v13, s[62:63]
    v_cndmask_b32 v35, v27, v12, s[62:63]
    v_cndmask_b32 v39, v27, v13, s[62:63]
    v_max3_f32 v29, v20, v21, v22
    v_min3_f32 v30, v20, v21, v22
    v_max3_f32 v29, v29, v23, v32
    v_min3_f32 v30, v30, v23, v36
    v_max3_f32 v29, v29, v33, v34
    v_min3_f32 v30, v30, v37, v38
    v_max_f32 v29, v29, v35
    v_min_f32 v30, v30, v39
    v_mov_b32 v31, v29
    s_nop 1
    v_permlane32_swap_b32 v29, v31
    v_max_f32 v29, v29, v31
    v_mov_b32 v31, v29
    s_nop 1
    v_permlane16_swap_b32 v29, v31
    v_max_f32 v29, v29, v31
    v_mov_b32 v31, v30
    s_nop 1
    v_permlane32_swap_b32 v30, v31
    v_min_f32 v30, v30, v31
    v_mov_b32 v31, v30
    s_nop 1
    v_permlane16_swap_b32 v30, v31
    v_min_f32 v30, v30, v31
    v_mul_f32 v29, s72, v29
    v_mul_f32 v30, s71, v30
    v_fma_f32 v40, v20, s71, v29
    v_fma_f32 v44, v32, s71, v29
    v_fma_f32 v48, v20, s72, v30
    v_fma_f32 v52, v36, s72, v30
    v_fma_f32 v41, v21, s71, v29
    v_fma_f32 v45, v33, s71, v29
    v_fma_f32 v49, v21, s72, v30
    v_fma_f32 v53, v37, s72, v30
    v_fma_f32 v42, v22, s71, v29
    v_fma_f32 v46, v34, s71, v29
    v_fma_f32 v50, v22, s72, v30
    v_fma_f32 v54, v38, s72, v30
    v_fma_f32 v43, v23, s71, v29
    v_fma_f32 v47, v35, s71, v29
    v_fma_f32 v51, v23, s72, v30
    v_fma_f32 v55, v39, s72, v30
    v_exp_f32 v40, v40
    v_exp_f32 v41, v41
    v_exp_f32 v42, v42
    v_exp_f32 v43, v43
    v_exp_f32 v44, v44
    v_exp_f32 v45, v45
    v_exp_f32 v46, v46
    v_exp_f32 v47, v47
    v_exp_f32 v48, v48
    v_exp_f32 v49, v49
    v_exp_f32 v50, v50
    v_exp_f32 v51, v51
    v_exp_f32 v52, v52
    v_exp_f32 v53, v53
    v_exp_f32 v54, v54
    v_exp_f32 v55, v55
    v_add_f32 v29, v40, v41
    v_add_f32 v30, v48, v49
    v_add_f32 v29, v29, v42
    v_add_f32 v30, v30, v50
    v_add_f32 v29, v29, v43
    v_add_f32 v30, v30, v51
    v_add_f32 v29, v29, v44
    v_add_f32 v30, v30, v52
    v_add_f32 v29, v29, v45
    v_add_f32 v30, v30, v53
    v_add_f32 v29, v29, v46
    v_add_f32 v30, v30, v54
    v_add_f32 v29, v29, v47
    v_add_f32 v30, v30, v55
    v_mov_b32 v31, v29
    s_nop 1
    v_permlane32_swap_b32 v29, v31
    v_add_f32 v29, v29, v31
    v_mov_b32 v31, v29
    s_nop 1
    v_permlane16_swap_b32 v29, v31
    v_add_f32 v29, v29, v31
    v_mov_b32 v31, v30
    s_nop 1
    v_permlane32_swap_b32 v30, v31
    v_add_f32 v30, v30, v31
    v_mov_b32 v31, v30
    s_nop 1
    v_permlane16_swap_b32 v30, v31
    v_add_f32 v30, v30, v31
    v_rcp_f32 v29, v29
    v_rcp_f32 v30, v30
    v_mul_f32 v40, v40, v29
    v_mul_f32 v48, v48, v30
    v_mul_f32 v41, v41, v29
    v_mul_f32 v49, v49, v30
    v_mul_f32 v42, v42, v29
    v_mul_f32 v50, v50, v30
    v_mul_f32 v43, v43, v29
    v_mul_f32 v51, v51, v30
    v_mul_f32 v44, v44, v29
    v_mul_f32 v52, v52, v30
    v_mul_f32 v45, v45, v29
    v_mul_f32 v53, v53, v30
    v_mul_f32 v46, v46, v29
    v_mul_f32 v54, v54, v30
    v_mul_f32 v47, v47, v29
    v_mul_f32 v55, v55, v30
    v_cvt_pk_bf16_f32 v56, v40, v41
    v_cvt_pk_bf16_f32 v57, v42, v43
    v_cvt_pk_bf16_f32 v58, v44, v45
    v_cvt_pk_bf16_f32 v59, v46, v47
    v_cvt_pk_bf16_f32 v60, v48, v49
    v_cvt_pk_bf16_f32 v61, v50, v51
    v_cvt_pk_bf16_f32 v62, v52, v53
    v_cvt_pk_bf16_f32 v63, v54, v55
    ds_write_b64 v8, v[56:57] offset:9216
    ds_write_b64 v8, v[58:59] offset:9248
    ds_write_b64 v8, v[60:61] offset:9280
    ds_write_b64 v8, v[62:63] offset:9312
    v_cvt_pk_bf16_f32 v16, v84, v85
    v_cvt_pk_bf16_f32 v17, v86, v87
    v_cvt_pk_bf16_f32 v18, v92, v93
    v_cvt_pk_bf16_f32 v19, v94, v95
    s_nop 1
    v_mfma_f32_16x16x32_bf16 v[20:23], v[200:203], v[16:19], 0
    v_mfma_f32_16x16x32_bf16 v[24:27], v[204:207], v[16:19], 0
    s_nop 6
    v_cvt_pk_bf16_f32 v28, v20, v21
    v_lshlrev_b32 v20, 16, v28
    v_and_b32 v21, 0xffff0000, v28
    v_cvt_pk_bf16_f32 v28, v22, v23
    v_lshlrev_b32 v22, 16, v28
    v_and_b32 v23, 0xffff0000, v28
    v_cvt_pk_bf16_f32 v28, v24, v25
    v_lshlrev_b32 v24, 16, v28
    v_and_b32 v25, 0xffff0000, v28
    v_cvt_pk_bf16_f32 v28, v26, v27
    v_lshlrev_b32 v26, 16, v28
    v_and_b32 v27, 0xffff0000, v28
    v_cndmask_b32 v32, v24, v12, s[62:63]
    v_cndmask_b32 v36, v24, v13, s[62:63]
    v_cndmask_b32 v33, v25, v12, s[62:63]
    v_cndmask_b32 v37, v25, v13, s[62:63]
    v_cndmask_b32 v34, v26, v12, s[62:63]
    v_cndmask_b32 v38, v26, v13, s[62:63]
    v_cndmask_b32 v35, v27, v12, s[62:63]
    v_cndmask_b32 v39, v27, v13, s[62:63]
    v_max3_f32 v29, v20, v21, v22
    v_min3_f32 v30, v20, v21, v22
    v_max3_f32 v29, v29, v23, v32
    v_min3_f32 v30, v30, v23, v36
    v_max3_f32 v29, v29, v33, v34
    v_min3_f32 v30, v30, v37, v38
    v_max_f32 v29, v29, v35
    v_min_f32 v30, v30, v39
    v_mov_b32 v31, v29
    s_nop 1
    v_permlane32_swap_b32 v29, v31
    v_max_f32 v29, v29, v31
    v_mov_b32 v31, v29
    s_nop 1
    v_permlane16_swap_b32 v29, v31
    v_max_f32 v29, v29, v31
    v_mov_b32 v31, v30
    s_nop 1
    v_permlane32_swap_b32 v30, v31
    v_min_f32 v30, v30, v31
    v_mov_b32 v31, v30
    s_nop 1
    v_permlane16_swap_b32 v30, v31
    v_min_f32 v30, v30, v31
    v_mul_f32 v29, s72, v29
    v_mul_f32 v30, s71, v30
    v_fma_f32 v40, v20, s71, v29
    v_fma_f32 v44, v32, s71, v29
    v_fma_f32 v48, v20, s72, v30
    v_fma_f32 v52, v36, s72, v30
    v_fma_f32 v41, v21, s71, v29
    v_fma_f32 v45, v33, s71, v29
    v_fma_f32 v49, v21, s72, v30
    v_fma_f32 v53, v37, s72, v30
    v_fma_f32 v42, v22, s71, v29
    v_fma_f32 v46, v34, s71, v29
    v_fma_f32 v50, v22, s72, v30
    v_fma_f32 v54, v38, s72, v30
    v_fma_f32 v43, v23, s71, v29
    v_fma_f32 v47, v35, s71, v29
    v_fma_f32 v51, v23, s72, v30
    v_fma_f32 v55, v39, s72, v30
    v_exp_f32 v40, v40
    v_exp_f32 v41, v41
    v_exp_f32 v42, v42
    v_exp_f32 v43, v43
    v_exp_f32 v44, v44
    v_exp_f32 v45, v45
    v_exp_f32 v46, v46
    v_exp_f32 v47, v47
    v_exp_f32 v48, v48
    v_exp_f32 v49, v49
    v_exp_f32 v50, v50
    v_exp_f32 v51, v51
    v_exp_f32 v52, v52
    v_exp_f32 v53, v53
    v_exp_f32 v54, v54
    v_exp_f32 v55, v55
    v_add_f32 v29, v40, v41
    v_add_f32 v30, v48, v49
    v_add_f32 v29, v29, v42
    v_add_f32 v30, v30, v50
    v_add_f32 v29, v29, v43
    v_add_f32 v30, v30, v51
    v_add_f32 v29, v29, v44
    v_add_f32 v30, v30, v52
    v_add_f32 v29, v29, v45
    v_add_f32 v30, v30, v53
    v_add_f32 v29, v29, v46
    v_add_f32 v30, v30, v54
    v_add_f32 v29, v29, v47
    v_add_f32 v30, v30, v55
    v_mov_b32 v31, v29
    s_nop 1
    v_permlane32_swap_b32 v29, v31
    v_add_f32 v29, v29, v31
    v_mov_b32 v31, v29
    s_nop 1
    v_permlane16_swap_b32 v29, v31
    v_add_f32 v29, v29, v31
    v_mov_b32 v31, v30
    s_nop 1
    v_permlane32_swap_b32 v30, v31
    v_add_f32 v30, v30, v31
    v_mov_b32 v31, v30
    s_nop 1
    v_permlane16_swap_b32 v30, v31
    v_add_f32 v30, v30, v31
    v_rcp_f32 v29, v29
    v_rcp_f32 v30, v30
    v_mul_f32 v40, v40, v29
    v_mul_f32 v48, v48, v30
    v_mul_f32 v41, v41, v29
    v_mul_f32 v49, v49, v30
    v_mul_f32 v42, v42, v29
    v_mul_f32 v50, v50, v30
    v_mul_f32 v43, v43, v29
    v_mul_f32 v51, v51, v30
    v_mul_f32 v44, v44, v29
    v_mul_f32 v52, v52, v30
    v_mul_f32 v45, v45, v29
    v_mul_f32 v53, v53, v30
    v_mul_f32 v46, v46, v29
    v_mul_f32 v54, v54, v30
    v_mul_f32 v47, v47, v29
    v_mul_f32 v55, v55, v30
    v_cvt_pk_bf16_f32 v56, v40, v41
    v_cvt_pk_bf16_f32 v57, v42, v43
    v_cvt_pk_bf16_f32 v58, v44, v45
    v_cvt_pk_bf16_f32 v59, v46, v47
    v_cvt_pk_bf16_f32 v60, v48, v49
    v_cvt_pk_bf16_f32 v61, v50, v51
    v_cvt_pk_bf16_f32 v62, v52, v53
    v_cvt_pk_bf16_f32 v63, v54, v55
    ds_write_b64 v8, v[56:57] offset:11520
    ds_write_b64 v8, v[58:59] offset:11552
    ds_write_b64 v8, v[60:61] offset:11584
    ds_write_b64 v8, v[62:63] offset:11616
    s_lshl_b32 s54, s46, 4
    s_lshl_b32 s55, s69, 3
    s_add_u32 s54, s54, s55
    s_lshl_b32 s55, s48, 1
    s_add_u32 s54, s54, s55
    s_add_u32 s54, s54, s80
    s_lshl_b32 s54, s54, 13
    v_add_u32 v10, s54, v11
    s_lshl_b32 s54, s48, 13
    s_lshl_b32 s55, s80, 12
    s_add_u32 s54, s54, s55
    s_add_u32 s54, s54, 73728
    v_add_u32 v11, s54, v11
    s_waitcnt lgkmcnt(0)
    s_barrier
    ds_read_b64_tr_b16 v[16:17], v9 offset:0
    ds_read_b64_tr_b16 v[18:19], v9 offset:2304
    ds_read_b64_tr_b16 v[20:21], v9 offset:4608
    ds_read_b64_tr_b16 v[22:23], v9 offset:6912
    ds_read_b64_tr_b16 v[24:25], v9 offset:32
    ds_read_b64_tr_b16 v[26:27], v9 offset:2336
    ds_read_b64_tr_b16 v[28:29], v9 offset:4640
    ds_read_b64_tr_b16 v[30:31], v9 offset:6944
    ds_read_b64_tr_b16 v[32:33], v9 offset:64
    ds_read_b64_tr_b16 v[34:35], v9 offset:2368
    ds_read_b64_tr_b16 v[36:37], v9 offset:4672
    ds_read_b64_tr_b16 v[38:39], v9 offset:6976
    ds_read_b64_tr_b16 v[40:41], v9 offset:96
    ds_read_b64_tr_b16 v[42:43], v9 offset:2400
    ds_read_b64_tr_b16 v[44:45], v9 offset:4704
    ds_read_b64_tr_b16 v[46:47], v9 offset:7008
    ds_read_b128 v[48:51], v11 offset:0
    ds_read_b128 v[52:55], v11 offset:1024
    ds_read_b128 v[56:59], v11 offset:2048
    ds_read_b128 v[60:63], v11 offset:3072
    s_waitcnt lgkmcnt(0)
    v_mfma_f32_16x16x32_bf16 v[64:67], v[16:19], v[48:51], 0
    v_mfma_f32_16x16x32_bf16 v[64:67], v[20:23], v[52:55], v[64:67]
    v_mfma_f32_16x16x32_bf16 v[68:71], v[16:19], v[56:59], 0
    v_mfma_f32_16x16x32_bf16 v[68:71], v[20:23], v[60:63], v[68:71]
    v_mfma_f32_16x16x32_bf16 v[72:75], v[24:27], v[48:51], 0
    v_mfma_f32_16x16x32_bf16 v[72:75], v[28:31], v[52:55], v[72:75]
    v_mfma_f32_16x16x32_bf16 v[76:79], v[24:27], v[56:59], 0
    v_mfma_f32_16x16x32_bf16 v[76:79], v[28:31], v[60:63], v[76:79]
    v_mfma_f32_16x16x32_bf16 v[80:83], v[32:35], v[48:51], 0
    v_mfma_f32_16x16x32_bf16 v[80:83], v[36:39], v[52:55], v[80:83]
    v_mfma_f32_16x16x32_bf16 v[84:87], v[32:35], v[56:59], 0
    v_mfma_f32_16x16x32_bf16 v[84:87], v[36:39], v[60:63], v[84:87]
    v_mfma_f32_16x16x32_bf16 v[88:91], v[40:43], v[48:51], 0
    v_mfma_f32_16x16x32_bf16 v[88:91], v[44:47], v[52:55], v[88:91]
    v_mfma_f32_16x16x32_bf16 v[92:95], v[40:43], v[56:59], 0
    v_mfma_f32_16x16x32_bf16 v[92:95], v[44:47], v[60:63], v[92:95]
    buffer_store_dwordx4 v[64:67], v10, s[16:19], 0 offen offset:0
    buffer_store_dwordx4 v[68:71], v10, s[16:19], 0 offen offset:1024
    buffer_store_dwordx4 v[72:75], v10, s[16:19], 0 offen offset:2048
    buffer_store_dwordx4 v[76:79], v10, s[16:19], 0 offen offset:3072
    s_mov_b32 s54, 4096
    buffer_store_dwordx4 v[80:83], v10, s[16:19], s54 offen offset:0
    buffer_store_dwordx4 v[84:87], v10, s[16:19], s54 offen offset:1024
    buffer_store_dwordx4 v[88:91], v10, s[16:19], s54 offen offset:2048
    buffer_store_dwordx4 v[92:95], v10, s[16:19], s54 offen offset:3072
    s_nop 1
    s_branch K1_END
K1_Z1:
    s_waitcnt vmcnt(8)
    s_barrier
    v_add_u32 v7, s52, v6
    ds_read_b128 v[16:19], v5 offset:0
    ds_read_b128 v[20:23], v5 offset:14592
    ds_read_b64_tr_b16 v[32:33], v7 offset:0
    ds_read_b64_tr_b16 v[34:35], v7 offset:4224
    ds_read_b64_tr_b16 v[36:37], v7 offset:32
    ds_read_b64_tr_b16 v[38:39], v7 offset:4256
    ds_read_b64_tr_b16 v[40:41], v7 offset:64
    ds_read_b64_tr_b16 v[42:43], v7 offset:4288
    ds_read_b64_tr_b16 v[44:45], v7 offset:96
    ds_read_b64_tr_b16 v[46:47], v7 offset:4320
    ds_read_b64_tr_b16 v[48:49], v7 offset:128
    ds_read_b64_tr_b16 v[50:51], v7 offset:4352
    ds_read_b64_tr_b16 v[52:53], v7 offset:160
    ds_read_b64_tr_b16 v[54:55], v7 offset:4384
    ds_read_b64_tr_b16 v[56:57], v7 offset:192
    ds_read_b64_tr_b16 v[58:59], v7 offset:4416
    v_add_u32 v5, 64, v5
    s_add_u32 s52, s52, 33792
    s_cmp_eq_u32 s52, 159744
    s_cselect_b32 s52, 58368, s52
    s_mov_b32 s53, 5
K1_LOOP_Z1:
    s_waitcnt vmcnt(4) lgkmcnt(0)
    s_barrier
    v_add_u32 v7, s52, v6
    ds_read_b128 v[192:195], v5 offset:0
    ds_read_b128 v[196:199], v5 offset:14592
    ds_read_b64_tr_b16 v[208:209], v7 offset:0
    ds_read_b64_tr_b16 v[210:211], v7 offset:4224
    ds_read_b64_tr_b16 v[212:213], v7 offset:32
    ds_read_b64_tr_b16 v[214:215], v7 offset:4256
    ds_read_b64_tr_b16 v[216:217], v7 offset:64
    ds_read_b64_tr_b16 v[218:219], v7 offset:4288
    ds_read_b64_tr_b16 v[220:221], v7 offset:96
    ds_read_b64_tr_b16 v[222:223], v7 offset:4320
    ds_read_b64_tr_b16 v[224:225], v7 offset:128
    ds_read_b64_tr_b16 v[226:227], v7 offset:4352
    ds_read_b64_tr_b16 v[228:229], v7 offset:160
    ds_read_b64_tr_b16 v[230:231], v7 offset:4384
    ds_read_b64_tr_b16 v[232:233], v7 offset:192
    ds_read_b64_tr_b16 v[234:235], v7 offset:4416
    v_add_u32 v5, 64, v5
    s_add_u32 s52, s52, 33792
    s_cmp_eq_u32 s52, 159744
    s_cselect_b32 s52, 58368, s52
    v_mfma_f32_16x16x32_bf16 v[64:67], v[32:35], v[16:19], v[64:67]
    v_mfma_f32_16x16x32_bf16 v[68:71], v[32:35], v[20:23], v[68:71]
    s_add_u32 s54, s51, s55
    v_mfma_f32_16x16x32_bf16 v[72:75], v[36:39], v[16:19], v[72:75]
    v_mfma_f32_16x16x32_bf16 v[76:79], v[36:39], v[20:23], v[76:79]
    s_add_u32 m0, s54, 0
    s_mov_b64 exec, s[66:67]
    buffer_load_dwordx4 v4, s[8:11], s50 offen lds
    s_mov_b64 exec, -1
    s_add_u32 s50, s50, s49
    v_mfma_f32_16x16x32_bf16 v[80:83], v[40:43], v[16:19], v[80:83]
    v_mfma_f32_16x16x32_bf16 v[84:87], v[40:43], v[20:23], v[84:87]
    s_add_u32 m0, s54, 1056
    s_mov_b64 exec, s[66:67]
    buffer_load_dwordx4 v4, s[8:11], s50 offen lds
    s_mov_b64 exec, -1
    s_add_u32 s50, s50, s49
    v_mfma_f32_16x16x32_bf16 v[88:91], v[44:47], v[16:19], v[88:91]
    v_mfma_f32_16x16x32_bf16 v[92:95], v[44:47], v[20:23], v[92:95]
    s_add_u32 m0, s54, 2112
    s_mov_b64 exec, s[66:67]
    buffer_load_dwordx4 v4, s[8:11], s50 offen lds
    s_mov_b64 exec, -1
    s_add_u32 s50, s50, s49
    v_mfma_f32_16x16x32_bf16 v[96:99], v[48:51], v[16:19], v[96:99]
    v_mfma_f32_16x16x32_bf16 v[100:103], v[48:51], v[20:23], v[100:103]
    s_add_u32 m0, s54, 3168
    s_mov_b64 exec, s[66:67]
    buffer_load_dwordx4 v4, s[8:11], s50 offen lds
    s_mov_b64 exec, -1
    s_add_u32 s50, s50, s49
    v_mfma_f32_16x16x32_bf16 v[104:107], v[52:55], v[16:19], v[104:107]
    v_mfma_f32_16x16x32_bf16 v[108:111], v[52:55], v[20:23], v[108:111]
    s_add_u32 s50, s50, s56
    s_add_u32 s51, s51, 33792
    s_cmp_eq_u32 s51, 159744
    s_cselect_b32 s51, 58368, s51
    v_mfma_f32_16x16x32_bf16 v[112:115], v[56:59], v[16:19], v[112:115]
    v_mfma_f32_16x16x32_bf16 v[116:119], v[56:59], v[20:23], v[116:119]
    s_waitcnt vmcnt(4) lgkmcnt(0)
    s_barrier
    v_add_u32 v7, s52, v6
    ds_read_b128 v[16:19], v5 offset:0
    ds_read_b128 v[20:23], v5 offset:14592
    ds_read_b64_tr_b16 v[32:33], v7 offset:0
    ds_read_b64_tr_b16 v[34:35], v7 offset:4224
    ds_read_b64_tr_b16 v[36:37], v7 offset:32
    ds_read_b64_tr_b16 v[38:39], v7 offset:4256
    ds_read_b64_tr_b16 v[40:41], v7 offset:64
    ds_read_b64_tr_b16 v[42:43], v7 offset:4288
    ds_read_b64_tr_b16 v[44:45], v7 offset:96
    ds_read_b64_tr_b16 v[46:47], v7 offset:4320
    ds_read_b64_tr_b16 v[48:49], v7 offset:128
    ds_read_b64_tr_b16 v[50:51], v7 offset:4352
    ds_read_b64_tr_b16 v[52:53], v7 offset:160
    ds_read_b64_tr_b16 v[54:55], v7 offset:4384
    ds_read_b64_tr_b16 v[56:57], v7 offset:192
    ds_read_b64_tr_b16 v[58:59], v7 offset:4416
    v_add_u32 v5, 64, v5
    s_add_u32 s52, s52, 33792
    s_cmp_eq_u32 s52, 159744
    s_cselect_b32 s52, 58368, s52
    v_mfma_f32_16x16x32_bf16 v[64:67], v[208:211], v[192:195], v[64:67]
    v_mfma_f32_16x16x32_bf16 v[68:71], v[208:211], v[196:199], v[68:71]
    s_add_u32 s54, s51, s55
    v_mfma_f32_16x16x32_bf16 v[72:75], v[212:215], v[192:195], v[72:75]
    v_mfma_f32_16x16x32_bf16 v[76:79], v[212:215], v[196:199], v[76:79]
    s_add_u32 m0, s54, 0
    s_mov_b64 exec, s[66:67]
    buffer_load_dwordx4 v4, s[8:11], s50 offen lds
    s_mov_b64 exec, -1
    s_add_u32 s50, s50, s49
    v_mfma_f32_16x16x32_bf16 v[80:83], v[216:219], v[192:195], v[80:83]
    v_mfma_f32_16x16x32_bf16 v[84:87], v[216:219], v[196:199], v[84:87]
    s_add_u32 m0, s54, 1056
    s_mov_b64 exec, s[66:67]
    buffer_load_dwordx4 v4, s[8:11], s50 offen lds
    s_mov_b64 exec, -1
    s_add_u32 s50, s50, s49
    v_mfma_f32_16x16x32_bf16 v[88:91], v[220:223], v[192:195], v[88:91]
    v_mfma_f32_16x16x32_bf16 v[92:95], v[220:223], v[196:199], v[92:95]
    s_add_u32 m0, s54, 2112
    s_mov_b64 exec, s[66:67]
    buffer_load_dwordx4 v4, s[8:11], s50 offen lds
    s_mov_b64 exec, -1
    s_add_u32 s50, s50, s49
    v_mfma_f32_16x16x32_bf16 v[96:99], v[224:227], v[192:195], v[96:99]
    v_mfma_f32_16x16x32_bf16 v[100:103], v[224:227], v[196:199], v[100:103]
    s_add_u32 m0, s54, 3168
    s_mov_b64 exec, s[66:67]
    buffer_load_dwordx4 v4, s[8:11], s50 offen lds
    s_mov_b64 exec, -1
    s_add_u32 s50, s50, s49
    v_mfma_f32_16x16x32_bf16 v[104:107], v[228:231], v[192:195], v[104:107]
    v_mfma_f32_16x16x32_bf16 v[108:111], v[228:231], v[196:199], v[108:111]
    s_add_u32 s50, s50, s56
    s_add_u32 s51, s51, 33792
    s_cmp_eq_u32 s51, 159744
    s_cselect_b32 s51, 58368, s51
    v_mfma_f32_16x16x32_bf16 v[112:115], v[232:235], v[192:195], v[112:115]
    v_mfma_f32_16x16x32_bf16 v[116:119], v[232:235], v[196:199], v[116:119]
    s_sub_u32 s53, s53, 1
    s_cmp_lg_u32 s53, 0
    s_cbranch_scc1 K1_LOOP_Z1
    s_waitcnt vmcnt(4) lgkmcnt(0)
    s_barrier
    v_add_u32 v7, s52, v6
    ds_read_b128 v[192:195], v5 offset:0
    ds_read_b128 v[196:199], v5 offset:14592
    ds_read_b64_tr_b16 v[208:209], v7 offset:0
    ds_read_b64_tr_b16 v[210:211], v7 offset:4224
    ds_read_b64_tr_b16 v[212:213], v7 offset:32
    ds_read_b64_tr_b16 v[214:215], v7 offset:4256
    ds_read_b64_tr_b16 v[216:217], v7 offset:64
    ds_read_b64_tr_b16 v[218:219], v7 offset:4288
    ds_read_b64_tr_b16 v[220:221], v7 offset:96
    ds_read_b64_tr_b16 v[222:223], v7 offset:4320
    ds_read_b64_tr_b16 v[224:225], v7 offset:128
    ds_read_b64_tr_b16 v[226:227], v7 offset:4352
    ds_read_b64_tr_b16 v[228:229], v7 offset:160
    ds_read_b64_tr_b16 v[230:231], v7 offset:4384
    ds_read_b64_tr_b16 v[232:233], v7 offset:192
    ds_read_b64_tr_b16 v[234:235], v7 offset:4416
    v_add_u32 v5, 64, v5
    s_add_u32 s52, s52, 33792
    s_cmp_eq_u32 s52, 159744
    s_cselect_b32 s52, 58368, s52
    v_mfma_f32_16x16x32_bf16 v[64:67], v[32:35], v[16:19], v[64:67]
    v_mfma_f32_16x16x32_bf16 v[68:71], v[32:35], v[20:23], v[68:71]
    s_add_u32 s54, s51, s55
    v_mfma_f32_16x16x32_bf16 v[72:75], v[36:39], v[16:19], v[72:75]
    v_mfma_f32_16x16x32_bf16 v[76:79], v[36:39], v[20:23], v[76:79]
    s_add_u32 m0, s54, 0
    s_mov_b64 exec, s[66:67]
    buffer_load_dwordx4 v4, s[8:11], s50 offen lds
    s_mov_b64 exec, -1
    s_add_u32 s50, s50, s49
    v_mfma_f32_16x16x32_bf16 v[80:83], v[40:43], v[16:19], v[80:83]
    v_mfma_f32_16x16x32_bf16 v[84:87], v[40:43], v[20:23], v[84:87]
    s_add_u32 m0, s54, 1056
    s_mov_b64 exec, s[66:67]
    buffer_load_dwordx4 v4, s[8:11], s50 offen lds
    s_mov_b64 exec, -1
    s_add_u32 s50, s50, s49
    v_mfma_f32_16x16x32_bf16 v[88:91], v[44:47], v[16:19], v[88:91]
    v_mfma_f32_16x16x32_bf16 v[92:95], v[44:47], v[20:23], v[92:95]
    s_add_u32 m0, s54, 2112
    s_mov_b64 exec, s[66:67]
    buffer_load_dwordx4 v4, s[8:11], s50 offen lds
    s_mov_b64 exec, -1
    s_add_u32 s50, s50, s49
    v_mfma_f32_16x16x32_bf16 v[96:99], v[48:51], v[16:19], v[96:99]
    v_mfma_f32_16x16x32_bf16 v[100:103], v[48:51], v[20:23], v[100:103]
    s_add_u32 m0, s54, 3168
    s_mov_b64 exec, s[66:67]
    buffer_load_dwordx4 v4, s[8:11], s50 offen lds
    s_mov_b64 exec, -1
    s_add_u32 s50, s50, s49
    v_mfma_f32_16x16x32_bf16 v[104:107], v[52:55], v[16:19], v[104:107]
    v_mfma_f32_16x16x32_bf16 v[108:111], v[52:55], v[20:23], v[108:111]
    s_add_u32 s50, s50, s56
    s_add_u32 s51, s51, 33792
    s_cmp_eq_u32 s51, 159744
    s_cselect_b32 s51, 58368, s51
    v_mfma_f32_16x16x32_bf16 v[112:115], v[56:59], v[16:19], v[112:115]
    v_mfma_f32_16x16x32_bf16 v[116:119], v[56:59], v[20:23], v[116:119]
    s_waitcnt vmcnt(4) lgkmcnt(0)
    s_barrier
    v_add_u32 v7, s52, v6
    ds_read_b128 v[16:19], v5 offset:0
    ds_read_b128 v[20:23], v5 offset:14592
    ds_read_b64_tr_b16 v[32:33], v7 offset:0
    ds_read_b64_tr_b16 v[34:35], v7 offset:4224
    ds_read_b64_tr_b16 v[36:37], v7 offset:32
    ds_read_b64_tr_b16 v[38:39], v7 offset:4256
    ds_read_b64_tr_b16 v[40:41], v7 offset:64
    ds_read_b64_tr_b16 v[42:43], v7 offset:4288
    ds_read_b64_tr_b16 v[44:45], v7 offset:96
    ds_read_b64_tr_b16 v[46:47], v7 offset:4320
    ds_read_b64_tr_b16 v[48:49], v7 offset:128
    ds_read_b64_tr_b16 v[50:51], v7 offset:4352
    ds_read_b64_tr_b16 v[52:53], v7 offset:160
    ds_read_b64_tr_b16 v[54:55], v7 offset:4384
    ds_read_b64_tr_b16 v[56:57], v7 offset:192
    ds_read_b64_tr_b16 v[58:59], v7 offset:4416
    v_add_u32 v5, 64, v5
    s_add_u32 s52, s52, 33792
    s_cmp_eq_u32 s52, 159744
    s_cselect_b32 s52, 58368, s52
    v_mfma_f32_16x16x32_bf16 v[64:67], v[208:211], v[192:195], v[64:67]
    v_mfma_f32_16x16x32_bf16 v[68:71], v[208:211], v[196:199], v[68:71]
    v_mfma_f32_16x16x32_bf16 v[72:75], v[212:215], v[192:195], v[72:75]
    v_mfma_f32_16x16x32_bf16 v[76:79], v[212:215], v[196:199], v[76:79]
    v_mfma_f32_16x16x32_bf16 v[80:83], v[216:219], v[192:195], v[80:83]
    v_mfma_f32_16x16x32_bf16 v[84:87], v[216:219], v[196:199], v[84:87]
    v_mfma_f32_16x16x32_bf16 v[88:91], v[220:223], v[192:195], v[88:91]
    v_mfma_f32_16x16x32_bf16 v[92:95], v[220:223], v[196:199], v[92:95]
    v_mfma_f32_16x16x32_bf16 v[96:99], v[224:227], v[192:195], v[96:99]
    v_mfma_f32_16x16x32_bf16 v[100:103], v[224:227], v[196:199], v[100:103]
    v_mfma_f32_16x16x32_bf16 v[104:107], v[228:231], v[192:195], v[104:107]
    v_mfma_f32_16x16x32_bf16 v[108:111], v[228:231], v[196:199], v[108:111]
    v_mfma_f32_16x16x32_bf16 v[112:115], v[232:235], v[192:195], v[112:115]
    v_mfma_f32_16x16x32_bf16 v[116:119], v[232:235], v[196:199], v[116:119]
    s_waitcnt vmcnt(0) lgkmcnt(0)
    s_barrier
    v_add_u32 v7, s52, v6
    ds_read_b128 v[192:195], v5 offset:0
    ds_read_b128 v[196:199], v5 offset:14592
    ds_read_b64_tr_b16 v[208:209], v7 offset:0
    ds_read_b64_tr_b16 v[210:211], v7 offset:4224
    ds_read_b64_tr_b16 v[212:213], v7 offset:32
    ds_read_b64_tr_b16 v[214:215], v7 offset:4256
    ds_read_b64_tr_b16 v[216:217], v7 offset:64
    ds_read_b64_tr_b16 v[218:219], v7 offset:4288
    ds_read_b64_tr_b16 v[220:221], v7 offset:96
    ds_read_b64_tr_b16 v[222:223], v7 offset:4320
    ds_read_b64_tr_b16 v[224:225], v7 offset:128
    ds_read_b64_tr_b16 v[226:227], v7 offset:4352
    ds_read_b64_tr_b16 v[228:229], v7 offset:160
    ds_read_b64_tr_b16 v[230:231], v7 offset:4384
    ds_read_b64_tr_b16 v[232:233], v7 offset:192
    ds_read_b64_tr_b16 v[234:235], v7 offset:4416
    v_add_u32 v5, 64, v5
    s_add_u32 s52, s52, 33792
    s_cmp_eq_u32 s52, 159744
    s_cselect_b32 s52, 58368, s52
    v_mfma_f32_16x16x32_bf16 v[64:67], v[32:35], v[16:19], v[64:67]
    v_mfma_f32_16x16x32_bf16 v[68:71], v[32:35], v[20:23], v[68:71]
    v_mfma_f32_16x16x32_bf16 v[72:75], v[36:39], v[16:19], v[72:75]
    v_mfma_f32_16x16x32_bf16 v[76:79], v[36:39], v[20:23], v[76:79]
    v_mfma_f32_16x16x32_bf16 v[80:83], v[40:43], v[16:19], v[80:83]
    v_mfma_f32_16x16x32_bf16 v[84:87], v[40:43], v[20:23], v[84:87]
    v_mfma_f32_16x16x32_bf16 v[88:91], v[44:47], v[16:19], v[88:91]
    v_mfma_f32_16x16x32_bf16 v[92:95], v[44:47], v[20:23], v[92:95]
    v_mfma_f32_16x16x32_bf16 v[96:99], v[48:51], v[16:19], v[96:99]
    v_mfma_f32_16x16x32_bf16 v[100:103], v[48:51], v[20:23], v[100:103]
    v_mfma_f32_16x16x32_bf16 v[104:107], v[52:55], v[16:19], v[104:107]
    v_mfma_f32_16x16x32_bf16 v[108:111], v[52:55], v[20:23], v[108:111]
    v_mfma_f32_16x16x32_bf16 v[112:115], v[56:59], v[16:19], v[112:115]
    v_mfma_f32_16x16x32_bf16 v[116:119], v[56:59], v[20:23], v[116:119]
    s_waitcnt lgkmcnt(0)
    v_mfma_f32_16x16x32_bf16 v[64:67], v[208:211], v[192:195], v[64:67]
    v_mfma_f32_16x16x32_bf16 v[68:71], v[208:211], v[196:199], v[68:71]
    v_mfma_f32_16x16x32_bf16 v[72:75], v[212:215], v[192:195], v[72:75]
    v_mfma_f32_16x16x32_bf16 v[76:79], v[212:215], v[196:199], v[76:79]
    v_mfma_f32_16x16x32_bf16 v[80:83], v[216:219], v[192:195], v[80:83]
    v_mfma_f32_16x16x32_bf16 v[84:87], v[216:219], v[196:199], v[84:87]
    v_mfma_f32_16x16x32_bf16 v[88:91], v[220:223], v[192:195], v[88:91]
    v_mfma_f32_16x16x32_bf16 v[92:95], v[220:223], v[196:199], v[92:95]
    v_mfma_f32_16x16x32_bf16 v[96:99], v[224:227], v[192:195], v[96:99]
    v_mfma_f32_16x16x32_bf16 v[100:103], v[224:227], v[196:199], v[100:103]
    v_mfma_f32_16x16x32_bf16 v[104:107], v[228:231], v[192:195], v[104:107]
    v_mfma_f32_16x16x32_bf16 v[108:111], v[228:231], v[196:199], v[108:111]
    v_mfma_f32_16x16x32_bf16 v[112:115], v[232:235], v[192:195], v[112:115]
    v_mfma_f32_16x16x32_bf16 v[116:119], v[232:235], v[196:199], v[116:119]
    s_nop 7
    s_barrier
    s_mov_b32 s8, s34
    s_mov_b32 s9, s35
    s_mov_b32 s10, 401408
    s_mov_b32 s11, 0x00020000
    s_mov_b32 s12, s38
    s_mov_b32 s13, s39
    s_mov_b32 s14, 802816
    s_mov_b32 s15, 0x00020000
    s_lshl_b32 s54, s46, 1
    s_add_u32 s54, s54, s69
    s_lshl_b32 s54, s54, 3
    s_add_u32 s54, s54, s81
    v_lshlrev_b32 v4, 1, v1
    s_add_u32 s55, s54, 0
    s_mul_i32 s56, s55, 9363
    s_lshr_b32 s56, s56, 16
    s_mul_i32 s57, s56, 7
    s_sub_u32 s57, s55, s57
    s_mul_i32 s58, s56, 8*896
    s_lshl_b32 s59, s57, 7
    s_add_u32 s58, s58, s59
    s_mul_i32 s59, s57, 64*2688
    s_add_u32 s60, s56, 0
    s_lshl_b32 s60, s60, 4
    s_add_u32 s59, s59, s60
    s_cmp_ge_u32 s55, 392
    s_cselect_b32 s58, 2130706432, s58
    s_cselect_b32 s74, 2130706432, s59
    s_add_u32 s59, s58, 3584
    buffer_load_ushort v192, v4, s[8:11], s58 offen offset:0
    buffer_load_ushort v193, v4, s[8:11], s58 offen offset:896
    buffer_load_ushort v194, v4, s[8:11], s58 offen offset:1792
    buffer_load_ushort v195, v4, s[8:11], s58 offen offset:2688
    buffer_load_ushort v196, v4, s[8:11], s59 offen offset:0
    buffer_load_ushort v197, v4, s[8:11], s59 offen offset:896
    buffer_load_ushort v198, v4, s[8:11], s59 offen offset:1792
    buffer_load_ushort v199, v4, s[8:11], s59 offen offset:2688
    s_add_u32 s55, s54, 0
    s_mul_i32 s56, s55, 9363
    s_lshr_b32 s56, s56, 16
    s_mul_i32 s57, s56, 7
    s_sub_u32 s57, s55, s57
    s_mul_i32 s58, s56, 8*896
    s_lshl_b32 s59, s57, 7
    s_add_u32 s58, s58, s59
    s_mul_i32 s59, s57, 64*2688
    s_add_u32 s60, s56, 56
    s_lshl_b32 s60, s60, 4
    s_add_u32 s59, s59, s60
    s_cmp_ge_u32 s55, 784
    s_cselect_b32 s58, 2130706432, s58
    s_cselect_b32 s75, 2130706432, s59
    s_add_u32 s59, s58, 3584
    buffer_load_ushort v200, v4, s[12:15], s58 offen offset:0
    buffer_load_ushort v201, v4, s[12:15], s58 offen offset:896
    buffer_load_ushort v202, v4, s[12:15], s58 offen offset:1792
    buffer_load_ushort v203, v4, s[12:15], s58 offen offset:2688
    buffer_load_ushort v204, v4, s[12:15], s59 offen offset:0
    buffer_load_ushort v205, v4, s[12:15], s59 offen offset:896
    buffer_load_ushort v206, v4, s[12:15], s59 offen offset:1792
    buffer_load_ushort v207, v4, s[12:15], s59 offen offset:2688
    s_add_u32 s55, s54, 512
    s_mul_i32 s56, s55, 9363
    s_lshr_b32 s56, s56, 16
    s_mul_i32 s57, s56, 7
    s_sub_u32 s57, s55, s57
    s_mul_i32 s58, s56, 8*896
    s_lshl_b32 s59, s57, 7
    s_add_u32 s58, s58, s59
    s_mul_i32 s59, s57, 64*2688
    s_add_u32 s60, s56, 56
    s_lshl_b32 s60, s60, 4
    s_add_u32 s59, s59, s60
    s_cmp_ge_u32 s55, 784
    s_cselect_b32 s58, 2130706432, s58
    s_cselect_b32 s76, 2130706432, s59
    s_add_u32 s59, s58, 3584
    buffer_load_ushort v208, v4, s[12:15], s58 offen offset:0
    buffer_load_ushort v209, v4, s[12:15], s58 offen offset:896
    buffer_load_ushort v210, v4, s[12:15], s58 offen offset:1792
    buffer_load_ushort v211, v4, s[12:15], s58 offen offset:2688
    buffer_load_ushort v212, v4, s[12:15], s59 offen offset:0
    buffer_load_ushort v213, v4, s[12:15], s59 offen offset:896
    buffer_load_ushort v214, v4, s[12:15], s59 offen offset:1792
    buffer_load_ushort v215, v4, s[12:15], s59 offen offset:2688
    s_add_u32 s16, s42, 6291456
    s_addc_u32 s17, s43, 0
    s_mov_b32 s18, 3670016
    s_mov_b32 s19, 0x00020000
    v_add_u32 v8, s82, v3
    v_mul_u32_u24 v8, 1792, v8
    s_mul_i32 s54, s69, 896
    s_mul_i32 s55, s48, 224
    s_add_u32 s54, s54, s55
    v_add_u32 v8, s54, v8
    v_lshl_add_u32 v9, v2, 3, v8
    v_and_b32 v10, 1, v2
    v_lshl_add_u32 v8, v10, 5, v8
    v_lshrrev_b32 v10, 1, v2
    v_lshl_add_u32 v8, v10, 4, v8
    v_mov_b32 v224, 0xc0135761
    v_mov_b32 v225, 0xc0135761
    v_mov_b32 v226, 0xbdd2d3e8
    v_mov_b32 v227, 0xbdd2d3e8
    v_mov_b32 v228, 1.0
    v_mov_b32 v229, 1.0
    s_mov_b32 s54, 0
    v_cvt_pk_bf16_f32 v16, v64, v65
    v_cvt_pk_bf16_f32 v18, v66, v67
    v_cvt_pk_bf16_f32 v20, v72, v73
    v_cvt_pk_bf16_f32 v22, v74, v75
    v_cvt_pk_bf16_f32 v24, v80, v81
    v_cvt_pk_bf16_f32 v26, v82, v83
    v_cvt_pk_bf16_f32 v28, v88, v89
    v_cvt_pk_bf16_f32 v30, v90, v91
    v_lshlrev_b32 v64, 16, v16
    v_and_b32 v65, 0xffff0000, v16
    v_lshlrev_b32 v66, 16, v18
    v_and_b32 v67, 0xffff0000, v18
    v_lshlrev_b32 v72, 16, v20
    v_and_b32 v73, 0xffff0000, v20
    v_lshlrev_b32 v74, 16, v22
    v_and_b32 v75, 0xffff0000, v22
    v_lshlrev_b32 v80, 16, v24
    v_and_b32 v81, 0xffff0000, v24
    v_lshlrev_b32 v82, 16, v26
    v_and_b32 v83, 0xffff0000, v26
    v_lshlrev_b32 v88, 16, v28
    v_and_b32 v89, 0xffff0000, v28
    v_lshlrev_b32 v90, 16, v30
    v_and_b32 v91, 0xffff0000, v30
    v_pk_mul_f32 v[16:17], v[64:65], v[64:65]
    v_pk_mul_f32 v[18:19], v[66:67], v[66:67]
    v_pk_mul_f32 v[20:21], v[72:73], v[72:73]
    v_pk_mul_f32 v[22:23], v[74:75], v[74:75]
    v_pk_mul_f32 v[24:25], v[80:81], v[80:81]
    v_pk_mul_f32 v[26:27], v[82:83], v[82:83]
    v_pk_mul_f32 v[28:29], v[88:89], v[88:89]
    v_pk_mul_f32 v[30:31], v[90:91], v[90:91]
    v_pk_fma_f32 v[16:17], v[16:17], v[226:227], v[224:225]
    v_pk_fma_f32 v[18:19], v[18:19], v[226:227], v[224:225]
    v_pk_fma_f32 v[20:21], v[20:21], v[226:227], v[224:225]
    v_pk_fma_f32 v[22:23], v[22:23], v[226:227], v[224:225]
    v_pk_fma_f32 v[24:25], v[24:25], v[226:227], v[224:225]
    v_pk_fma_f32 v[26:27], v[26:27], v[226:227], v[224:225]
    v_pk_fma_f32 v[28:29], v[28:29], v[226:227], v[224:225]
    v_pk_fma_f32 v[30:31], v[30:31], v[226:227], v[224:225]
    v_pk_mul_f32 v[16:17], v[16:17], v[64:65]
    v_pk_mul_f32 v[18:19], v[18:19], v[66:67]
    v_pk_mul_f32 v[20:21], v[20:21], v[72:73]
    v_pk_mul_f32 v[22:23], v[22:23], v[74:75]
    v_pk_mul_f32 v[24:25], v[24:25], v[80:81]
    v_pk_mul_f32 v[26:27], v[26:27], v[82:83]
    v_pk_mul_f32 v[28:29], v[28:29], v[88:89]
    v_pk_mul_f32 v[30:31], v[30:31], v[90:91]
    v_exp_f32 v16, v16
    v_exp_f32 v17, v17
    v_exp_f32 v18, v18
    v_exp_f32 v19, v19
    v_exp_f32 v20, v20
    v_exp_f32 v21, v21
    v_exp_f32 v22, v22
    v_exp_f32 v23, v23
    v_exp_f32 v24, v24
    v_exp_f32 v25, v25
    v_exp_f32 v26, v26
    v_exp_f32 v27, v27
    v_exp_f32 v28, v28
    v_exp_f32 v29, v29
    v_exp_f32 v30, v30
    v_exp_f32 v31, v31
    v_pk_add_f32 v[16:17], v[16:17], v[228:229]
    v_pk_add_f32 v[18:19], v[18:19], v[228:229]
    v_pk_add_f32 v[20:21], v[20:21], v[228:229]
    v_pk_add_f32 v[22:23], v[22:23], v[228:229]
    v_pk_add_f32 v[24:25], v[24:25], v[228:229]
    v_pk_add_f32 v[26:27], v[26:27], v[228:229]
    v_pk_add_f32 v[28:29], v[28:29], v[228:229]
    v_pk_add_f32 v[30:31], v[30:31], v[228:229]
    v_rcp_f32 v16, v16
    v_rcp_f32 v17, v17
    v_rcp_f32 v18, v18
    v_rcp_f32 v19, v19
    v_rcp_f32 v20, v20
    v_rcp_f32 v21, v21
    v_rcp_f32 v22, v22
    v_rcp_f32 v23, v23
    v_rcp_f32 v24, v24
    v_rcp_f32 v25, v25
    v_rcp_f32 v26, v26
    v_rcp_f32 v27, v27
    v_rcp_f32 v28, v28
    v_rcp_f32 v29, v29
    v_rcp_f32 v30, v30
    v_rcp_f32 v31, v31
    v_pk_mul_f32 v[64:65], v[64:65], v[16:17]
    v_pk_mul_f32 v[66:67], v[66:67], v[18:19]
    v_pk_mul_f32 v[72:73], v[72:73], v[20:21]
    v_pk_mul_f32 v[74:75], v[74:75], v[22:23]
    v_pk_mul_f32 v[80:81], v[80:81], v[24:25]
    v_pk_mul_f32 v[82:83], v[82:83], v[26:27]
    v_pk_mul_f32 v[88:89], v[88:89], v[28:29]
    v_pk_mul_f32 v[90:91], v[90:91], v[30:31]
    v_cvt_pk_bf16_f32 v32, v64, v65
    v_cvt_pk_bf16_f32 v33, v66, v67
    v_cvt_pk_bf16_f32 v34, v72, v73
    v_cvt_pk_bf16_f32 v35, v74, v75
    v_cvt_pk_bf16_f32 v36, v80, v81
    v_cvt_pk_bf16_f32 v37, v82, v83
    v_cvt_pk_bf16_f32 v38, v88, v89
    v_cvt_pk_bf16_f32 v39, v90, v91
    v_permlane16_swap_b32 v32, v34
    v_permlane16_swap_b32 v33, v35
    v_permlane16_swap_b32 v36, v38
    v_permlane16_swap_b32 v37, v39
    buffer_store_dwordx4 v[32:35], v8, s[16:19], s54 offen offset:0
    buffer_store_dwordx4 v[36:39], v8, s[16:19], s54 offen offset:64
    v_cvt_pk_bf16_f32 v16, v96, v97
    v_cvt_pk_bf16_f32 v18, v98, v99
    v_cvt_pk_bf16_f32 v20, v104, v105
    v_cvt_pk_bf16_f32 v22, v106, v107
    v_cvt_pk_bf16_f32 v24, v112, v113
    v_cvt_pk_bf16_f32 v26, v114, v115
    v_lshlrev_b32 v96, 16, v16
    v_and_b32 v97, 0xffff0000, v16
    v_lshlrev_b32 v98, 16, v18
    v_and_b32 v99, 0xffff0000, v18
    v_lshlrev_b32 v104, 16, v20
    v_and_b32 v105, 0xffff0000, v20
    v_lshlrev_b32 v106, 16, v22
    v_and_b32 v107, 0xffff0000, v22
    v_lshlrev_b32 v112, 16, v24
    v_and_b32 v113, 0xffff0000, v24
    v_lshlrev_b32 v114, 16, v26
    v_and_b32 v115, 0xffff0000, v26
    v_pk_mul_f32 v[16:17], v[96:97], v[96:97]
    v_pk_mul_f32 v[18:19], v[98:99], v[98:99]
    v_pk_mul_f32 v[20:21], v[104:105], v[104:105]
    v_pk_mul_f32 v[22:23], v[106:107], v[106:107]
    v_pk_mul_f32 v[24:25], v[112:113], v[112:113]
    v_pk_mul_f32 v[26:27], v[114:115], v[114:115]
    v_pk_fma_f32 v[16:17], v[16:17], v[226:227], v[224:225]
    v_pk_fma_f32 v[18:19], v[18:19], v[226:227], v[224:225]
    v_pk_fma_f32 v[20:21], v[20:21], v[226:227], v[224:225]
    v_pk_fma_f32 v[22:23], v[22:23], v[226:227], v[224:225]
    v_pk_fma_f32 v[24:25], v[24:25], v[226:227], v[224:225]
    v_pk_fma_f32 v[26:27], v[26:27], v[226:227], v[224:225]
    v_pk_mul_f32 v[16:17], v[16:17], v[96:97]
    v_pk_mul_f32 v[18:19], v[18:19], v[98:99]
    v_pk_mul_f32 v[20:21], v[20:21], v[104:105]
    v_pk_mul_f32 v[22:23], v[22:23], v[106:107]
    v_pk_mul_f32 v[24:25], v[24:25], v[112:113]
    v_pk_mul_f32 v[26:27], v[26:27], v[114:115]
    v_exp_f32 v16, v16
    v_exp_f32 v17, v17
    v_exp_f32 v18, v18
    v_exp_f32 v19, v19
    v_exp_f32 v20, v20
    v_exp_f32 v21, v21
    v_exp_f32 v22, v22
    v_exp_f32 v23, v23
    v_exp_f32 v24, v24
    v_exp_f32 v25, v25
    v_exp_f32 v26, v26
    v_exp_f32 v27, v27
    v_pk_add_f32 v[16:17], v[16:17], v[228:229]
    v_pk_add_f32 v[18:19], v[18:19], v[228:229]
    v_pk_add_f32 v[20:21], v[20:21], v[228:229]
    v_pk_add_f32 v[22:23], v[22:23], v[228:229]
    v_pk_add_f32 v[24:25], v[24:25], v[228:229]
    v_pk_add_f32 v[26:27], v[26:27], v[228:229]
    v_rcp_f32 v16, v16
    v_rcp_f32 v17, v17
    v_rcp_f32 v18, v18
    v_rcp_f32 v19, v19
    v_rcp_f32 v20, v20
    v_rcp_f32 v21, v21
    v_rcp_f32 v22, v22
    v_rcp_f32 v23, v23
    v_rcp_f32 v24, v24
    v_rcp_f32 v25, v25
    v_rcp_f32 v26, v26
    v_rcp_f32 v27, v27
    v_pk_mul_f32 v[96:97], v[96:97], v[16:17]
    v_pk_mul_f32 v[98:99], v[98:99], v[18:19]
    v_pk_mul_f32 v[104:105], v[104:105], v[20:21]
    v_pk_mul_f32 v[106:107], v[106:107], v[22:23]
    v_pk_mul_f32 v[112:113], v[112:113], v[24:25]
    v_pk_mul_f32 v[114:115], v[114:115], v[26:27]
    v_cvt_pk_bf16_f32 v32, v96, v97
    v_cvt_pk_bf16_f32 v33, v98, v99
    v_cvt_pk_bf16_f32 v34, v104, v105
    v_cvt_pk_bf16_f32 v35, v106, v107
    s_nop 0
    v_permlane16_swap_b32 v32, v34
    v_permlane16_swap_b32 v33, v35
    buffer_store_dwordx4 v[32:35], v8, s[16:19], s54 offen offset:128
    v_cvt_pk_bf16_f32 v112, v112, v113
    v_cvt_pk_bf16_f32 v113, v114, v115
    buffer_store_dwordx2 v[112:113], v9, s[16:19], s54 offen offset:192
    s_mov_b32 s54, 28672
    v_cvt_pk_bf16_f32 v16, v68, v69
    v_cvt_pk_bf16_f32 v18, v70, v71
    v_cvt_pk_bf16_f32 v20, v76, v77
    v_cvt_pk_bf16_f32 v22, v78, v79
    v_cvt_pk_bf16_f32 v24, v84, v85
    v_cvt_pk_bf16_f32 v26, v86, v87
    v_cvt_pk_bf16_f32 v28, v92, v93
    v_cvt_pk_bf16_f32 v30, v94, v95
    v_lshlrev_b32 v68, 16, v16
    v_and_b32 v69, 0xffff0000, v16
    v_lshlrev_b32 v70, 16, v18
    v_and_b32 v71, 0xffff0000, v18
    v_lshlrev_b32 v76, 16, v20
    v_and_b32 v77, 0xffff0000, v20
    v_lshlrev_b32 v78, 16, v22
    v_and_b32 v79, 0xffff0000, v22
    v_lshlrev_b32 v84, 16, v24
    v_and_b32 v85, 0xffff0000, v24
    v_lshlrev_b32 v86, 16, v26
    v_and_b32 v87, 0xffff0000, v26
    v_lshlrev_b32 v92, 16, v28
    v_and_b32 v93, 0xffff0000, v28
    v_lshlrev_b32 v94, 16, v30
    v_and_b32 v95, 0xffff0000, v30
    v_pk_mul_f32 v[16:17], v[68:69], v[68:69]
    v_pk_mul_f32 v[18:19], v[70:71], v[70:71]
    v_pk_mul_f32 v[20:21], v[76:77], v[76:77]
    v_pk_mul_f32 v[22:23], v[78:79], v[78:79]
    v_pk_mul_f32 v[24:25], v[84:85], v[84:85]
    v_pk_mul_f32 v[26:27], v[86:87], v[86:87]
    v_pk_mul_f32 v[28:29], v[92:93], v[92:93]
    v_pk_mul_f32 v[30:31], v[94:95], v[94:95]
    v_pk_fma_f32 v[16:17], v[16:17], v[226:227], v[224:225]
    v_pk_fma_f32 v[18:19], v[18:19], v[226:227], v[224:225]
    v_pk_fma_f32 v[20:21], v[20:21], v[226:227], v[224:225]
    v_pk_fma_f32 v[22:23], v[22:23], v[226:227], v[224:225]
    v_pk_fma_f32 v[24:25], v[24:25], v[226:227], v[224:225]
    v_pk_fma_f32 v[26:27], v[26:27], v[226:227], v[224:225]
    v_pk_fma_f32 v[28:29], v[28:29], v[226:227], v[224:225]
    v_pk_fma_f32 v[30:31], v[30:31], v[226:227], v[224:225]
    v_pk_mul_f32 v[16:17], v[16:17], v[68:69]
    v_pk_mul_f32 v[18:19], v[18:19], v[70:71]
    v_pk_mul_f32 v[20:21], v[20:21], v[76:77]
    v_pk_mul_f32 v[22:23], v[22:23], v[78:79]
    v_pk_mul_f32 v[24:25], v[24:25], v[84:85]
    v_pk_mul_f32 v[26:27], v[26:27], v[86:87]
    v_pk_mul_f32 v[28:29], v[28:29], v[92:93]
    v_pk_mul_f32 v[30:31], v[30:31], v[94:95]
    v_exp_f32 v16, v16
    v_exp_f32 v17, v17
    v_exp_f32 v18, v18
    v_exp_f32 v19, v19
    v_exp_f32 v20, v20
    v_exp_f32 v21, v21
    v_exp_f32 v22, v22
    v_exp_f32 v23, v23
    v_exp_f32 v24, v24
    v_exp_f32 v25, v25
    v_exp_f32 v26, v26
    v_exp_f32 v27, v27
    v_exp_f32 v28, v28
    v_exp_f32 v29, v29
    v_exp_f32 v30, v30
    v_exp_f32 v31, v31
    v_pk_add_f32 v[16:17], v[16:17], v[228:229]
    v_pk_add_f32 v[18:19], v[18:19], v[228:229]
    v_pk_add_f32 v[20:21], v[20:21], v[228:229]
    v_pk_add_f32 v[22:23], v[22:23], v[228:229]
    v_pk_add_f32 v[24:25], v[24:25], v[228:229]
    v_pk_add_f32 v[26:27], v[26:27], v[228:229]
    v_pk_add_f32 v[28:29], v[28:29], v[228:229]
    v_pk_add_f32 v[30:31], v[30:31], v[228:229]
    v_rcp_f32 v16, v16
    v_rcp_f32 v17, v17
    v_rcp_f32 v18, v18
    v_rcp_f32 v19, v19
    v_rcp_f32 v20, v20
    v_rcp_f32 v21, v21
    v_rcp_f32 v22, v22
    v_rcp_f32 v23, v23
    v_rcp_f32 v24, v24
    v_rcp_f32 v25, v25
    v_rcp_f32 v26, v26
    v_rcp_f32 v27, v27
    v_rcp_f32 v28, v28
    v_rcp_f32 v29, v29
    v_rcp_f32 v30, v30
    v_rcp_f32 v31, v31
    v_pk_mul_f32 v[68:69], v[68:69], v[16:17]
    v_pk_mul_f32 v[70:71], v[70:71], v[18:19]
    v_pk_mul_f32 v[76:77], v[76:77], v[20:21]
    v_pk_mul_f32 v[78:79], v[78:79], v[22:23]
    v_pk_mul_f32 v[84:85], v[84:85], v[24:25]
    v_pk_mul_f32 v[86:87], v[86:87], v[26:27]
    v_pk_mul_f32 v[92:93], v[92:93], v[28:29]
    v_pk_mul_f32 v[94:95], v[94:95], v[30:31]
    v_cvt_pk_bf16_f32 v32, v68, v69
    v_cvt_pk_bf16_f32 v33, v70, v71
    v_cvt_pk_bf16_f32 v34, v76, v77
    v_cvt_pk_bf16_f32 v35, v78, v79
    v_cvt_pk_bf16_f32 v36, v84, v85
    v_cvt_pk_bf16_f32 v37, v86, v87
    v_cvt_pk_bf16_f32 v38, v92, v93
    v_cvt_pk_bf16_f32 v39, v94, v95
    v_permlane16_swap_b32 v32, v34
    v_permlane16_swap_b32 v33, v35
    v_permlane16_swap_b32 v36, v38
    v_permlane16_swap_b32 v37, v39
    buffer_store_dwordx4 v[32:35], v8, s[16:19], s54 offen offset:0
    buffer_store_dwordx4 v[36:39], v8, s[16:19], s54 offen offset:64
    v_cvt_pk_bf16_f32 v16, v100, v101
    v_cvt_pk_bf16_f32 v18, v102, v103
    v_cvt_pk_bf16_f32 v20, v108, v109
    v_cvt_pk_bf16_f32 v22, v110, v111
    v_cvt_pk_bf16_f32 v24, v116, v117
    v_cvt_pk_bf16_f32 v26, v118, v119
    v_lshlrev_b32 v100, 16, v16
    v_and_b32 v101, 0xffff0000, v16
    v_lshlrev_b32 v102, 16, v18
    v_and_b32 v103, 0xffff0000, v18
    v_lshlrev_b32 v108, 16, v20
    v_and_b32 v109, 0xffff0000, v20
    v_lshlrev_b32 v110, 16, v22
    v_and_b32 v111, 0xffff0000, v22
    v_lshlrev_b32 v116, 16, v24
    v_and_b32 v117, 0xffff0000, v24
    v_lshlrev_b32 v118, 16, v26
    v_and_b32 v119, 0xffff0000, v26
    v_pk_mul_f32 v[16:17], v[100:101], v[100:101]
    v_pk_mul_f32 v[18:19], v[102:103], v[102:103]
    v_pk_mul_f32 v[20:21], v[108:109], v[108:109]
    v_pk_mul_f32 v[22:23], v[110:111], v[110:111]
    v_pk_mul_f32 v[24:25], v[116:117], v[116:117]
    v_pk_mul_f32 v[26:27], v[118:119], v[118:119]
    v_pk_fma_f32 v[16:17], v[16:17], v[226:227], v[224:225]
    v_pk_fma_f32 v[18:19], v[18:19], v[226:227], v[224:225]
    v_pk_fma_f32 v[20:21], v[20:21], v[226:227], v[224:225]
    v_pk_fma_f32 v[22:23], v[22:23], v[226:227], v[224:225]
    v_pk_fma_f32 v[24:25], v[24:25], v[226:227], v[224:225]
    v_pk_fma_f32 v[26:27], v[26:27], v[226:227], v[224:225]
    v_pk_mul_f32 v[16:17], v[16:17], v[100:101]
    v_pk_mul_f32 v[18:19], v[18:19], v[102:103]
    v_pk_mul_f32 v[20:21], v[20:21], v[108:109]
    v_pk_mul_f32 v[22:23], v[22:23], v[110:111]
    v_pk_mul_f32 v[24:25], v[24:25], v[116:117]
    v_pk_mul_f32 v[26:27], v[26:27], v[118:119]
    v_exp_f32 v16, v16
    v_exp_f32 v17, v17
    v_exp_f32 v18, v18
    v_exp_f32 v19, v19
    v_exp_f32 v20, v20
    v_exp_f32 v21, v21
    v_exp_f32 v22, v22
    v_exp_f32 v23, v23
    v_exp_f32 v24, v24
    v_exp_f32 v25, v25
    v_exp_f32 v26, v26
    v_exp_f32 v27, v27
    v_pk_add_f32 v[16:17], v[16:17], v[228:229]
    v_pk_add_f32 v[18:19], v[18:19], v[228:229]
    v_pk_add_f32 v[20:21], v[20:21], v[228:229]
    v_pk_add_f32 v[22:23], v[22:23], v[228:229]
    v_pk_add_f32 v[24:25], v[24:25], v[228:229]
    v_pk_add_f32 v[26:27], v[26:27], v[228:229]
    v_rcp_f32 v16, v16
    v_rcp_f32 v17, v17
    v_rcp_f32 v18, v18
    v_rcp_f32 v19, v19
    v_rcp_f32 v20, v20
    v_rcp_f32 v21, v21
    v_rcp_f32 v22, v22
    v_rcp_f32 v23, v23
    v_rcp_f32 v24, v24
    v_rcp_f32 v25, v25
    v_rcp_f32 v26, v26
    v_rcp_f32 v27, v27
    v_pk_mul_f32 v[100:101], v[100:101], v[16:17]
    v_pk_mul_f32 v[102:103], v[102:103], v[18:19]
    v_pk_mul_f32 v[108:109], v[108:109], v[20:21]
    v_pk_mul_f32 v[110:111], v[110:111], v[22:23]
    v_pk_mul_f32 v[116:117], v[116:117], v[24:25]
    v_pk_mul_f32 v[118:119], v[118:119], v[26:27]
    v_cvt_pk_bf16_f32 v32, v100, v101
    v_cvt_pk_bf16_f32 v33, v102, v103
    v_cvt_pk_bf16_f32 v34, v108, v109
    v_cvt_pk_bf16_f32 v35, v110, v111
    s_nop 0
    v_permlane16_swap_b32 v32, v34
    v_permlane16_swap_b32 v33, v35
    buffer_store_dwordx4 v[32:35], v8, s[16:19], s54 offen offset:128
    v_cvt_pk_bf16_f32 v116, v116, v117
    v_cvt_pk_bf16_f32 v117, v118, v119
    buffer_store_dwordx2 v[116:117], v9, s[16:19], s54 offen offset:192
    s_add_u32 s16, s42, 23068672
    s_addc_u32 s17, s43, 0
    s_mov_b32 s18, 1204224
    s_mov_b32 s19, 0x00020000
    v_mul_u32_u24 v5, 2688, v1
    s_waitcnt vmcnt(0)
    v_lshl_or_b32 v16, v193, 16, v192
    v_lshl_or_b32 v17, v195, 16, v194
    v_lshl_or_b32 v18, v197, 16, v196
    v_lshl_or_b32 v19, v199, 16, v198
    buffer_store_dwordx4 v[16:19], v5, s[16:19], s74 offen
    v_lshl_or_b32 v20, v201, 16, v200
    v_lshl_or_b32 v21, v203, 16, v202
    v_lshl_or_b32 v22, v205, 16, v204
    v_lshl_or_b32 v23, v207, 16, v206
    buffer_store_dwordx4 v[20:23], v5, s[16:19], s75 offen
    v_lshl_or_b32 v24, v209, 16, v208
    v_lshl_or_b32 v25, v211, 16, v210
    v_lshl_or_b32 v26, v213, 16, v212
    v_lshl_or_b32 v27, v215, 16, v214
    buffer_store_dwordx4 v[24:27], v5, s[16:19], s76 offen
    s_nop 1
    s_branch K1_END
K1_Z2:
    s_waitcnt vmcnt(8)
    s_barrier
    v_add_u32 v7, s52, v6
    ds_read_b128 v[16:19], v5 offset:0
    ds_read_b128 v[20:23], v5 offset:14592
    ds_read_b64_tr_b16 v[32:33], v7 offset:0
    ds_read_b64_tr_b16 v[34:35], v7 offset:4224
    ds_read_b64_tr_b16 v[36:37], v7 offset:32
    ds_read_b64_tr_b16 v[38:39], v7 offset:4256
    ds_read_b64_tr_b16 v[40:41], v7 offset:64
    ds_read_b64_tr_b16 v[42:43], v7 offset:4288
    ds_read_b64_tr_b16 v[44:45], v7 offset:96
    ds_read_b64_tr_b16 v[46:47], v7 offset:4320
    ds_read_b64_tr_b16 v[48:49], v7 offset:128
    ds_read_b64_tr_b16 v[50:51], v7 offset:4352
    ds_read_b64_tr_b16 v[52:53], v7 offset:160
    ds_read_b64_tr_b16 v[54:55], v7 offset:4384
    ds_read_b64_tr_b16 v[56:57], v7 offset:192
    ds_read_b64_tr_b16 v[58:59], v7 offset:4416
    v_add_u32 v5, 64, v5
    s_add_u32 s52, s52, 33792
    s_cmp_eq_u32 s52, 159744
    s_cselect_b32 s52, 58368, s52
    s_mov_b32 s53, 5
K1_LOOP_Z2:
    s_waitcnt vmcnt(4) lgkmcnt(0)
    s_barrier
    v_add_u32 v7, s52, v6
    ds_read_b128 v[192:195], v5 offset:0
    ds_read_b128 v[196:199], v5 offset:14592
    ds_read_b64_tr_b16 v[208:209], v7 offset:0
    ds_read_b64_tr_b16 v[210:211], v7 offset:4224
    ds_read_b64_tr_b16 v[212:213], v7 offset:32
    ds_read_b64_tr_b16 v[214:215], v7 offset:4256
    ds_read_b64_tr_b16 v[216:217], v7 offset:64
    ds_read_b64_tr_b16 v[218:219], v7 offset:4288
    ds_read_b64_tr_b16 v[220:221], v7 offset:96
    ds_read_b64_tr_b16 v[222:223], v7 offset:4320
    ds_read_b64_tr_b16 v[224:225], v7 offset:128
    ds_read_b64_tr_b16 v[226:227], v7 offset:4352
    ds_read_b64_tr_b16 v[228:229], v7 offset:160
    ds_read_b64_tr_b16 v[230:231], v7 offset:4384
    ds_read_b64_tr_b16 v[232:233], v7 offset:192
    ds_read_b64_tr_b16 v[234:235], v7 offset:4416
    v_add_u32 v5, 64, v5
    s_add_u32 s52, s52, 33792
    s_cmp_eq_u32 s52, 159744
    s_cselect_b32 s52, 58368, s52
    v_mfma_f32_16x16x32_bf16 v[64:67], v[16:19], v[32:35], v[64:67]
    v_mfma_f32_16x16x32_bf16 v[68:71], v[20:23], v[32:35], v[68:71]
    s_add_u32 s54, s51, s55
    v_mfma_f32_16x16x32_bf16 v[72:75], v[16:19], v[36:39], v[72:75]
    v_mfma_f32_16x16x32_bf16 v[76:79], v[20:23], v[36:39], v[76:79]
    s_add_u32 m0, s54, 0
    s_mov_b64 exec, s[66:67]
    buffer_load_dwordx4 v4, s[8:11], s50 offen lds
    s_mov_b64 exec, -1
    s_add_u32 s50, s50, s49
    v_mfma_f32_16x16x32_bf16 v[80:83], v[16:19], v[40:43], v[80:83]
    v_mfma_f32_16x16x32_bf16 v[84:87], v[20:23], v[40:43], v[84:87]
    s_add_u32 m0, s54, 1056
    s_mov_b64 exec, s[66:67]
    buffer_load_dwordx4 v4, s[8:11], s50 offen lds
    s_mov_b64 exec, -1
    s_add_u32 s50, s50, s49
    v_mfma_f32_16x16x32_bf16 v[88:91], v[16:19], v[44:47], v[88:91]
    v_mfma_f32_16x16x32_bf16 v[92:95], v[20:23], v[44:47], v[92:95]
    s_add_u32 m0, s54, 2112
    s_mov_b64 exec, s[66:67]
    buffer_load_dwordx4 v4, s[8:11], s50 offen lds
    s_mov_b64 exec, -1
    s_add_u32 s50, s50, s49
    v_mfma_f32_16x16x32_bf16 v[96:99], v[16:19], v[48:51], v[96:99]
    v_mfma_f32_16x16x32_bf16 v[100:103], v[20:23], v[48:51], v[100:103]
    s_add_u32 m0, s54, 3168
    s_mov_b64 exec, s[66:67]
    buffer_load_dwordx4 v4, s[8:11], s50 offen lds
    s_mov_b64 exec, -1
    s_add_u32 s50, s50, s49
    v_mfma_f32_16x16x32_bf16 v[104:107], v[16:19], v[52:55], v[104:107]
    v_mfma_f32_16x16x32_bf16 v[108:111], v[20:23], v[52:55], v[108:111]
    s_add_u32 s50, s50, s56
    s_add_u32 s51, s51, 33792
    s_cmp_eq_u32 s51, 159744
    s_cselect_b32 s51, 58368, s51
    v_mfma_f32_16x16x32_bf16 v[112:115], v[16:19], v[56:59], v[112:115]
    v_mfma_f32_16x16x32_bf16 v[116:119], v[20:23], v[56:59], v[116:119]
    s_waitcnt vmcnt(4) lgkmcnt(0)
    s_barrier
    v_add_u32 v7, s52, v6
    ds_read_b128 v[16:19], v5 offset:0
    ds_read_b128 v[20:23], v5 offset:14592
    ds_read_b64_tr_b16 v[32:33], v7 offset:0
    ds_read_b64_tr_b16 v[34:35], v7 offset:4224
    ds_read_b64_tr_b16 v[36:37], v7 offset:32
    ds_read_b64_tr_b16 v[38:39], v7 offset:4256
    ds_read_b64_tr_b16 v[40:41], v7 offset:64
    ds_read_b64_tr_b16 v[42:43], v7 offset:4288
    ds_read_b64_tr_b16 v[44:45], v7 offset:96
    ds_read_b64_tr_b16 v[46:47], v7 offset:4320
    ds_read_b64_tr_b16 v[48:49], v7 offset:128
    ds_read_b64_tr_b16 v[50:51], v7 offset:4352
    ds_read_b64_tr_b16 v[52:53], v7 offset:160
    ds_read_b64_tr_b16 v[54:55], v7 offset:4384
    ds_read_b64_tr_b16 v[56:57], v7 offset:192
    ds_read_b64_tr_b16 v[58:59], v7 offset:4416
    v_add_u32 v5, 64, v5
    s_add_u32 s52, s52, 33792
    s_cmp_eq_u32 s52, 159744
    s_cselect_b32 s52, 58368, s52
    v_mfma_f32_16x16x32_bf16 v[64:67], v[192:195], v[208:211], v[64:67]
    v_mfma_f32_16x16x32_bf16 v[68:71], v[196:199], v[208:211], v[68:71]
    s_add_u32 s54, s51, s55
    v_mfma_f32_16x16x32_bf16 v[72:75], v[192:195], v[212:215], v[72:75]
    v_mfma_f32_16x16x32_bf16 v[76:79], v[196:199], v[212:215], v[76:79]
    s_add_u32 m0, s54, 0
    s_mov_b64 exec, s[66:67]
    buffer_load_dwordx4 v4, s[8:11], s50 offen lds
    s_mov_b64 exec, -1
    s_add_u32 s50, s50, s49
    v_mfma_f32_16x16x32_bf16 v[80:83], v[192:195], v[216:219], v[80:83]
    v_mfma_f32_16x16x32_bf16 v[84:87], v[196:199], v[216:219], v[84:87]
    s_add_u32 m0, s54, 1056
    s_mov_b64 exec, s[66:67]
    buffer_load_dwordx4 v4, s[8:11], s50 offen lds
    s_mov_b64 exec, -1
    s_add_u32 s50, s50, s49
    v_mfma_f32_16x16x32_bf16 v[88:91], v[192:195], v[220:223], v[88:91]
    v_mfma_f32_16x16x32_bf16 v[92:95], v[196:199], v[220:223], v[92:95]
    s_add_u32 m0, s54, 2112
    s_mov_b64 exec, s[66:67]
    buffer_load_dwordx4 v4, s[8:11], s50 offen lds
    s_mov_b64 exec, -1
    s_add_u32 s50, s50, s49
    v_mfma_f32_16x16x32_bf16 v[96:99], v[192:195], v[224:227], v[96:99]
    v_mfma_f32_16x16x32_bf16 v[100:103], v[196:199], v[224:227], v[100:103]
    s_add_u32 m0, s54, 3168
    s_mov_b64 exec, s[66:67]
    buffer_load_dwordx4 v4, s[8:11], s50 offen lds
    s_mov_b64 exec, -1
    s_add_u32 s50, s50, s49
    v_mfma_f32_16x16x32_bf16 v[104:107], v[192:195], v[228:231], v[104:107]
    v_mfma_f32_16x16x32_bf16 v[108:111], v[196:199], v[228:231], v[108:111]
    s_add_u32 s50, s50, s56
    s_add_u32 s51, s51, 33792
    s_cmp_eq_u32 s51, 159744
    s_cselect_b32 s51, 58368, s51
    v_mfma_f32_16x16x32_bf16 v[112:115], v[192:195], v[232:235], v[112:115]
    v_mfma_f32_16x16x32_bf16 v[116:119], v[196:199], v[232:235], v[116:119]
    s_sub_u32 s53, s53, 1
    s_cmp_lg_u32 s53, 0
    s_cbranch_scc1 K1_LOOP_Z2
    s_waitcnt vmcnt(4) lgkmcnt(0)
    s_barrier
    v_add_u32 v7, s52, v6
    ds_read_b128 v[192:195], v5 offset:0
    ds_read_b128 v[196:199], v5 offset:14592
    ds_read_b64_tr_b16 v[208:209], v7 offset:0
    ds_read_b64_tr_b16 v[210:211], v7 offset:4224
    ds_read_b64_tr_b16 v[212:213], v7 offset:32
    ds_read_b64_tr_b16 v[214:215], v7 offset:4256
    ds_read_b64_tr_b16 v[216:217], v7 offset:64
    ds_read_b64_tr_b16 v[218:219], v7 offset:4288
    ds_read_b64_tr_b16 v[220:221], v7 offset:96
    ds_read_b64_tr_b16 v[222:223], v7 offset:4320
    ds_read_b64_tr_b16 v[224:225], v7 offset:128
    ds_read_b64_tr_b16 v[226:227], v7 offset:4352
    ds_read_b64_tr_b16 v[228:229], v7 offset:160
    ds_read_b64_tr_b16 v[230:231], v7 offset:4384
    ds_read_b64_tr_b16 v[232:233], v7 offset:192
    ds_read_b64_tr_b16 v[234:235], v7 offset:4416
    v_add_u32 v5, 64, v5
    s_add_u32 s52, s52, 33792
    s_cmp_eq_u32 s52, 159744
    s_cselect_b32 s52, 58368, s52
    v_mfma_f32_16x16x32_bf16 v[64:67], v[16:19], v[32:35], v[64:67]
    v_mfma_f32_16x16x32_bf16 v[68:71], v[20:23], v[32:35], v[68:71]
    s_add_u32 s54, s51, s55
    v_mfma_f32_16x16x32_bf16 v[72:75], v[16:19], v[36:39], v[72:75]
    v_mfma_f32_16x16x32_bf16 v[76:79], v[20:23], v[36:39], v[76:79]
    s_add_u32 m0, s54, 0
    s_mov_b64 exec, s[66:67]
    buffer_load_dwordx4 v4, s[8:11], s50 offen lds
    s_mov_b64 exec, -1
    s_add_u32 s50, s50, s49
    v_mfma_f32_16x16x32_bf16 v[80:83], v[16:19], v[40:43], v[80:83]
    v_mfma_f32_16x16x32_bf16 v[84:87], v[20:23], v[40:43], v[84:87]
    s_add_u32 m0, s54, 1056
    s_mov_b64 exec, s[66:67]
    buffer_load_dwordx4 v4, s[8:11], s50 offen lds
    s_mov_b64 exec, -1
    s_add_u32 s50, s50, s49
    v_mfma_f32_16x16x32_bf16 v[88:91], v[16:19], v[44:47], v[88:91]
    v_mfma_f32_16x16x32_bf16 v[92:95], v[20:23], v[44:47], v[92:95]
    s_add_u32 m0, s54, 2112
    s_mov_b64 exec, s[66:67]
    buffer_load_dwordx4 v4, s[8:11], s50 offen lds
    s_mov_b64 exec, -1
    s_add_u32 s50, s50, s49
    v_mfma_f32_16x16x32_bf16 v[96:99], v[16:19], v[48:51], v[96:99]
    v_mfma_f32_16x16x32_bf16 v[100:103], v[20:23], v[48:51], v[100:103]
    s_add_u32 m0, s54, 3168
    s_mov_b64 exec, s[66:67]
    buffer_load_dwordx4 v4, s[8:11], s50 offen lds
    s_mov_b64 exec, -1
    s_add_u32 s50, s50, s49
    v_mfma_f32_16x16x32_bf16 v[104:107], v[16:19], v[52:55], v[104:107]
    v_mfma_f32_16x16x32_bf16 v[108:111], v[20:23], v[52:55], v[108:111]
    s_add_u32 s50, s50, s56
    s_add_u32 s51, s51, 33792
    s_cmp_eq_u32 s51, 159744
    s_cselect_b32 s51, 58368, s51
    v_mfma_f32_16x16x32_bf16 v[112:115], v[16:19], v[56:59], v[112:115]
    v_mfma_f32_16x16x32_bf16 v[116:119], v[20:23], v[56:59], v[116:119]
    s_waitcnt vmcnt(4) lgkmcnt(0)
    s_barrier
    v_add_u32 v7, s52, v6
    ds_read_b128 v[16:19], v5 offset:0
    ds_read_b128 v[20:23], v5 offset:14592
    ds_read_b64_tr_b16 v[32:33], v7 offset:0
    ds_read_b64_tr_b16 v[34:35], v7 offset:4224
    ds_read_b64_tr_b16 v[36:37], v7 offset:32
    ds_read_b64_tr_b16 v[38:39], v7 offset:4256
    ds_read_b64_tr_b16 v[40:41], v7 offset:64
    ds_read_b64_tr_b16 v[42:43], v7 offset:4288
    ds_read_b64_tr_b16 v[44:45], v7 offset:96
    ds_read_b64_tr_b16 v[46:47], v7 offset:4320
    ds_read_b64_tr_b16 v[48:49], v7 offset:128
    ds_read_b64_tr_b16 v[50:51], v7 offset:4352
    ds_read_b64_tr_b16 v[52:53], v7 offset:160
    ds_read_b64_tr_b16 v[54:55], v7 offset:4384
    ds_read_b64_tr_b16 v[56:57], v7 offset:192
    ds_read_b64_tr_b16 v[58:59], v7 offset:4416
    v_add_u32 v5, 64, v5
    s_add_u32 s52, s52, 33792
    s_cmp_eq_u32 s52, 159744
    s_cselect_b32 s52, 58368, s52
    v_mfma_f32_16x16x32_bf16 v[64:67], v[192:195], v[208:211], v[64:67]
    v_mfma_f32_16x16x32_bf16 v[68:71], v[196:199], v[208:211], v[68:71]
    v_mfma_f32_16x16x32_bf16 v[72:75], v[192:195], v[212:215], v[72:75]
    v_mfma_f32_16x16x32_bf16 v[76:79], v[196:199], v[212:215], v[76:79]
    v_mfma_f32_16x16x32_bf16 v[80:83], v[192:195], v[216:219], v[80:83]
    v_mfma_f32_16x16x32_bf16 v[84:87], v[196:199], v[216:219], v[84:87]
    v_mfma_f32_16x16x32_bf16 v[88:91], v[192:195], v[220:223], v[88:91]
    v_mfma_f32_16x16x32_bf16 v[92:95], v[196:199], v[220:223], v[92:95]
    v_mfma_f32_16x16x32_bf16 v[96:99], v[192:195], v[224:227], v[96:99]
    v_mfma_f32_16x16x32_bf16 v[100:103], v[196:199], v[224:227], v[100:103]
    v_mfma_f32_16x16x32_bf16 v[104:107], v[192:195], v[228:231], v[104:107]
    v_mfma_f32_16x16x32_bf16 v[108:111], v[196:199], v[228:231], v[108:111]
    v_mfma_f32_16x16x32_bf16 v[112:115], v[192:195], v[232:235], v[112:115]
    v_mfma_f32_16x16x32_bf16 v[116:119], v[196:199], v[232:235], v[116:119]
    s_waitcnt vmcnt(0) lgkmcnt(0)
    s_barrier
    v_add_u32 v7, s52, v6
    ds_read_b128 v[192:195], v5 offset:0
    ds_read_b128 v[196:199], v5 offset:14592
    ds_read_b64_tr_b16 v[208:209], v7 offset:0
    ds_read_b64_tr_b16 v[210:211], v7 offset:4224
    ds_read_b64_tr_b16 v[212:213], v7 offset:32
    ds_read_b64_tr_b16 v[214:215], v7 offset:4256
    ds_read_b64_tr_b16 v[216:217], v7 offset:64
    ds_read_b64_tr_b16 v[218:219], v7 offset:4288
    ds_read_b64_tr_b16 v[220:221], v7 offset:96
    ds_read_b64_tr_b16 v[222:223], v7 offset:4320
    ds_read_b64_tr_b16 v[224:225], v7 offset:128
    ds_read_b64_tr_b16 v[226:227], v7 offset:4352
    ds_read_b64_tr_b16 v[228:229], v7 offset:160
    ds_read_b64_tr_b16 v[230:231], v7 offset:4384
    ds_read_b64_tr_b16 v[232:233], v7 offset:192
    ds_read_b64_tr_b16 v[234:235], v7 offset:4416
    v_add_u32 v5, 64, v5
    s_add_u32 s52, s52, 33792
    s_cmp_eq_u32 s52, 159744
    s_cselect_b32 s52, 58368, s52
    v_mfma_f32_16x16x32_bf16 v[64:67], v[16:19], v[32:35], v[64:67]
    v_mfma_f32_16x16x32_bf16 v[68:71], v[20:23], v[32:35], v[68:71]
    v_mfma_f32_16x16x32_bf16 v[72:75], v[16:19], v[36:39], v[72:75]
    v_mfma_f32_16x16x32_bf16 v[76:79], v[20:23], v[36:39], v[76:79]
    v_mfma_f32_16x16x32_bf16 v[80:83], v[16:19], v[40:43], v[80:83]
    v_mfma_f32_16x16x32_bf16 v[84:87], v[20:23], v[40:43], v[84:87]
    v_mfma_f32_16x16x32_bf16 v[88:91], v[16:19], v[44:47], v[88:91]
    v_mfma_f32_16x16x32_bf16 v[92:95], v[20:23], v[44:47], v[92:95]
    v_mfma_f32_16x16x32_bf16 v[96:99], v[16:19], v[48:51], v[96:99]
    v_mfma_f32_16x16x32_bf16 v[100:103], v[20:23], v[48:51], v[100:103]
    v_mfma_f32_16x16x32_bf16 v[104:107], v[16:19], v[52:55], v[104:107]
    v_mfma_f32_16x16x32_bf16 v[108:111], v[20:23], v[52:55], v[108:111]
    v_mfma_f32_16x16x32_bf16 v[112:115], v[16:19], v[56:59], v[112:115]
    v_mfma_f32_16x16x32_bf16 v[116:119], v[20:23], v[56:59], v[116:119]
    s_waitcnt lgkmcnt(0)
    v_mfma_f32_16x16x32_bf16 v[64:67], v[192:195], v[208:211], v[64:67]
    v_mfma_f32_16x16x32_bf16 v[68:71], v[196:199], v[208:211], v[68:71]
    v_mfma_f32_16x16x32_bf16 v[72:75], v[192:195], v[212:215], v[72:75]
    v_mfma_f32_16x16x32_bf16 v[76:79], v[196:199], v[212:215], v[76:79]
    v_mfma_f32_16x16x32_bf16 v[80:83], v[192:195], v[216:219], v[80:83]
    v_mfma_f32_16x16x32_bf16 v[84:87], v[196:199], v[216:219], v[84:87]
    v_mfma_f32_16x16x32_bf16 v[88:91], v[192:195], v[220:223], v[88:91]
    v_mfma_f32_16x16x32_bf16 v[92:95], v[196:199], v[220:223], v[92:95]
    v_mfma_f32_16x16x32_bf16 v[96:99], v[192:195], v[224:227], v[96:99]
    v_mfma_f32_16x16x32_bf16 v[100:103], v[196:199], v[224:227], v[100:103]
    v_mfma_f32_16x16x32_bf16 v[104:107], v[192:195], v[228:231], v[104:107]
    v_mfma_f32_16x16x32_bf16 v[108:111], v[196:199], v[228:231], v[108:111]
    v_mfma_f32_16x16x32_bf16 v[112:115], v[192:195], v[232:235], v[112:115]
    v_mfma_f32_16x16x32_bf16 v[116:119], v[196:199], v[232:235], v[116:119]
    s_nop 7
    s_barrier
    s_add_u32 s16, s42, 10485760
    s_addc_u32 s17, s43, 0
    s_mov_b32 s18, 3670016
    s_mov_b32 s19, 0x00020000
    v_mov_b32 v224, 0xc0135761
    v_mov_b32 v225, 0xc0135761
    v_mov_b32 v226, 0xbdd2d3e8
    v_mov_b32 v227, 0xbdd2d3e8
    v_mov_b32 v228, 1.0
    v_mov_b32 v229, 1.0
    v_mov_b32 v32, 0
    v_mov_b32 v33, 0
    v_mov_b32 v34, 0
    v_mov_b32 v35, 0
    v_mov_b32 v36, 0
    v_mov_b32 v37, 0
    v_mov_b32 v38, 0
    v_mov_b32 v39, 0
    v_mov_b32 v40, 0
    v_mov_b32 v41, 0
    v_mov_b32 v42, 0
    v_mov_b32 v43, 0
    v_mov_b32 v44, 0
    v_mov_b32 v45, 0
    v_mov_b32 v46, 0
    v_mov_b32 v47, 0
    v_cvt_pk_bf16_f32 v16, v64, v65
    v_cvt_pk_bf16_f32 v18, v66, v67
    v_cvt_pk_bf16_f32 v20, v68, v69
    v_cvt_pk_bf16_f32 v22, v70, v71
    v_cvt_pk_bf16_f32 v24, v72, v73
    v_cvt_pk_bf16_f32 v26, v74, v75
    v_cvt_pk_bf16_f32 v28, v76, v77
    v_cvt_pk_bf16_f32 v30, v78, v79
    v_lshlrev_b32 v64, 16, v16
    v_and_b32 v65, 0xffff0000, v16
    v_lshlrev_b32 v66, 16, v18
    v_and_b32 v67, 0xffff0000, v18
    v_lshlrev_b32 v68, 16, v20
    v_and_b32 v69, 0xffff0000, v20
    v_lshlrev_b32 v70, 16, v22
    v_and_b32 v71, 0xffff0000, v22
    v_lshlrev_b32 v72, 16, v24
    v_and_b32 v73, 0xffff0000, v24
    v_lshlrev_b32 v74, 16, v26
    v_and_b32 v75, 0xffff0000, v26
    v_lshlrev_b32 v76, 16, v28
    v_and_b32 v77, 0xffff0000, v28
    v_lshlrev_b32 v78, 16, v30
    v_and_b32 v79, 0xffff0000, v30
    v_pk_mul_f32 v[16:17], v[64:65], v[64:65]
    v_pk_mul_f32 v[18:19], v[66:67], v[66:67]
    v_pk_mul_f32 v[20:21], v[68:69], v[68:69]
    v_pk_mul_f32 v[22:23], v[70:71], v[70:71]
    v_pk_mul_f32 v[24:25], v[72:73], v[72:73]
    v_pk_mul_f32 v[26:27], v[74:75], v[74:75]
    v_pk_mul_f32 v[28:29], v[76:77], v[76:77]
    v_pk_mul_f32 v[30:31], v[78:79], v[78:79]
    v_pk_fma_f32 v[16:17], v[16:17], v[226:227], v[224:225]
    v_pk_fma_f32 v[18:19], v[18:19], v[226:227], v[224:225]
    v_pk_fma_f32 v[20:21], v[20:21], v[226:227], v[224:225]
    v_pk_fma_f32 v[22:23], v[22:23], v[226:227], v[224:225]
    v_pk_fma_f32 v[24:25], v[24:25], v[226:227], v[224:225]
    v_pk_fma_f32 v[26:27], v[26:27], v[226:227], v[224:225]
    v_pk_fma_f32 v[28:29], v[28:29], v[226:227], v[224:225]
    v_pk_fma_f32 v[30:31], v[30:31], v[226:227], v[224:225]
    v_pk_mul_f32 v[16:17], v[16:17], v[64:65]
    v_pk_mul_f32 v[18:19], v[18:19], v[66:67]
    v_pk_mul_f32 v[20:21], v[20:21], v[68:69]
    v_pk_mul_f32 v[22:23], v[22:23], v[70:71]
    v_pk_mul_f32 v[24:25], v[24:25], v[72:73]
    v_pk_mul_f32 v[26:27], v[26:27], v[74:75]
    v_pk_mul_f32 v[28:29], v[28:29], v[76:77]
    v_pk_mul_f32 v[30:31], v[30:31], v[78:79]
    v_exp_f32 v16, v16
    v_exp_f32 v17, v17
    v_exp_f32 v18, v18
    v_exp_f32 v19, v19
    v_exp_f32 v20, v20
    v_exp_f32 v21, v21
    v_exp_f32 v22, v22
    v_exp_f32 v23, v23
    v_exp_f32 v24, v24
    v_exp_f32 v25, v25
    v_exp_f32 v26, v26
    v_exp_f32 v27, v27
    v_exp_f32 v28, v28
    v_exp_f32 v29, v29
    v_exp_f32 v30, v30
    v_exp_f32 v31, v31
    v_pk_add_f32 v[16:17], v[16:17], v[228:229]
    v_pk_add_f32 v[18:19], v[18:19], v[228:229]
    v_pk_add_f32 v[20:21], v[20:21], v[228:229]
    v_pk_add_f32 v[22:23], v[22:23], v[228:229]
    v_pk_add_f32 v[24:25], v[24:25], v[228:229]
    v_pk_add_f32 v[26:27], v[26:27], v[228:229]
    v_pk_add_f32 v[28:29], v[28:29], v[228:229]
    v_pk_add_f32 v[30:31], v[30:31], v[228:229]
    v_rcp_f32 v16, v16
    v_rcp_f32 v17, v17
    v_rcp_f32 v18, v18
    v_rcp_f32 v19, v19
    v_rcp_f32 v20, v20
    v_rcp_f32 v21, v21
    v_rcp_f32 v22, v22
    v_rcp_f32 v23, v23
    v_rcp_f32 v24, v24
    v_rcp_f32 v25, v25
    v_rcp_f32 v26, v26
    v_rcp_f32 v27, v27
    v_rcp_f32 v28, v28
    v_rcp_f32 v29, v29
    v_rcp_f32 v30, v30
    v_rcp_f32 v31, v31
    v_pk_mul_f32 v[64:65], v[64:65], v[16:17]
    v_pk_mul_f32 v[66:67], v[66:67], v[18:19]
    v_pk_mul_f32 v[68:69], v[68:69], v[20:21]
    v_pk_mul_f32 v[70:71], v[70:71], v[22:23]
    v_pk_mul_f32 v[72:73], v[72:73], v[24:25]
    v_pk_mul_f32 v[74:75], v[74:75], v[26:27]
    v_pk_mul_f32 v[76:77], v[76:77], v[28:29]
    v_pk_mul_f32 v[78:79], v[78:79], v[30:31]
    v_cvt_pk_bf16_f32 v16, v64, v65
    v_cvt_pk_bf16_f32 v17, v66, v67
    v_cvt_pk_bf16_f32 v18, v68, v69
    v_cvt_pk_bf16_f32 v19, v70, v71
    v_cvt_pk_bf16_f32 v20, v72, v73
    v_cvt_pk_bf16_f32 v21, v74, v75
    v_cvt_pk_bf16_f32 v22, v76, v77
    v_cvt_pk_bf16_f32 v23, v78, v79
    v_lshlrev_b32 v64, 16, v16
    v_and_b32 v65, 0xffff0000, v16
    v_lshlrev_b32 v66, 16, v17
    v_and_b32 v67, 0xffff0000, v17
    v_lshlrev_b32 v68, 16, v18
    v_and_b32 v69, 0xffff0000, v18
    v_lshlrev_b32 v70, 16, v19
    v_and_b32 v71, 0xffff0000, v19
    v_lshlrev_b32 v72, 16, v20
    v_and_b32 v73, 0xffff0000, v20
    v_lshlrev_b32 v74, 16, v21
    v_and_b32 v75, 0xffff0000, v21
    v_lshlrev_b32 v76, 16, v22
    v_and_b32 v77, 0xffff0000, v22
    v_lshlrev_b32 v78, 16, v23
    v_and_b32 v79, 0xffff0000, v23
    v_add_f32 v32, v32, v64
    v_fma_f32 v36, v64, v64, v36
    v_add_f32 v33, v33, v65
    v_fma_f32 v37, v65, v65, v37
    v_add_f32 v34, v34, v66
    v_fma_f32 v38, v66, v66, v38
    v_add_f32 v35, v35, v67
    v_fma_f32 v39, v67, v67, v39
    v_add_f32 v40, v40, v68
    v_fma_f32 v44, v68, v68, v44
    v_add_f32 v41, v41, v69
    v_fma_f32 v45, v69, v69, v45
    v_add_f32 v42, v42, v70
    v_fma_f32 v46, v70, v70, v46
    v_add_f32 v43, v43, v71
    v_fma_f32 v47, v71, v71, v47
    v_add_f32 v32, v32, v72
    v_fma_f32 v36, v72, v72, v36
    v_add_f32 v33, v33, v73
    v_fma_f32 v37, v73, v73, v37
    v_add_f32 v34, v34, v74
    v_fma_f32 v38, v74, v74, v38
    v_add_f32 v35, v35, v75
    v_fma_f32 v39, v75, v75, v39
    v_add_f32 v40, v40, v76
    v_fma_f32 v44, v76, v76, v44
    v_add_f32 v41, v41, v77
    v_fma_f32 v45, v77, v77, v45
    v_add_f32 v42, v42, v78
    v_fma_f32 v46, v78, v78, v46
    v_add_f32 v43, v43, v79
    v_fma_f32 v47, v79, v79, v47
    v_cvt_pk_bf16_f32 v16, v80, v81
    v_cvt_pk_bf16_f32 v18, v82, v83
    v_cvt_pk_bf16_f32 v20, v84, v85
    v_cvt_pk_bf16_f32 v22, v86, v87
    v_cvt_pk_bf16_f32 v24, v88, v89
    v_cvt_pk_bf16_f32 v26, v90, v91
    v_cvt_pk_bf16_f32 v28, v92, v93
    v_cvt_pk_bf16_f32 v30, v94, v95
    v_lshlrev_b32 v80, 16, v16
    v_and_b32 v81, 0xffff0000, v16
    v_lshlrev_b32 v82, 16, v18
    v_and_b32 v83, 0xffff0000, v18
    v_lshlrev_b32 v84, 16, v20
    v_and_b32 v85, 0xffff0000, v20
    v_lshlrev_b32 v86, 16, v22
    v_and_b32 v87, 0xffff0000, v22
    v_lshlrev_b32 v88, 16, v24
    v_and_b32 v89, 0xffff0000, v24
    v_lshlrev_b32 v90, 16, v26
    v_and_b32 v91, 0xffff0000, v26
    v_lshlrev_b32 v92, 16, v28
    v_and_b32 v93, 0xffff0000, v28
    v_lshlrev_b32 v94, 16, v30
    v_and_b32 v95, 0xffff0000, v30
    v_pk_mul_f32 v[16:17], v[80:81], v[80:81]
    v_pk_mul_f32 v[18:19], v[82:83], v[82:83]
    v_pk_mul_f32 v[20:21], v[84:85], v[84:85]
    v_pk_mul_f32 v[22:23], v[86:87], v[86:87]
    v_pk_mul_f32 v[24:25], v[88:89], v[88:89]
    v_pk_mul_f32 v[26:27], v[90:91], v[90:91]
    v_pk_mul_f32 v[28:29], v[92:93], v[92:93]
    v_pk_mul_f32 v[30:31], v[94:95], v[94:95]
    v_pk_fma_f32 v[16:17], v[16:17], v[226:227], v[224:225]
    v_pk_fma_f32 v[18:19], v[18:19], v[226:227], v[224:225]
    v_pk_fma_f32 v[20:21], v[20:21], v[226:227], v[224:225]
    v_pk_fma_f32 v[22:23], v[22:23], v[226:227], v[224:225]
    v_pk_fma_f32 v[24:25], v[24:25], v[226:227], v[224:225]
    v_pk_fma_f32 v[26:27], v[26:27], v[226:227], v[224:225]
    v_pk_fma_f32 v[28:29], v[28:29], v[226:227], v[224:225]
    v_pk_fma_f32 v[30:31], v[30:31], v[226:227], v[224:225]
    v_pk_mul_f32 v[16:17], v[16:17], v[80:81]
    v_pk_mul_f32 v[18:19], v[18:19], v[82:83]
    v_pk_mul_f32 v[20:21], v[20:21], v[84:85]
    v_pk_mul_f32 v[22:23], v[22:23], v[86:87]
    v_pk_mul_f32 v[24:25], v[24:25], v[88:89]
    v_pk_mul_f32 v[26:27], v[26:27], v[90:91]
    v_pk_mul_f32 v[28:29], v[28:29], v[92:93]
    v_pk_mul_f32 v[30:31], v[30:31], v[94:95]
    v_exp_f32 v16, v16
    v_exp_f32 v17, v17
    v_exp_f32 v18, v18
    v_exp_f32 v19, v19
    v_exp_f32 v20, v20
    v_exp_f32 v21, v21
    v_exp_f32 v22, v22
    v_exp_f32 v23, v23
    v_exp_f32 v24, v24
    v_exp_f32 v25, v25
    v_exp_f32 v26, v26
    v_exp_f32 v27, v27
    v_exp_f32 v28, v28
    v_exp_f32 v29, v29
    v_exp_f32 v30, v30
    v_exp_f32 v31, v31
    v_pk_add_f32 v[16:17], v[16:17], v[228:229]
    v_pk_add_f32 v[18:19], v[18:19], v[228:229]
    v_pk_add_f32 v[20:21], v[20:21], v[228:229]
    v_pk_add_f32 v[22:23], v[22:23], v[228:229]
    v_pk_add_f32 v[24:25], v[24:25], v[228:229]
    v_pk_add_f32 v[26:27], v[26:27], v[228:229]
    v_pk_add_f32 v[28:29], v[28:29], v[228:229]
    v_pk_add_f32 v[30:31], v[30:31], v[228:229]
    v_rcp_f32 v16, v16
    v_rcp_f32 v17, v17
    v_rcp_f32 v18, v18
    v_rcp_f32 v19, v19
    v_rcp_f32 v20, v20
    v_rcp_f32 v21, v21
    v_rcp_f32 v22, v22
    v_rcp_f32 v23, v23
    v_rcp_f32 v24, v24
    v_rcp_f32 v25, v25
    v_rcp_f32 v26, v26
    v_rcp_f32 v27, v27
    v_rcp_f32 v28, v28
    v_rcp_f32 v29, v29
    v_rcp_f32 v30, v30
    v_rcp_f32 v31, v31
    v_pk_mul_f32 v[80:81], v[80:81], v[16:17]
    v_pk_mul_f32 v[82:83], v[82:83], v[18:19]
    v_pk_mul_f32 v[84:85], v[84:85], v[20:21]
    v_pk_mul_f32 v[86:87], v[86:87], v[22:23]
    v_pk_mul_f32 v[88:89], v[88:89], v[24:25]
    v_pk_mul_f32 v[90:91], v[90:91], v[26:27]
    v_pk_mul_f32 v[92:93], v[92:93], v[28:29]
    v_pk_mul_f32 v[94:95], v[94:95], v[30:31]
    v_cvt_pk_bf16_f32 v16, v80, v81
    v_cvt_pk_bf16_f32 v17, v82, v83
    v_cvt_pk_bf16_f32 v18, v84, v85
    v_cvt_pk_bf16_f32 v19, v86, v87
    v_cvt_pk_bf16_f32 v20, v88, v89
    v_cvt_pk_bf16_f32 v21, v90, v91
    v_cvt_pk_bf16_f32 v22, v92, v93
    v_cvt_pk_bf16_f32 v23, v94, v95
    v_lshlrev_b32 v80, 16, v16
    v_and_b32 v81, 0xffff0000, v16
    v_lshlrev_b32 v82, 16, v17
    v_and_b32 v83, 0xffff0000, v17
    v_lshlrev_b32 v84, 16, v18
    v_and_b32 v85, 0xffff0000, v18
    v_lshlrev_b32 v86, 16, v19
    v_and_b32 v87, 0xffff0000, v19
    v_lshlrev_b32 v88, 16, v20
    v_and_b32 v89, 0xffff0000, v20
    v_lshlrev_b32 v90, 16, v21
    v_and_b32 v91, 0xffff0000, v21
    v_lshlrev_b32 v92, 16, v22
    v_and_b32 v93, 0xffff0000, v22
    v_lshlrev_b32 v94, 16, v23
    v_and_b32 v95, 0xffff0000, v23
    v_add_f32 v32, v32, v80
    v_fma_f32 v36, v80, v80, v36
    v_add_f32 v33, v33, v81
    v_fma_f32 v37, v81, v81, v37
    v_add_f32 v34, v34, v82
    v_fma_f32 v38, v82, v82, v38
    v_add_f32 v35, v35, v83
    v_fma_f32 v39, v83, v83, v39
    v_add_f32 v40, v40, v84
    v_fma_f32 v44, v84, v84, v44
    v_add_f32 v41, v41, v85
    v_fma_f32 v45, v85, v85, v45
    v_add_f32 v42, v42, v86
    v_fma_f32 v46, v86, v86, v46
    v_add_f32 v43, v43, v87
    v_fma_f32 v47, v87, v87, v47
    v_add_f32 v32, v32, v88
    v_fma_f32 v36, v88, v88, v36
    v_add_f32 v33, v33, v89
    v_fma_f32 v37, v89, v89, v37
    v_add_f32 v34, v34, v90
    v_fma_f32 v38, v90, v90, v38
    v_add_f32 v35, v35, v91
    v_fma_f32 v39, v91, v91, v39
    v_add_f32 v40, v40, v92
    v_fma_f32 v44, v92, v92, v44
    v_add_f32 v41, v41, v93
    v_fma_f32 v45, v93, v93, v45
    v_add_f32 v42, v42, v94
    v_fma_f32 v46, v94, v94, v46
    v_add_f32 v43, v43, v95
    v_fma_f32 v47, v95, v95, v47
    v_cvt_pk_bf16_f32 v16, v96, v97
    v_cvt_pk_bf16_f32 v18, v98, v99
    v_cvt_pk_bf16_f32 v20, v100, v101
    v_cvt_pk_bf16_f32 v22, v102, v103
    v_cvt_pk_bf16_f32 v24, v104, v105
    v_cvt_pk_bf16_f32 v26, v106, v107
    v_cvt_pk_bf16_f32 v28, v108, v109
    v_cvt_pk_bf16_f32 v30, v110, v111
    v_lshlrev_b32 v96, 16, v16
    v_and_b32 v97, 0xffff0000, v16
    v_lshlrev_b32 v98, 16, v18
    v_and_b32 v99, 0xffff0000, v18
    v_lshlrev_b32 v100, 16, v20
    v_and_b32 v101, 0xffff0000, v20
    v_lshlrev_b32 v102, 16, v22
    v_and_b32 v103, 0xffff0000, v22
    v_lshlrev_b32 v104, 16, v24
    v_and_b32 v105, 0xffff0000, v24
    v_lshlrev_b32 v106, 16, v26
    v_and_b32 v107, 0xffff0000, v26
    v_lshlrev_b32 v108, 16, v28
    v_and_b32 v109, 0xffff0000, v28
    v_lshlrev_b32 v110, 16, v30
    v_and_b32 v111, 0xffff0000, v30
    v_pk_mul_f32 v[16:17], v[96:97], v[96:97]
    v_pk_mul_f32 v[18:19], v[98:99], v[98:99]
    v_pk_mul_f32 v[20:21], v[100:101], v[100:101]
    v_pk_mul_f32 v[22:23], v[102:103], v[102:103]
    v_pk_mul_f32 v[24:25], v[104:105], v[104:105]
    v_pk_mul_f32 v[26:27], v[106:107], v[106:107]
    v_pk_mul_f32 v[28:29], v[108:109], v[108:109]
    v_pk_mul_f32 v[30:31], v[110:111], v[110:111]
    v_pk_fma_f32 v[16:17], v[16:17], v[226:227], v[224:225]
    v_pk_fma_f32 v[18:19], v[18:19], v[226:227], v[224:225]
    v_pk_fma_f32 v[20:21], v[20:21], v[226:227], v[224:225]
    v_pk_fma_f32 v[22:23], v[22:23], v[226:227], v[224:225]
    v_pk_fma_f32 v[24:25], v[24:25], v[226:227], v[224:225]
    v_pk_fma_f32 v[26:27], v[26:27], v[226:227], v[224:225]
    v_pk_fma_f32 v[28:29], v[28:29], v[226:227], v[224:225]
    v_pk_fma_f32 v[30:31], v[30:31], v[226:227], v[224:225]
    v_pk_mul_f32 v[16:17], v[16:17], v[96:97]
    v_pk_mul_f32 v[18:19], v[18:19], v[98:99]
    v_pk_mul_f32 v[20:21], v[20:21], v[100:101]
    v_pk_mul_f32 v[22:23], v[22:23], v[102:103]
    v_pk_mul_f32 v[24:25], v[24:25], v[104:105]
    v_pk_mul_f32 v[26:27], v[26:27], v[106:107]
    v_pk_mul_f32 v[28:29], v[28:29], v[108:109]
    v_pk_mul_f32 v[30:31], v[30:31], v[110:111]
    v_exp_f32 v16, v16
    v_exp_f32 v17, v17
    v_exp_f32 v18, v18
    v_exp_f32 v19, v19
    v_exp_f32 v20, v20
    v_exp_f32 v21, v21
    v_exp_f32 v22, v22
    v_exp_f32 v23, v23
    v_exp_f32 v24, v24
    v_exp_f32 v25, v25
    v_exp_f32 v26, v26
    v_exp_f32 v27, v27
    v_exp_f32 v28, v28
    v_exp_f32 v29, v29
    v_exp_f32 v30, v30
    v_exp_f32 v31, v31
    v_pk_add_f32 v[16:17], v[16:17], v[228:229]
    v_pk_add_f32 v[18:19], v[18:19], v[228:229]
    v_pk_add_f32 v[20:21], v[20:21], v[228:229]
    v_pk_add_f32 v[22:23], v[22:23], v[228:229]
    v_pk_add_f32 v[24:25], v[24:25], v[228:229]
    v_pk_add_f32 v[26:27], v[26:27], v[228:229]
    v_pk_add_f32 v[28:29], v[28:29], v[228:229]
    v_pk_add_f32 v[30:31], v[30:31], v[228:229]
    v_rcp_f32 v16, v16
    v_rcp_f32 v17, v17
    v_rcp_f32 v18, v18
    v_rcp_f32 v19, v19
    v_rcp_f32 v20, v20
    v_rcp_f32 v21, v21
    v_rcp_f32 v22, v22
    v_rcp_f32 v23, v23
    v_rcp_f32 v24, v24
    v_rcp_f32 v25, v25
    v_rcp_f32 v26, v26
    v_rcp_f32 v27, v27
    v_rcp_f32 v28, v28
    v_rcp_f32 v29, v29
    v_rcp_f32 v30, v30
    v_rcp_f32 v31, v31
    v_pk_mul_f32 v[96:97], v[96:97], v[16:17]
    v_pk_mul_f32 v[98:99], v[98:99], v[18:19]
    v_pk_mul_f32 v[100:101], v[100:101], v[20:21]
    v_pk_mul_f32 v[102:103], v[102:103], v[22:23]
    v_pk_mul_f32 v[104:105], v[104:105], v[24:25]
    v_pk_mul_f32 v[106:107], v[106:107], v[26:27]
    v_pk_mul_f32 v[108:109], v[108:109], v[28:29]
    v_pk_mul_f32 v[110:111], v[110:111], v[30:31]
    v_cvt_pk_bf16_f32 v16, v96, v97
    v_cvt_pk_bf16_f32 v17, v98, v99
    v_cvt_pk_bf16_f32 v18, v100, v101
    v_cvt_pk_bf16_f32 v19, v102, v103
    v_cvt_pk_bf16_f32 v20, v104, v105
    v_cvt_pk_bf16_f32 v21, v106, v107
    v_cvt_pk_bf16_f32 v22, v108, v109
    v_cvt_pk_bf16_f32 v23, v110, v111
    v_lshlrev_b32 v96, 16, v16
    v_and_b32 v97, 0xffff0000, v16
    v_lshlrev_b32 v98, 16, v17
    v_and_b32 v99, 0xffff0000, v17
    v_lshlrev_b32 v100, 16, v18
    v_and_b32 v101, 0xffff0000, v18
    v_lshlrev_b32 v102, 16, v19
    v_and_b32 v103, 0xffff0000, v19
    v_lshlrev_b32 v104, 16, v20
    v_and_b32 v105, 0xffff0000, v20
    v_lshlrev_b32 v106, 16, v21
    v_and_b32 v107, 0xffff0000, v21
    v_lshlrev_b32 v108, 16, v22
    v_and_b32 v109, 0xffff0000, v22
    v_lshlrev_b32 v110, 16, v23
    v_and_b32 v111, 0xffff0000, v23
    v_add_f32 v32, v32, v96
    v_fma_f32 v36, v96, v96, v36
    v_add_f32 v33, v33, v97
    v_fma_f32 v37, v97, v97, v37
    v_add_f32 v34, v34, v98
    v_fma_f32 v38, v98, v98, v38
    v_add_f32 v35, v35, v99
    v_fma_f32 v39, v99, v99, v39
    v_add_f32 v40, v40, v100
    v_fma_f32 v44, v100, v100, v44
    v_add_f32 v41, v41, v101
    v_fma_f32 v45, v101, v101, v45
    v_add_f32 v42, v42, v102
    v_fma_f32 v46, v102, v102, v46
    v_add_f32 v43, v43, v103
    v_fma_f32 v47, v103, v103, v47
    v_add_f32 v32, v32, v104
    v_fma_f32 v36, v104, v104, v36
    v_add_f32 v33, v33, v105
    v_fma_f32 v37, v105, v105, v37
    v_add_f32 v34, v34, v106
    v_fma_f32 v38, v106, v106, v38
    v_add_f32 v35, v35, v107
    v_fma_f32 v39, v107, v107, v39
    v_add_f32 v40, v40, v108
    v_fma_f32 v44, v108, v108, v44
    v_add_f32 v41, v41, v109
    v_fma_f32 v45, v109, v109, v45
    v_add_f32 v42, v42, v110
    v_fma_f32 v46, v110, v110, v46
    v_add_f32 v43, v43, v111
    v_fma_f32 v47, v111, v111, v47
    v_cvt_pk_bf16_f32 v16, v112, v113
    v_cvt_pk_bf16_f32 v18, v114, v115
    v_cvt_pk_bf16_f32 v20, v116, v117
    v_cvt_pk_bf16_f32 v22, v118, v119
    v_lshlrev_b32 v112, 16, v16
    v_and_b32 v113, 0xffff0000, v16
    v_lshlrev_b32 v114, 16, v18
    v_and_b32 v115, 0xffff0000, v18
    v_lshlrev_b32 v116, 16, v20
    v_and_b32 v117, 0xffff0000, v20
    v_lshlrev_b32 v118, 16, v22
    v_and_b32 v119, 0xffff0000, v22
    v_pk_mul_f32 v[16:17], v[112:113], v[112:113]
    v_pk_mul_f32 v[18:19], v[114:115], v[114:115]
    v_pk_mul_f32 v[20:21], v[116:117], v[116:117]
    v_pk_mul_f32 v[22:23], v[118:119], v[118:119]
    v_pk_fma_f32 v[16:17], v[16:17], v[226:227], v[224:225]
    v_pk_fma_f32 v[18:19], v[18:19], v[226:227], v[224:225]
    v_pk_fma_f32 v[20:21], v[20:21], v[226:227], v[224:225]
    v_pk_fma_f32 v[22:23], v[22:23], v[226:227], v[224:225]
    v_pk_mul_f32 v[16:17], v[16:17], v[112:113]
    v_pk_mul_f32 v[18:19], v[18:19], v[114:115]
    v_pk_mul_f32 v[20:21], v[20:21], v[116:117]
    v_pk_mul_f32 v[22:23], v[22:23], v[118:119]
    v_exp_f32 v16, v16
    v_exp_f32 v17, v17
    v_exp_f32 v18, v18
    v_exp_f32 v19, v19
    v_exp_f32 v20, v20
    v_exp_f32 v21, v21
    v_exp_f32 v22, v22
    v_exp_f32 v23, v23
    v_pk_add_f32 v[16:17], v[16:17], v[228:229]
    v_pk_add_f32 v[18:19], v[18:19], v[228:229]
    v_pk_add_f32 v[20:21], v[20:21], v[228:229]
    v_pk_add_f32 v[22:23], v[22:23], v[228:229]
    v_rcp_f32 v16, v16
    v_rcp_f32 v17, v17
    v_rcp_f32 v18, v18
    v_rcp_f32 v19, v19
    v_rcp_f32 v20, v20
    v_rcp_f32 v21, v21
    v_rcp_f32 v22, v22
    v_rcp_f32 v23, v23
    v_pk_mul_f32 v[112:113], v[112:113], v[16:17]
    v_pk_mul_f32 v[114:115], v[114:115], v[18:19]
    v_pk_mul_f32 v[116:117], v[116:117], v[20:21]
    v_pk_mul_f32 v[118:119], v[118:119], v[22:23]
    v_cvt_pk_bf16_f32 v16, v112, v113
    v_cvt_pk_bf16_f32 v17, v114, v115
    v_cvt_pk_bf16_f32 v18, v116, v117
    v_cvt_pk_bf16_f32 v19, v118, v119
    v_lshlrev_b32 v112, 16, v16
    v_and_b32 v113, 0xffff0000, v16
    v_lshlrev_b32 v114, 16, v17
    v_and_b32 v115, 0xffff0000, v17
    v_lshlrev_b32 v116, 16, v18
    v_and_b32 v117, 0xffff0000, v18
    v_lshlrev_b32 v118, 16, v19
    v_and_b32 v119, 0xffff0000, v19
    v_add_f32 v32, v32, v112
    v_fma_f32 v36, v112, v112, v36
    v_add_f32 v33, v33, v113
    v_fma_f32 v37, v113, v113, v37
    v_add_f32 v34, v34, v114
    v_fma_f32 v38, v114, v114, v38
    v_add_f32 v35, v35, v115
    v_fma_f32 v39, v115, v115, v39
    v_add_f32 v40, v40, v116
    v_fma_f32 v44, v116, v116, v44
    v_add_f32 v41, v41, v117
    v_fma_f32 v45, v117, v117, v45
    v_add_f32 v42, v42, v118
    v_fma_f32 v46, v118, v118, v46
    v_add_f32 v43, v43, v119
    v_fma_f32 v47, v119, v119, v47
    v_add_f32_dpp v32, v32, v32 row_ror:8 row_mask:0xf bank_mask:0xf
    v_add_f32_dpp v33, v33, v33 row_ror:8 row_mask:0xf bank_mask:0xf
    v_add_f32_dpp v34, v34, v34 row_ror:8 row_mask:0xf bank_mask:0xf
    v_add_f32_dpp v35, v35, v35 row_ror:8 row_mask:0xf bank_mask:0xf
    v_add_f32_dpp v36, v36, v36 row_ror:8 row_mask:0xf bank_mask:0xf
    v_add_f32_dpp v37, v37, v37 row_ror:8 row_mask:0xf bank_mask:0xf
    v_add_f32_dpp v38, v38, v38 row_ror:8 row_mask:0xf bank_mask:0xf
    v_add_f32_dpp v39, v39, v39 row_ror:8 row_mask:0xf bank_mask:0xf
    v_add_f32_dpp v40, v40, v40 row_ror:8 row_mask:0xf bank_mask:0xf
    v_add_f32_dpp v41, v41, v41 row_ror:8 row_mask:0xf bank_mask:0xf
    v_add_f32_dpp v42, v42, v42 row_ror:8 row_mask:0xf bank_mask:0xf
    v_add_f32_dpp v43, v43, v43 row_ror:8 row_mask:0xf bank_mask:0xf
    v_add_f32_dpp v44, v44, v44 row_ror:8 row_mask:0xf bank_mask:0xf
    v_add_f32_dpp v45, v45, v45 row_ror:8 row_mask:0xf bank_mask:0xf
    v_add_f32_dpp v46, v46, v46 row_ror:8 row_mask:0xf bank_mask:0xf
    v_add_f32_dpp v47, v47, v47 row_ror:8 row_mask:0xf bank_mask:0xf
    v_add_f32_dpp v32, v32, v32 row_ror:4 row_mask:0xf bank_mask:0xf
    v_add_f32_dpp v33, v33, v33 row_ror:4 row_mask:0xf bank_mask:0xf
    v_add_f32_dpp v34, v34, v34 row_ror:4 row_mask:0xf bank_mask:0xf
    v_add_f32_dpp v35, v35, v35 row_ror:4 row_mask:0xf bank_mask:0xf
    v_add_f32_dpp v36, v36, v36 row_ror:4 row_mask:0xf bank_mask:0xf
    v_add_f32_dpp v37, v37, v37 row_ror:4 row_mask:0xf bank_mask:0xf
    v_add_f32_dpp v38, v38, v38 row_ror:4 row_mask:0xf bank_mask:0xf
    v_add_f32_dpp v39, v39, v39 row_ror:4 row_mask:0xf bank_mask:0xf
    v_add_f32_dpp v40, v40, v40 row_ror:4 row_mask:0xf bank_mask:0xf
    v_add_f32_dpp v41, v41, v41 row_ror:4 row_mask:0xf bank_mask:0xf
    v_add_f32_dpp v42, v42, v42 row_ror:4 row_mask:0xf bank_mask:0xf
    v_add_f32_dpp v43, v43, v43 row_ror:4 row_mask:0xf bank_mask:0xf
    v_add_f32_dpp v44, v44, v44 row_ror:4 row_mask:0xf bank_mask:0xf
    v_add_f32_dpp v45, v45, v45 row_ror:4 row_mask:0xf bank_mask:0xf
    v_add_f32_dpp v46, v46, v46 row_ror:4 row_mask:0xf bank_mask:0xf
    v_add_f32_dpp v47, v47, v47 row_ror:4 row_mask:0xf bank_mask:0xf
    v_add_f32_dpp v32, v32, v32 row_ror:2 row_mask:0xf bank_mask:0xf
    v_add_f32_dpp v33, v33, v33 row_ror:2 row_mask:0xf bank_mask:0xf
    v_add_f32_dpp v34, v34, v34 row_ror:2 row_mask:0xf bank_mask:0xf
    v_add_f32_dpp v35, v35, v35 row_ror:2 row_mask:0xf bank_mask:0xf
    v_add_f32_dpp v36, v36, v36 row_ror:2 row_mask:0xf bank_mask:0xf
    v_add_f32_dpp v37, v37, v37 row_ror:2 row_mask:0xf bank_mask:0xf
    v_add_f32_dpp v38, v38, v38 row_ror:2 row_mask:0xf bank_mask:0xf
    v_add_f32_dpp v39, v39, v39 row_ror:2 row_mask:0xf bank_mask:0xf
    v_add_f32_dpp v40, v40, v40 row_ror:2 row_mask:0xf bank_mask:0xf
    v_add_f32_dpp v41, v41, v41 row_ror:2 row_mask:0xf bank_mask:0xf
    v_add_f32_dpp v42, v42, v42 row_ror:2 row_mask:0xf bank_mask:0xf
    v_add_f32_dpp v43, v43, v43 row_ror:2 row_mask:0xf bank_mask:0xf
    v_add_f32_dpp v44, v44, v44 row_ror:2 row_mask:0xf bank_mask:0xf
    v_add_f32_dpp v45, v45, v45 row_ror:2 row_mask:0xf bank_mask:0xf
    v_add_f32_dpp v46, v46, v46 row_ror:2 row_mask:0xf bank_mask:0xf
    v_add_f32_dpp v47, v47, v47 row_ror:2 row_mask:0xf bank_mask:0xf
    v_add_f32_dpp v32, v32, v32 row_ror:1 row_mask:0xf bank_mask:0xf
    v_add_f32_dpp v33, v33, v33 row_ror:1 row_mask:0xf bank_mask:0xf
    v_add_f32_dpp v34, v34, v34 row_ror:1 row_mask:0xf bank_mask:0xf
    v_add_f32_dpp v35, v35, v35 row_ror:1 row_mask:0xf bank_mask:0xf
    v_add_f32_dpp v36, v36, v36 row_ror:1 row_mask:0xf bank_mask:0xf
    v_add_f32_dpp v37, v37, v37 row_ror:1 row_mask:0xf bank_mask:0xf
    v_add_f32_dpp v38, v38, v38 row_ror:1 row_mask:0xf bank_mask:0xf
    v_add_f32_dpp v39, v39, v39 row_ror:1 row_mask:0xf bank_mask:0xf
    v_add_f32_dpp v40, v40, v40 row_ror:1 row_mask:0xf bank_mask:0xf
    v_add_f32_dpp v41, v41, v41 row_ror:1 row_mask:0xf bank_mask:0xf
    v_add_f32_dpp v42, v42, v42 row_ror:1 row_mask:0xf bank_mask:0xf
    v_add_f32_dpp v43, v43, v43 row_ror:1 row_mask:0xf bank_mask:0xf
    v_add_f32_dpp v44, v44, v44 row_ror:1 row_mask:0xf bank_mask:0xf
    v_add_f32_dpp v45, v45, v45 row_ror:1 row_mask:0xf bank_mask:0xf
    v_add_f32_dpp v46, v46, v46 row_ror:1 row_mask:0xf bank_mask:0xf
    v_add_f32_dpp v47, v47, v47 row_ror:1 row_mask:0xf bank_mask:0xf
    s_lshl_b32 s54, s48, 9
    s_lshl_b32 s55, s80, 8
    s_add_u32 s54, s54, s55
    s_add_u32 s54, s54, 58368
    v_lshlrev_b32 v8, 5, v2
    v_add_u32 v8, s54, v8
    ds_write_b128 v8, v[32:35] offset:0
    ds_write_b128 v8, v[36:39] offset:16
    ds_write_b128 v8, v[40:43] offset:128
    ds_write_b128 v8, v[44:47] offset:144
    s_waitcnt lgkmcnt(0)
    s_barrier
    s_cmp_lg_u32 s81, 0
    s_cbranch_scc1 K1_Z2_WAIT
    v_lshlrev_b32 v8, 3, v1
    v_lshrrev_b32 v9, 2, v1
    v_lshlrev_b32 v9, 5, v9
    v_and_b32 v10, 3, v1
    v_lshl_add_u32 v9, v10, 2, v9
    v_add_u32 v9, 58368, v9
    ds_read_b32 v16, v9 offset:0
    ds_read_b32 v17, v9 offset:16
    ds_read_b32 v18, v9 offset:512
    ds_read_b32 v19, v9 offset:528
    ds_read_b32 v20, v9 offset:1024
    ds_read_b32 v21, v9 offset:1040
    ds_read_b32 v22, v9 offset:1536
    ds_read_b32 v23, v9 offset:1552
    s_waitcnt lgkmcnt(0)
    v_add_f32 v16, v16, v18
    v_add_f32 v17, v17, v19
    v_add_f32 v20, v20, v22
    v_add_f32 v21, v21, v23
    v_add_f32 v16, v16, v20
    v_add_f32 v17, v17, v21
    s_mov_b32 s54, s69
    s_lshl_b32 s55, s46, 1
    s_add_u32 s56, s55, s54
    s_xor_b32 s57, s56, 1
    s_lshl_b32 s58, s56, 9
    buffer_store_dwordx2 v[16:17], v8, s[24:27], s58 offen sc1
    s_waitcnt vmcnt(0)
    v_mov_b32 v18, 1
    s_lshl_b32 s58, s56, 2
    v_mov_b32 v19, 0
    v_cmp_eq_u32 vcc, 0, v1
    v_mov_b32 v20, 2130706432
    s_nop 0
    v_cndmask_b32 v19, v20, v19, vcc
    buffer_store_dword v18, v19, s[28:31], s58 offen sc1
    s_lshl_b32 s58, s57, 2
    v_mov_b32 v19, 0
    s_nop 1
K1_Z2_POLL:
    buffer_load_dword v18, v19, s[28:31], s58 offen sc1
    s_waitcnt vmcnt(0)
    v_readfirstlane_b32 s59, v18
    s_nop 1
    s_cmp_lg_u32 s59, 0
    s_nop 1
    s_cbranch_scc1 K1_Z2_GOT
    s_sleep 2
    s_branch K1_Z2_POLL
K1_Z2_GOT:
    s_lshl_b32 s58, s57, 9
    buffer_load_dwordx2 v[18:19], v8, s[24:27], s58 offen sc1
    s_waitcnt vmcnt(0)
    v_add_f32 v16, v16, v18
    v_add_f32 v17, v17, v19
    v_mul_f32 v16, 0x3a924925, v16
    v_mul_f32 v17, 0x3a924925, v17
    v_fma_f32 v17, -v16, v16, v17
    v_max_f32 v17, 0, v17
    v_cvt_pk_bf16_f32 v18, v16, v17
    v_lshlrev_b32 v16, 16, v18
    v_and_b32 v17, 0xffff0000, v18
    v_add_f32 v17, 0x3727c5ac, v17
    v_cvt_pk_bf16_f32 v17, v17, v17
    v_lshlrev_b32 v17, 16, v17
    v_sqrt_f32 v17, v17
    s_nop 0
    v_cvt_pk_bf16_f32 v17, v17, v17
    v_lshlrev_b32 v17, 16, v17
    v_rcp_f32 v17, v17
    v_sub_f32 v16, 0, v16
    v_add_u32 v9, 4096, v9
    ds_write_b32 v9, v17
    ds_write_b32 v9, v16 offset:16
    s_waitcnt lgkmcnt(0)
K1_Z2_WAIT:
    s_barrier
    v_lshlrev_b32 v8, 5, v2
    s_lshl_b32 s54, s80, 8
    s_add_u32 s54, s54, 62464
    v_add_u32 v8, s54, v8
    ds_read_b128 v[32:35], v8 offset:0
    ds_read_b128 v[36:39], v8 offset:16
    ds_read_b128 v[40:43], v8 offset:128
    ds_read_b128 v[44:47], v8 offset:144
    s_mul_i32 s54, s69, 448
    s_mul_i32 s55, s48, 112
    s_add_u32 s54, s54, s55
    v_add_u32 v8, s54, v3
    v_lshlrev_b32 v8, 8, v8
    v_and_b32 v10, 1, v2
    v_lshl_add_u32 v8, v10, 5, v8
    v_lshrrev_b32 v10, 1, v2
    v_lshl_add_u32 v8, v10, 4, v8
    s_lshr_b32 s54, s46, 1
    s_mul_i32 s54, s54, 229376
    s_and_b32 s55, s46, 1
    s_lshl_b32 s55, s55, 7
    s_add_u32 s54, s54, s55
    s_lshl_b32 s55, s80, 6
    s_add_u32 s54, s54, s55
    v_add_u32 v8, s54, v8
    s_waitcnt lgkmcnt(0)
    v_add_f32 v64, v64, v36
    v_add_f32 v65, v65, v37
    v_add_f32 v66, v66, v38
    v_add_f32 v67, v67, v39
    v_add_f32 v68, v68, v44
    v_add_f32 v69, v69, v45
    v_add_f32 v70, v70, v46
    v_add_f32 v71, v71, v47
    v_add_f32 v72, v72, v36
    v_add_f32 v73, v73, v37
    v_add_f32 v74, v74, v38
    v_add_f32 v75, v75, v39
    v_add_f32 v76, v76, v44
    v_add_f32 v77, v77, v45
    v_add_f32 v78, v78, v46
    v_add_f32 v79, v79, v47
    v_cvt_pk_bf16_f32 v16, v64, v65
    v_cvt_pk_bf16_f32 v17, v66, v67
    v_cvt_pk_bf16_f32 v18, v68, v69
    v_cvt_pk_bf16_f32 v19, v70, v71
    v_cvt_pk_bf16_f32 v20, v72, v73
    v_cvt_pk_bf16_f32 v21, v74, v75
    v_cvt_pk_bf16_f32 v22, v76, v77
    v_cvt_pk_bf16_f32 v23, v78, v79
    v_lshlrev_b32 v64, 16, v16
    v_and_b32 v65, 0xffff0000, v16
    v_lshlrev_b32 v66, 16, v17
    v_and_b32 v67, 0xffff0000, v17
    v_lshlrev_b32 v68, 16, v18
    v_and_b32 v69, 0xffff0000, v18
    v_lshlrev_b32 v70, 16, v19
    v_and_b32 v71, 0xffff0000, v19
    v_lshlrev_b32 v72, 16, v20
    v_and_b32 v73, 0xffff0000, v20
    v_lshlrev_b32 v74, 16, v21
    v_and_b32 v75, 0xffff0000, v21
    v_lshlrev_b32 v76, 16, v22
    v_and_b32 v77, 0xffff0000, v22
    v_lshlrev_b32 v78, 16, v23
    v_and_b32 v79, 0xffff0000, v23
    v_mul_f32 v64, v64, v32
    v_mul_f32 v65, v65, v33
    v_mul_f32 v66, v66, v34
    v_mul_f32 v67, v67, v35
    v_mul_f32 v68, v68, v40
    v_mul_f32 v69, v69, v41
    v_mul_f32 v70, v70, v42
    v_mul_f32 v71, v71, v43
    v_mul_f32 v72, v72, v32
    v_mul_f32 v73, v73, v33
    v_mul_f32 v74, v74, v34
    v_mul_f32 v75, v75, v35
    v_mul_f32 v76, v76, v40
    v_mul_f32 v77, v77, v41
    v_mul_f32 v78, v78, v42
    v_mul_f32 v79, v79, v43
    v_cvt_pk_bf16_f32 v64, v64, v65
    v_cvt_pk_bf16_f32 v65, v66, v67
    v_cvt_pk_bf16_f32 v66, v68, v69
    v_cvt_pk_bf16_f32 v67, v70, v71
    v_cvt_pk_bf16_f32 v72, v72, v73
    v_cvt_pk_bf16_f32 v73, v74, v75
    v_cvt_pk_bf16_f32 v74, v76, v77
    v_cvt_pk_bf16_f32 v75, v78, v79
    v_permlane16_swap_b32 v64, v66
    v_permlane16_swap_b32 v65, v67
    v_permlane16_swap_b32 v72, v74
    v_permlane16_swap_b32 v73, v75
    s_mov_b32 s54, 0
    buffer_store_dwordx4 v[64:67], v8, s[16:19], s54 offen
    s_mov_b32 s54, 4096
    buffer_store_dwordx4 v[72:75], v8, s[16:19], s54 offen
    v_add_f32 v80, v80, v36
    v_add_f32 v81, v81, v37
    v_add_f32 v82, v82, v38
    v_add_f32 v83, v83, v39
    v_add_f32 v84, v84, v44
    v_add_f32 v85, v85, v45
    v_add_f32 v86, v86, v46
    v_add_f32 v87, v87, v47
    v_add_f32 v88, v88, v36
    v_add_f32 v89, v89, v37
    v_add_f32 v90, v90, v38
    v_add_f32 v91, v91, v39
    v_add_f32 v92, v92, v44
    v_add_f32 v93, v93, v45
    v_add_f32 v94, v94, v46
    v_add_f32 v95, v95, v47
    v_cvt_pk_bf16_f32 v16, v80, v81
    v_cvt_pk_bf16_f32 v17, v82, v83
    v_cvt_pk_bf16_f32 v18, v84, v85
    v_cvt_pk_bf16_f32 v19, v86, v87
    v_cvt_pk_bf16_f32 v20, v88, v89
    v_cvt_pk_bf16_f32 v21, v90, v91
    v_cvt_pk_bf16_f32 v22, v92, v93
    v_cvt_pk_bf16_f32 v23, v94, v95
    v_lshlrev_b32 v80, 16, v16
    v_and_b32 v81, 0xffff0000, v16
    v_lshlrev_b32 v82, 16, v17
    v_and_b32 v83, 0xffff0000, v17
    v_lshlrev_b32 v84, 16, v18
    v_and_b32 v85, 0xffff0000, v18
    v_lshlrev_b32 v86, 16, v19
    v_and_b32 v87, 0xffff0000, v19
    v_lshlrev_b32 v88, 16, v20
    v_and_b32 v89, 0xffff0000, v20
    v_lshlrev_b32 v90, 16, v21
    v_and_b32 v91, 0xffff0000, v21
    v_lshlrev_b32 v92, 16, v22
    v_and_b32 v93, 0xffff0000, v22
    v_lshlrev_b32 v94, 16, v23
    v_and_b32 v95, 0xffff0000, v23
    v_mul_f32 v80, v80, v32
    v_mul_f32 v81, v81, v33
    v_mul_f32 v82, v82, v34
    v_mul_f32 v83, v83, v35
    v_mul_f32 v84, v84, v40
    v_mul_f32 v85, v85, v41
    v_mul_f32 v86, v86, v42
    v_mul_f32 v87, v87, v43
    v_mul_f32 v88, v88, v32
    v_mul_f32 v89, v89, v33
    v_mul_f32 v90, v90, v34
    v_mul_f32 v91, v91, v35
    v_mul_f32 v92, v92, v40
    v_mul_f32 v93, v93, v41
    v_mul_f32 v94, v94, v42
    v_mul_f32 v95, v95, v43
    v_cvt_pk_bf16_f32 v80, v80, v81
    v_cvt_pk_bf16_f32 v81, v82, v83
    v_cvt_pk_bf16_f32 v82, v84, v85
    v_cvt_pk_bf16_f32 v83, v86, v87
    v_cvt_pk_bf16_f32 v88, v88, v89
    v_cvt_pk_bf16_f32 v89, v90, v91
    v_cvt_pk_bf16_f32 v90, v92, v93
    v_cvt_pk_bf16_f32 v91, v94, v95
    v_permlane16_swap_b32 v80, v82
    v_permlane16_swap_b32 v81, v83
    v_permlane16_swap_b32 v88, v90
    v_permlane16_swap_b32 v89, v91
    s_mov_b32 s54, 8192
    buffer_store_dwordx4 v[80:83], v8, s[16:19], s54 offen
    s_mov_b32 s54, 12288
    buffer_store_dwordx4 v[88:91], v8, s[16:19], s54 offen
    v_add_f32 v96, v96, v36
    v_add_f32 v97, v97, v37
    v_add_f32 v98, v98, v38
    v_add_f32 v99, v99, v39
    v_add_f32 v100, v100, v44
    v_add_f32 v101, v101, v45
    v_add_f32 v102, v102, v46
    v_add_f32 v103, v103, v47
    v_add_f32 v104, v104, v36
    v_add_f32 v105, v105, v37
    v_add_f32 v106, v106, v38
    v_add_f32 v107, v107, v39
    v_add_f32 v108, v108, v44
    v_add_f32 v109, v109, v45
    v_add_f32 v110, v110, v46
    v_add_f32 v111, v111, v47
    v_cvt_pk_bf16_f32 v16, v96, v97
    v_cvt_pk_bf16_f32 v17, v98, v99
    v_cvt_pk_bf16_f32 v18, v100, v101
    v_cvt_pk_bf16_f32 v19, v102, v103
    v_cvt_pk_bf16_f32 v20, v104, v105
    v_cvt_pk_bf16_f32 v21, v106, v107
    v_cvt_pk_bf16_f32 v22, v108, v109
    v_cvt_pk_bf16_f32 v23, v110, v111
    v_lshlrev_b32 v96, 16, v16
    v_and_b32 v97, 0xffff0000, v16
    v_lshlrev_b32 v98, 16, v17
    v_and_b32 v99, 0xffff0000, v17
    v_lshlrev_b32 v100, 16, v18
    v_and_b32 v101, 0xffff0000, v18
    v_lshlrev_b32 v102, 16, v19
    v_and_b32 v103, 0xffff0000, v19
    v_lshlrev_b32 v104, 16, v20
    v_and_b32 v105, 0xffff0000, v20
    v_lshlrev_b32 v106, 16, v21
    v_and_b32 v107, 0xffff0000, v21
    v_lshlrev_b32 v108, 16, v22
    v_and_b32 v109, 0xffff0000, v22
    v_lshlrev_b32 v110, 16, v23
    v_and_b32 v111, 0xffff0000, v23
    v_mul_f32 v96, v96, v32
    v_mul_f32 v97, v97, v33
    v_mul_f32 v98, v98, v34
    v_mul_f32 v99, v99, v35
    v_mul_f32 v100, v100, v40
    v_mul_f32 v101, v101, v41
    v_mul_f32 v102, v102, v42
    v_mul_f32 v103, v103, v43
    v_mul_f32 v104, v104, v32
    v_mul_f32 v105, v105, v33
    v_mul_f32 v106, v106, v34
    v_mul_f32 v107, v107, v35
    v_mul_f32 v108, v108, v40
    v_mul_f32 v109, v109, v41
    v_mul_f32 v110, v110, v42
    v_mul_f32 v111, v111, v43
    v_cvt_pk_bf16_f32 v96, v96, v97
    v_cvt_pk_bf16_f32 v97, v98, v99
    v_cvt_pk_bf16_f32 v98, v100, v101
    v_cvt_pk_bf16_f32 v99, v102, v103
    v_cvt_pk_bf16_f32 v104, v104, v105
    v_cvt_pk_bf16_f32 v105, v106, v107
    v_cvt_pk_bf16_f32 v106, v108, v109
    v_cvt_pk_bf16_f32 v107, v110, v111
    v_permlane16_swap_b32 v96, v98
    v_permlane16_swap_b32 v97, v99
    v_permlane16_swap_b32 v104, v106
    v_permlane16_swap_b32 v105, v107
    s_mov_b32 s54, 16384
    buffer_store_dwordx4 v[96:99], v8, s[16:19], s54 offen
    s_mov_b32 s54, 20480
    buffer_store_dwordx4 v[104:107], v8, s[16:19], s54 offen
    v_add_f32 v112, v112, v36
    v_add_f32 v113, v113, v37
    v_add_f32 v114, v114, v38
    v_add_f32 v115, v115, v39
    v_add_f32 v116, v116, v44
    v_add_f32 v117, v117, v45
    v_add_f32 v118, v118, v46
    v_add_f32 v119, v119, v47
    v_cvt_pk_bf16_f32 v16, v112, v113
    v_cvt_pk_bf16_f32 v17, v114, v115
    v_cvt_pk_bf16_f32 v18, v116, v117
    v_cvt_pk_bf16_f32 v19, v118, v119
    v_lshlrev_b32 v112, 16, v16
    v_and_b32 v113, 0xffff0000, v16
    v_lshlrev_b32 v114, 16, v17
    v_and_b32 v115, 0xffff0000, v17
    v_lshlrev_b32 v116, 16, v18
    v_and_b32 v117, 0xffff0000, v18
    v_lshlrev_b32 v118, 16, v19
    v_and_b32 v119, 0xffff0000, v19
    v_mul_f32 v112, v112, v32
    v_mul_f32 v113, v113, v33
    v_mul_f32 v114, v114, v34
    v_mul_f32 v115, v115, v35
    v_mul_f32 v116, v116, v40
    v_mul_f32 v117, v117, v41
    v_mul_f32 v118, v118, v42
    v_mul_f32 v119, v119, v43
    v_cvt_pk_bf16_f32 v112, v112, v113
    v_cvt_pk_bf16_f32 v113, v114, v115
    v_cvt_pk_bf16_f32 v114, v116, v117
    v_cvt_pk_bf16_f32 v115, v118, v119
    s_nop 0
    v_permlane16_swap_b32 v112, v114
    v_permlane16_swap_b32 v113, v115
    s_mov_b32 s54, 24576
    buffer_store_dwordx4 v[112:115], v8, s[16:19], s54 offen
    s_nop 1
    s_branch K1_END
K1_END:
    s_cmp_ge_u32 s68, 2
    s_cbranch_scc1 K1_NOPF
    s_load_dwordx2 s[4:5], s[0:1], 48
    s_lshr_b32 s55, s45, 3
    s_lshl_b32 s55, s55, 1
    s_add_u32 s55, s55, s69
    s_mul_i32 s56, s55, 0x30000
    s_lshl_b32 s57, s55, 16
    s_add_u32 s57, s57, 0x180000
    s_cmp_eq_u32 s68, 0
    s_cselect_b32 s54, s56, s57
    s_cselect_b32 s59, 3, 1
    s_lshr_b32 s55, s44, 1
    s_lshl_b32 s55, s55, 21
    s_add_u32 s54, s54, s55
    s_lshl_b32 s55, s81, 13
    s_add_u32 s54, s54, s55
    v_lshlrev_b32 v4, 4, v1
    s_waitcnt lgkmcnt(0)
    s_mov_b32 s8, s4
    s_mov_b32 s9, s5
    s_mov_b32 s10, 8388608
    s_mov_b32 s11, 0x00020000
K1_PF:
    buffer_load_dwordx4 v[64:67], v4, s[8:11], s54 offen offset:0
    buffer_load_dwordx4 v[68:71], v4, s[8:11], s54 offen offset:1024
    buffer_load_dwordx4 v[72:75], v4, s[8:11], s54 offen offset:2048
    buffer_load_dwordx4 v[76:79], v4, s[8:11], s54 offen offset:3072
    s_add_u32 s54, s54, 4096
    buffer_load_dwordx4 v[80:83], v4, s[8:11], s54 offen offset:0
    buffer_load_dwordx4 v[84:87], v4, s[8:11], s54 offen offset:1024
    buffer_load_dwordx4 v[88:91], v4, s[8:11], s54 offen offset:2048
    buffer_load_dwordx4 v[92:95], v4, s[8:11], s54 offen offset:3072
    s_add_u32 s54, s54, 4096
    s_add_u32 s54, s54, 0xe000
    s_sub_u32 s59, s59, 1
    s_cmp_lg_u32 s59, 0
    s_cbranch_scc1 K1_PF
K1_NOPF:
K1_EXIT:
    s_endpgm
.globl k2_spatial_kernel
.p2align 8
.type k2_spatial_kernel,@function
k2_spatial_kernel:
    s_cmp_ge_u32 s2, 256
    s_cbranch_scc1 K2_EXIT
    s_load_dwordx2 s[4:5], s[0:1], 48
    s_load_dwordx2 s[6:7], s[0:1], 56
    s_load_dwordx2 s[32:33], s[0:1], 88
    s_and_b32 s36, s2, 7
    s_lshr_b32 s37, s2, 3
    s_mul_i32 s38, s37, 37
    s_lshr_b32 s38, s38, 8
    s_mul_i32 s39, s38, 7
    s_sub_u32 s39, s37, s39
    s_waitcnt lgkmcnt(0)
    s_cmp_ge_u32 s37, 28
    s_cbranch_scc1 K2_SPARE
    s_lshr_b32 s40, s36, 1
    s_lshl_b32 s40, s40, 2
    s_add_u32 s38, s38, s40
    s_and_b32 s40, s36, 1
    s_mul_i32 s40, s40, 7
    s_add_u32 s39, s39, s40
    s_lshl_b32 s40, s38, 7
    s_lshl_b32 s41, s39, 6
    s_mov_b32 s8, s4
    s_mov_b32 s9, s5
    s_mov_b32 s10, 8388608
    s_mov_b32 s11, 0x00020000
    s_add_u32 s12, s32, 10485760
    s_addc_u32 s13, s33, 0
    s_mov_b32 s14, 3670016
    s_mov_b32 s15, 0x00020000
    s_add_u32 s16, s32, 6291456
    s_addc_u32 s17, s33, 0
    s_mov_b32 s18, 3670016
    s_mov_b32 s19, 0x00020000
    s_mov_b32 s20, s32
    s_mov_b32 s21, s33
    s_mov_b32 s22, 5505024
    s_mov_b32 s23, 0x00020000
    s_mov_b32 s24, s6
    s_mov_b32 s25, s7
    s_mov_b32 s26, 4096
    s_mov_b32 s27, 0x00020000
    v_and_b32 v1, 63, v0
    v_lshrrev_b32 v26, 6, v0
    s_nop 0
    v_readfirstlane_b32 s44, v26
    s_nop 1
    s_lshr_b32 s56, s44, 1
    s_and_b32 s57, s44, 1
    v_lshrrev_b32 v26, 4, v1
    v_and_b32 v27, 15, v1
    s_mul_i32 s51, s44, 32
    s_add_u32 s52, s51, s40
    s_mov_b32 s53, 4096
    v_add_u32 v28, 0, v26
    v_add_u32 v2, s52, v28
    v_mul_lo_u32 v2, v2, s53
    v_add_u32 v28, s51, v28
    v_and_b32 v28, 15, v28
    v_xor_b32 v28, v28, v27
    v_lshl_add_u32 v2, v28, 4, v2
    v_add_u32 v28, 4, v26
    v_add_u32 v3, s52, v28
    v_mul_lo_u32 v3, v3, s53
    v_add_u32 v28, s51, v28
    v_and_b32 v28, 15, v28
    v_xor_b32 v28, v28, v27
    v_lshl_add_u32 v3, v28, 4, v3
    v_add_u32 v28, 8, v26
    v_add_u32 v4, s52, v28
    v_mul_lo_u32 v4, v4, s53
    v_add_u32 v28, s51, v28
    v_and_b32 v28, 15, v28
    v_xor_b32 v28, v28, v27
    v_lshl_add_u32 v4, v28, 4, v4
    v_add_u32 v28, 12, v26
    v_add_u32 v5, s52, v28
    v_mul_lo_u32 v5, v5, s53
    v_add_u32 v28, s51, v28
    v_and_b32 v28, 15, v28
    v_xor_b32 v28, v28, v27
    v_lshl_add_u32 v5, v28, 4, v5
    v_add_u32 v28, 16, v26
    v_add_u32 v6, s52, v28
    v_mul_lo_u32 v6, v6, s53
    v_add_u32 v28, s51, v28
    v_and_b32 v28, 15, v28
    v_xor_b32 v28, v28, v27
    v_lshl_add_u32 v6, v28, 4, v6
    v_add_u32 v28, 20, v26
    v_add_u32 v7, s52, v28
    v_mul_lo_u32 v7, v7, s53
    v_add_u32 v28, s51, v28
    v_and_b32 v28, 15, v28
    v_xor_b32 v28, v28, v27
    v_lshl_add_u32 v7, v28, 4, v7
    v_add_u32 v28, 24, v26
    v_add_u32 v8, s52, v28
    v_mul_lo_u32 v8, v8, s53
    v_add_u32 v28, s51, v28
    v_and_b32 v28, 15, v28
    v_xor_b32 v28, v28, v27
    v_lshl_add_u32 v8, v28, 4, v8
    v_add_u32 v28, 28, v26
    v_add_u32 v9, s52, v28
    v_mul_lo_u32 v9, v9, s53
    v_add_u32 v28, s51, v28
    v_and_b32 v28, 15, v28
    v_xor_b32 v28, v28, v27
    v_lshl_add_u32 v9, v28, 4, v9
    s_mul_i32 s51, s44, 16
    s_add_u32 s52, s51, s41
    s_mov_b32 s53, 256
    v_add_u32 v28, 0, v26
    v_add_u32 v10, s52, v28
    v_mul_lo_u32 v10, v10, s53
    v_add_u32 v28, s51, v28
    v_and_b32 v28, 15, v28
    v_xor_b32 v28, v28, v27
    v_lshl_add_u32 v10, v28, 4, v10
    v_add_u32 v28, 4, v26
    v_add_u32 v11, s52, v28
    v_mul_lo_u32 v11, v11, s53
    v_add_u32 v28, s51, v28
    v_and_b32 v28, 15, v28
    v_xor_b32 v28, v28, v27
    v_lshl_add_u32 v11, v28, 4, v11
    v_add_u32 v28, 8, v26
    v_add_u32 v12, s52, v28
    v_mul_lo_u32 v12, v12, s53
    v_add_u32 v28, s51, v28
    v_and_b32 v28, 15, v28
    v_xor_b32 v28, v28, v27
    v_lshl_add_u32 v12, v28, 4, v12
    v_add_u32 v28, 12, v26
    v_add_u32 v13, s52, v28
    v_mul_lo_u32 v13, v13, s53
    v_add_u32 v28, s51, v28
    v_and_b32 v28, 15, v28
    v_xor_b32 v28, v28, v27
    v_lshl_add_u32 v13, v28, 4, v13
    s_mul_i32 s49, s44, 8192
    s_mul_i32 s50, s44, 4096
    s_add_u32 s50, s50, 32768
    v_lshrrev_b32 v26, 4, v1
    v_and_b32 v27, 15, v1
    v_and_b32 v28, 15, v27
    v_add_u32 v14, 0, v26
    v_xor_b32 v14, v14, v28
    v_lshlrev_b32 v14, 4, v14
    v_lshl_add_u32 v14, v27, 8, v14
    v_add_u32 v15, 4, v26
    v_xor_b32 v15, v15, v28
    v_lshlrev_b32 v15, 4, v15
    v_lshl_add_u32 v15, v27, 8, v15
    v_add_u32 v16, 8, v26
    v_xor_b32 v16, v16, v28
    v_lshlrev_b32 v16, 4, v16
    v_lshl_add_u32 v16, v27, 8, v16
    v_add_u32 v17, 12, v26
    v_xor_b32 v17, v17, v28
    v_lshlrev_b32 v17, 4, v17
    v_lshl_add_u32 v17, v27, 8, v17
    s_mul_i32 s58, s56, 16384
    s_mul_i32 s59, s57, 8192
    s_add_u32 s59, s59, 32768
    s_mov_b32 s45, 0
    s_mov_b32 s46, 0
    s_mov_b32 s47, 0
    s_mov_b32 s48, 0
    v_and_b32 v112, 15, v1
    s_lshl_b32 s51, s56, 6
    s_add_u32 s51, s51, s40
    v_add_u32 v112, s51, v112
    v_lshlrev_b32 v115, 1, v112
    v_lshrrev_b32 v136, 4, v1
    v_lshlrev_b32 v137, 3, v136
    s_lshl_b32 s51, s57, 5
    s_add_u32 s51, s51, s41
    s_lshl_b32 s51, s51, 1
    v_mul_u32_u24 v113, 1792, v112
    v_add_u32 v113, v113, v137
    v_add_u32 v113, s51, v113
    v_mul_u32_u24 v114, 2688, v112
    v_add_u32 v114, s51, v114
    v_add_u32 v114, 896, v114
    v_and_b32 v137, 1, v136
    v_lshl_add_u32 v114, v137, 5, v114
    v_lshrrev_b32 v137, 1, v136
    v_lshl_add_u32 v114, v137, 4, v114
    s_add_u32 s51, s45, s49
    s_add_u32 s52, s45, s50
    s_add_u32 m0, s51, 0
    s_nop 0
    buffer_load_dwordx4 v2, s[8:11], s47 offen lds
    s_add_u32 m0, s51, 1024
    s_nop 0
    buffer_load_dwordx4 v3, s[8:11], s47 offen lds
    s_add_u32 m0, s51, 2048
    s_nop 0
    buffer_load_dwordx4 v4, s[8:11], s47 offen lds
    s_add_u32 m0, s51, 3072
    s_nop 0
    buffer_load_dwordx4 v5, s[8:11], s47 offen lds
    s_add_u32 m0, s51, 4096
    s_nop 0
    buffer_load_dwordx4 v6, s[8:11], s47 offen lds
    s_add_u32 m0, s51, 5120
    s_nop 0
    buffer_load_dwordx4 v7, s[8:11], s47 offen lds
    s_add_u32 m0, s51, 6144
    s_nop 0
    buffer_load_dwordx4 v8, s[8:11], s47 offen lds
    s_add_u32 m0, s51, 7168
    s_nop 0
    buffer_load_dwordx4 v9, s[8:11], s47 offen lds
    s_add_u32 m0, s52, 0
    s_nop 0
    buffer_load_dwordx4 v10, s[12:15], s48 offen lds
    s_add_u32 m0, s52, 1024
    s_nop 0
    buffer_load_dwordx4 v11, s[12:15], s48 offen lds
    s_add_u32 m0, s52, 2048
    s_nop 0
    buffer_load_dwordx4 v12, s[12:15], s48 offen lds
    s_add_u32 m0, s52, 3072
    s_nop 0
    buffer_load_dwordx4 v13, s[12:15], s48 offen lds
    s_add_u32 s47, s47, 256
    s_add_u32 s48, s48, 229376
    s_add_u32 s45, s45, 49152
    s_cmp_eq_u32 s45, 147456
    s_cselect_b32 s45, 0, s45
    s_add_u32 s51, s45, s49
    s_add_u32 s52, s45, s50
    s_add_u32 m0, s51, 0
    s_nop 0
    buffer_load_dwordx4 v2, s[8:11], s47 offen lds
    s_add_u32 m0, s51, 1024
    s_nop 0
    buffer_load_dwordx4 v3, s[8:11], s47 offen lds
    s_add_u32 m0, s51, 2048
    s_nop 0
    buffer_load_dwordx4 v4, s[8:11], s47 offen lds
    s_add_u32 m0, s51, 3072
    s_nop 0
    buffer_load_dwordx4 v5, s[8:11], s47 offen lds
    s_add_u32 m0, s51, 4096
    s_nop 0
    buffer_load_dwordx4 v6, s[8:11], s47 offen lds
    s_add_u32 m0, s51, 5120
    s_nop 0
    buffer_load_dwordx4 v7, s[8:11], s47 offen lds
    s_add_u32 m0, s51, 6144
    s_nop 0
    buffer_load_dwordx4 v8, s[8:11], s47 offen lds
    s_add_u32 m0, s51, 7168
    s_nop 0
    buffer_load_dwordx4 v9, s[8:11], s47 offen lds
    s_add_u32 m0, s52, 0
    s_nop 0
    buffer_load_dwordx4 v10, s[12:15], s48 offen lds
    s_add_u32 m0, s52, 1024
    s_nop 0
    buffer_load_dwordx4 v11, s[12:15], s48 offen lds
    s_add_u32 m0, s52, 2048
    s_nop 0
    buffer_load_dwordx4 v12, s[12:15], s48 offen lds
    s_add_u32 m0, s52, 3072
    s_nop 0
    buffer_load_dwordx4 v13, s[12:15], s48 offen lds
    s_add_u32 s47, s47, 256
    s_add_u32 s48, s48, 229376
    s_add_u32 s45, s45, 49152
    s_cmp_eq_u32 s45, 147456
    s_cselect_b32 s45, 0, s45
    buffer_load_ushort v116, v115, s[24:27], 0 offen offset:0
    buffer_load_ushort v117, v115, s[24:27], 0 offen offset:32
    buffer_load_ushort v118, v115, s[24:27], 0 offen offset:64
    buffer_load_ushort v119, v115, s[24:27], 0 offen offset:96
    s_mov_b32 s51, 0
    buffer_load_dwordx2 v[120:121], v113, s[16:19], s51 offen offset:0
    buffer_load_dwordx2 v[122:123], v113, s[16:19], s51 offen offset:32
    s_mov_b32 s51, 28672
    buffer_load_dwordx2 v[124:125], v113, s[16:19], s51 offen offset:0
    buffer_load_dwordx2 v[126:127], v113, s[16:19], s51 offen offset:32
    s_mov_b32 s51, 57344
    buffer_load_dwordx2 v[128:129], v113, s[16:19], s51 offen offset:0
    buffer_load_dwordx2 v[130:131], v113, s[16:19], s51 offen offset:32
    s_mov_b32 s51, 86016
    buffer_load_dwordx2 v[132:133], v113, s[16:19], s51 offen offset:0
    buffer_load_dwordx2 v[134:135], v113, s[16:19], s51 offen offset:32
    v_mov_b32 v80, 0
    v_mov_b32 v81, 0
    v_mov_b32 v82, 0
    v_mov_b32 v83, 0
    v_mov_b32 v84, 0
    v_mov_b32 v85, 0
    v_mov_b32 v86, 0
    v_mov_b32 v87, 0
    v_mov_b32 v88, 0
    v_mov_b32 v89, 0
    v_mov_b32 v90, 0
    v_mov_b32 v91, 0
    v_mov_b32 v92, 0
    v_mov_b32 v93, 0
    v_mov_b32 v94, 0
    v_mov_b32 v95, 0
    v_mov_b32 v96, 0
    v_mov_b32 v97, 0
    v_mov_b32 v98, 0
    v_mov_b32 v99, 0
    v_mov_b32 v100, 0
    v_mov_b32 v101, 0
    v_mov_b32 v102, 0
    v_mov_b32 v103, 0
    v_mov_b32 v104, 0
    v_mov_b32 v105, 0
    v_mov_b32 v106, 0
    v_mov_b32 v107, 0
    v_mov_b32 v108, 0
    v_mov_b32 v109, 0
    v_mov_b32 v110, 0
    v_mov_b32 v111, 0
    s_waitcnt vmcnt(24)
    s_barrier
    s_add_u32 s53, s46, s58
    s_add_u32 s54, s46, s59
    v_add_u32 v18, s53, v14
    v_add_u32 v22, s54, v14
    v_add_u32 v19, s53, v15
    v_add_u32 v23, s54, v15
    v_add_u32 v20, s53, v16
    v_add_u32 v24, s54, v16
    v_add_u32 v21, s53, v17
    v_add_u32 v25, s54, v17
    s_add_u32 s46, s46, 49152
    s_cmp_eq_u32 s46, 147456
    s_cselect_b32 s46, 0, s46
    ds_read_b128 v[64:67], v22 offset:0
    ds_read_b128 v[68:71], v22 offset:4096
    ds_read_b128 v[32:35], v18 offset:0
    ds_read_b128 v[36:39], v18 offset:4096
    ds_read_b128 v[40:43], v18 offset:8192
    ds_read_b128 v[44:47], v18 offset:12288
    s_mov_b32 s55, 14
Lg_1:
    ds_read_b128 v[72:75], v23 offset:0
    ds_read_b128 v[76:79], v23 offset:4096
    ds_read_b128 v[48:51], v19 offset:0
    ds_read_b128 v[52:55], v19 offset:4096
    ds_read_b128 v[56:59], v19 offset:8192
    ds_read_b128 v[60:63], v19 offset:12288
    s_waitcnt lgkmcnt(6)
    v_mfma_f32_16x16x32_bf16 v[80:83], v[64:67], v[32:35], v[80:83]
    s_add_u32 s51, s45, s49
    s_add_u32 s52, s45, s50
    v_mfma_f32_16x16x32_bf16 v[84:87], v[68:71], v[32:35], v[84:87]
    s_add_u32 m0, s51, 0
    s_nop 0
    buffer_load_dwordx4 v2, s[8:11], s47 offen lds
    v_mfma_f32_16x16x32_bf16 v[88:91], v[64:67], v[36:39], v[88:91]
    s_add_u32 m0, s51, 1024
    s_nop 0
    buffer_load_dwordx4 v3, s[8:11], s47 offen lds
    v_mfma_f32_16x16x32_bf16 v[92:95], v[68:71], v[36:39], v[92:95]
    s_add_u32 m0, s51, 2048
    s_nop 0
    buffer_load_dwordx4 v4, s[8:11], s47 offen lds
    v_mfma_f32_16x16x32_bf16 v[96:99], v[64:67], v[40:43], v[96:99]
    s_add_u32 m0, s51, 3072
    s_nop 0
    buffer_load_dwordx4 v5, s[8:11], s47 offen lds
    v_mfma_f32_16x16x32_bf16 v[100:103], v[68:71], v[40:43], v[100:103]
    s_add_u32 m0, s51, 4096
    s_nop 0
    buffer_load_dwordx4 v6, s[8:11], s47 offen lds
    v_mfma_f32_16x16x32_bf16 v[104:107], v[64:67], v[44:47], v[104:107]
    s_add_u32 m0, s51, 5120
    s_nop 0
    buffer_load_dwordx4 v7, s[8:11], s47 offen lds
    v_mfma_f32_16x16x32_bf16 v[108:111], v[68:71], v[44:47], v[108:111]
    s_add_u32 m0, s51, 6144
    s_nop 0
    buffer_load_dwordx4 v8, s[8:11], s47 offen lds
    ds_read_b128 v[64:67], v24 offset:0
    ds_read_b128 v[68:71], v24 offset:4096
    ds_read_b128 v[32:35], v20 offset:0
    ds_read_b128 v[36:39], v20 offset:4096
    ds_read_b128 v[40:43], v20 offset:8192
    ds_read_b128 v[44:47], v20 offset:12288
    s_waitcnt lgkmcnt(6)
    v_mfma_f32_16x16x32_bf16 v[80:83], v[72:75], v[48:51], v[80:83]
    s_add_u32 m0, s51, 7168
    s_nop 0
    buffer_load_dwordx4 v9, s[8:11], s47 offen lds
    v_mfma_f32_16x16x32_bf16 v[84:87], v[76:79], v[48:51], v[84:87]
    s_add_u32 m0, s52, 0
    s_nop 0
    buffer_load_dwordx4 v10, s[12:15], s48 offen lds
    v_mfma_f32_16x16x32_bf16 v[88:91], v[72:75], v[52:55], v[88:91]
    s_add_u32 m0, s52, 1024
    s_nop 0
    buffer_load_dwordx4 v11, s[12:15], s48 offen lds
    v_mfma_f32_16x16x32_bf16 v[92:95], v[76:79], v[52:55], v[92:95]
    s_add_u32 m0, s52, 2048
    s_nop 0
    buffer_load_dwordx4 v12, s[12:15], s48 offen lds
    v_mfma_f32_16x16x32_bf16 v[96:99], v[72:75], v[56:59], v[96:99]
    s_add_u32 m0, s52, 3072
    s_nop 0
    buffer_load_dwordx4 v13, s[12:15], s48 offen lds
    v_mfma_f32_16x16x32_bf16 v[100:103], v[76:79], v[56:59], v[100:103]
    s_add_u32 s47, s47, 256
    s_add_u32 s48, s48, 229376
    s_add_u32 s45, s45, 49152
    s_cmp_eq_u32 s45, 147456
    s_cselect_b32 s45, 0, s45
    v_mfma_f32_16x16x32_bf16 v[104:107], v[72:75], v[60:63], v[104:107]
    v_mfma_f32_16x16x32_bf16 v[108:111], v[76:79], v[60:63], v[108:111]
    ds_read_b128 v[72:75], v25 offset:0
    ds_read_b128 v[76:79], v25 offset:4096
    ds_read_b128 v[48:51], v21 offset:0
    ds_read_b128 v[52:55], v21 offset:4096
    ds_read_b128 v[56:59], v21 offset:8192
    ds_read_b128 v[60:63], v21 offset:12288
    s_waitcnt lgkmcnt(6)
    v_mfma_f32_16x16x32_bf16 v[80:83], v[64:67], v[32:35], v[80:83]
    v_mfma_f32_16x16x32_bf16 v[84:87], v[68:71], v[32:35], v[84:87]
    v_mfma_f32_16x16x32_bf16 v[88:91], v[64:67], v[36:39], v[88:91]
    v_mfma_f32_16x16x32_bf16 v[92:95], v[68:71], v[36:39], v[92:95]
    v_mfma_f32_16x16x32_bf16 v[96:99], v[64:67], v[40:43], v[96:99]
    v_mfma_f32_16x16x32_bf16 v[100:103], v[68:71], v[40:43], v[100:103]
    v_mfma_f32_16x16x32_bf16 v[104:107], v[64:67], v[44:47], v[104:107]
    v_mfma_f32_16x16x32_bf16 v[108:111], v[68:71], v[44:47], v[108:111]
    s_waitcnt vmcnt(12) lgkmcnt(0)
    s_barrier
    s_add_u32 s53, s46, s58
    s_add_u32 s54, s46, s59
    v_add_u32 v18, s53, v14
    v_add_u32 v22, s54, v14
    v_add_u32 v19, s53, v15
    v_add_u32 v23, s54, v15
    v_add_u32 v20, s53, v16
    v_add_u32 v24, s54, v16
    v_add_u32 v21, s53, v17
    v_add_u32 v25, s54, v17
    s_add_u32 s46, s46, 49152
    s_cmp_eq_u32 s46, 147456
    s_cselect_b32 s46, 0, s46
    ds_read_b128 v[64:67], v22 offset:0
    ds_read_b128 v[68:71], v22 offset:4096
    ds_read_b128 v[32:35], v18 offset:0
    ds_read_b128 v[36:39], v18 offset:4096
    ds_read_b128 v[40:43], v18 offset:8192
    ds_read_b128 v[44:47], v18 offset:12288
    v_mfma_f32_16x16x32_bf16 v[80:83], v[72:75], v[48:51], v[80:83]
    v_mfma_f32_16x16x32_bf16 v[84:87], v[76:79], v[48:51], v[84:87]
    v_mfma_f32_16x16x32_bf16 v[88:91], v[72:75], v[52:55], v[88:91]
    v_mfma_f32_16x16x32_bf16 v[92:95], v[76:79], v[52:55], v[92:95]
    v_mfma_f32_16x16x32_bf16 v[96:99], v[72:75], v[56:59], v[96:99]
    v_mfma_f32_16x16x32_bf16 v[100:103], v[76:79], v[56:59], v[100:103]
    v_mfma_f32_16x16x32_bf16 v[104:107], v[72:75], v[60:63], v[104:107]
    v_mfma_f32_16x16x32_bf16 v[108:111], v[76:79], v[60:63], v[108:111]
    s_sub_u32 s55, s55, 1
    s_cmp_lg_u32 s55, 0
    s_cbranch_scc1 Lg_1
    ds_read_b128 v[72:75], v23 offset:0
    ds_read_b128 v[76:79], v23 offset:4096
    ds_read_b128 v[48:51], v19 offset:0
    ds_read_b128 v[52:55], v19 offset:4096
    ds_read_b128 v[56:59], v19 offset:8192
    ds_read_b128 v[60:63], v19 offset:12288
    s_waitcnt lgkmcnt(6)
    v_mfma_f32_16x16x32_bf16 v[80:83], v[64:67], v[32:35], v[80:83]
    v_mfma_f32_16x16x32_bf16 v[84:87], v[68:71], v[32:35], v[84:87]
    v_mfma_f32_16x16x32_bf16 v[88:91], v[64:67], v[36:39], v[88:91]
    v_mfma_f32_16x16x32_bf16 v[92:95], v[68:71], v[36:39], v[92:95]
    v_mfma_f32_16x16x32_bf16 v[96:99], v[64:67], v[40:43], v[96:99]
    v_mfma_f32_16x16x32_bf16 v[100:103], v[68:71], v[40:43], v[100:103]
    v_mfma_f32_16x16x32_bf16 v[104:107], v[64:67], v[44:47], v[104:107]
    v_mfma_f32_16x16x32_bf16 v[108:111], v[68:71], v[44:47], v[108:111]
    ds_read_b128 v[64:67], v24 offset:0
    ds_read_b128 v[68:71], v24 offset:4096
    ds_read_b128 v[32:35], v20 offset:0
    ds_read_b128 v[36:39], v20 offset:4096
    ds_read_b128 v[40:43], v20 offset:8192
    ds_read_b128 v[44:47], v20 offset:12288
    s_waitcnt lgkmcnt(6)
    v_mfma_f32_16x16x32_bf16 v[80:83], v[72:75], v[48:51], v[80:83]
    v_mfma_f32_16x16x32_bf16 v[84:87], v[76:79], v[48:51], v[84:87]
    v_mfma_f32_16x16x32_bf16 v[88:91], v[72:75], v[52:55], v[88:91]
    v_mfma_f32_16x16x32_bf16 v[92:95], v[76:79], v[52:55], v[92:95]
    v_mfma_f32_16x16x32_bf16 v[96:99], v[72:75], v[56:59], v[96:99]
    v_mfma_f32_16x16x32_bf16 v[100:103], v[76:79], v[56:59], v[100:103]
    v_mfma_f32_16x16x32_bf16 v[104:107], v[72:75], v[60:63], v[104:107]
    v_mfma_f32_16x16x32_bf16 v[108:111], v[76:79], v[60:63], v[108:111]
    ds_read_b128 v[72:75], v25 offset:0
    ds_read_b128 v[76:79], v25 offset:4096
    ds_read_b128 v[48:51], v21 offset:0
    ds_read_b128 v[52:55], v21 offset:4096
    ds_read_b128 v[56:59], v21 offset:8192
    ds_read_b128 v[60:63], v21 offset:12288
    s_waitcnt lgkmcnt(6)
    v_mfma_f32_16x16x32_bf16 v[80:83], v[64:67], v[32:35], v[80:83]
    v_mfma_f32_16x16x32_bf16 v[84:87], v[68:71], v[32:35], v[84:87]
    v_mfma_f32_16x16x32_bf16 v[88:91], v[64:67], v[36:39], v[88:91]
    v_mfma_f32_16x16x32_bf16 v[92:95], v[68:71], v[36:39], v[92:95]
    v_mfma_f32_16x16x32_bf16 v[96:99], v[64:67], v[40:43], v[96:99]
    v_mfma_f32_16x16x32_bf16 v[100:103], v[68:71], v[40:43], v[100:103]
    v_mfma_f32_16x16x32_bf16 v[104:107], v[64:67], v[44:47], v[104:107]
    v_mfma_f32_16x16x32_bf16 v[108:111], v[68:71], v[44:47], v[108:111]
    s_waitcnt vmcnt(0) lgkmcnt(0)
    s_barrier
    s_add_u32 s53, s46, s58
    s_add_u32 s54, s46, s59
    v_add_u32 v18, s53, v14
    v_add_u32 v22, s54, v14
    v_add_u32 v19, s53, v15
    v_add_u32 v23, s54, v15
    v_add_u32 v20, s53, v16
    v_add_u32 v24, s54, v16
    v_add_u32 v21, s53, v17
    v_add_u32 v25, s54, v17
    s_add_u32 s46, s46, 49152
    s_cmp_eq_u32 s46, 147456
    s_cselect_b32 s46, 0, s46
    ds_read_b128 v[64:67], v22 offset:0
    ds_read_b128 v[68:71], v22 offset:4096
    ds_read_b128 v[32:35], v18 offset:0
    ds_read_b128 v[36:39], v18 offset:4096
    ds_read_b128 v[40:43], v18 offset:8192
    ds_read_b128 v[44:47], v18 offset:12288
    v_mfma_f32_16x16x32_bf16 v[80:83], v[72:75], v[48:51], v[80:83]
    v_mfma_f32_16x16x32_bf16 v[84:87], v[76:79], v[48:51], v[84:87]
    v_mfma_f32_16x16x32_bf16 v[88:91], v[72:75], v[52:55], v[88:91]
    v_mfma_f32_16x16x32_bf16 v[92:95], v[76:79], v[52:55], v[92:95]
    v_mfma_f32_16x16x32_bf16 v[96:99], v[72:75], v[56:59], v[96:99]
    v_mfma_f32_16x16x32_bf16 v[100:103], v[76:79], v[56:59], v[100:103]
    v_mfma_f32_16x16x32_bf16 v[104:107], v[72:75], v[60:63], v[104:107]
    v_mfma_f32_16x16x32_bf16 v[108:111], v[76:79], v[60:63], v[108:111]
    ds_read_b128 v[72:75], v23 offset:0
    ds_read_b128 v[76:79], v23 offset:4096
    ds_read_b128 v[48:51], v19 offset:0
    ds_read_b128 v[52:55], v19 offset:4096
    ds_read_b128 v[56:59], v19 offset:8192
    ds_read_b128 v[60:63], v19 offset:12288
    s_waitcnt lgkmcnt(6)
    v_mfma_f32_16x16x32_bf16 v[80:83], v[64:67], v[32:35], v[80:83]
    v_mfma_f32_16x16x32_bf16 v[84:87], v[68:71], v[32:35], v[84:87]
    v_mfma_f32_16x16x32_bf16 v[88:91], v[64:67], v[36:39], v[88:91]
    v_mfma_f32_16x16x32_bf16 v[92:95], v[68:71], v[36:39], v[92:95]
    v_mfma_f32_16x16x32_bf16 v[96:99], v[64:67], v[40:43], v[96:99]
    v_mfma_f32_16x16x32_bf16 v[100:103], v[68:71], v[40:43], v[100:103]
    v_mfma_f32_16x16x32_bf16 v[104:107], v[64:67], v[44:47], v[104:107]
    v_mfma_f32_16x16x32_bf16 v[108:111], v[68:71], v[44:47], v[108:111]
    ds_read_b128 v[64:67], v24 offset:0
    ds_read_b128 v[68:71], v24 offset:4096
    ds_read_b128 v[32:35], v20 offset:0
    ds_read_b128 v[36:39], v20 offset:4096
    ds_read_b128 v[40:43], v20 offset:8192
    ds_read_b128 v[44:47], v20 offset:12288
    s_waitcnt lgkmcnt(6)
    v_mfma_f32_16x16x32_bf16 v[80:83], v[72:75], v[48:51], v[80:83]
    v_mfma_f32_16x16x32_bf16 v[84:87], v[76:79], v[48:51], v[84:87]
    v_mfma_f32_16x16x32_bf16 v[88:91], v[72:75], v[52:55], v[88:91]
    v_mfma_f32_16x16x32_bf16 v[92:95], v[76:79], v[52:55], v[92:95]
    v_mfma_f32_16x16x32_bf16 v[96:99], v[72:75], v[56:59], v[96:99]
    v_mfma_f32_16x16x32_bf16 v[100:103], v[76:79], v[56:59], v[100:103]
    v_mfma_f32_16x16x32_bf16 v[104:107], v[72:75], v[60:63], v[104:107]
    v_mfma_f32_16x16x32_bf16 v[108:111], v[76:79], v[60:63], v[108:111]
    ds_read_b128 v[72:75], v25 offset:0
    ds_read_b128 v[76:79], v25 offset:4096
    ds_read_b128 v[48:51], v21 offset:0
    ds_read_b128 v[52:55], v21 offset:4096
    ds_read_b128 v[56:59], v21 offset:8192
    ds_read_b128 v[60:63], v21 offset:12288
    s_waitcnt lgkmcnt(6)
    v_mfma_f32_16x16x32_bf16 v[80:83], v[64:67], v[32:35], v[80:83]
    v_mfma_f32_16x16x32_bf16 v[84:87], v[68:71], v[32:35], v[84:87]
    v_mfma_f32_16x16x32_bf16 v[88:91], v[64:67], v[36:39], v[88:91]
    v_mfma_f32_16x16x32_bf16 v[92:95], v[68:71], v[36:39], v[92:95]
    v_mfma_f32_16x16x32_bf16 v[96:99], v[64:67], v[40:43], v[96:99]
    v_mfma_f32_16x16x32_bf16 v[100:103], v[68:71], v[40:43], v[100:103]
    v_mfma_f32_16x16x32_bf16 v[104:107], v[64:67], v[44:47], v[104:107]
    v_mfma_f32_16x16x32_bf16 v[108:111], v[68:71], v[44:47], v[108:111]
    s_waitcnt lgkmcnt(0)
    v_mfma_f32_16x16x32_bf16 v[80:83], v[72:75], v[48:51], v[80:83]
    v_mfma_f32_16x16x32_bf16 v[84:87], v[76:79], v[48:51], v[84:87]
    v_mfma_f32_16x16x32_bf16 v[88:91], v[72:75], v[52:55], v[88:91]
    v_mfma_f32_16x16x32_bf16 v[92:95], v[76:79], v[52:55], v[92:95]
    v_mfma_f32_16x16x32_bf16 v[96:99], v[72:75], v[56:59], v[96:99]
    v_mfma_f32_16x16x32_bf16 v[100:103], v[76:79], v[56:59], v[100:103]
    v_mfma_f32_16x16x32_bf16 v[104:107], v[72:75], v[60:63], v[104:107]
    v_mfma_f32_16x16x32_bf16 v[108:111], v[76:79], v[60:63], v[108:111]
    v_lshlrev_b32 v116, 16, v116
    v_lshlrev_b32 v117, 16, v117
    v_lshlrev_b32 v118, 16, v118
    v_lshlrev_b32 v119, 16, v119
    s_mov_b32 s51, 0
    v_cvt_pk_bf16_f32 v136, v80, v81
    v_lshlrev_b32 v80, 16, v136
    v_and_b32 v81, 0xffff0000, v136
    v_cvt_pk_bf16_f32 v137, v82, v83
    v_lshlrev_b32 v82, 16, v137
    v_and_b32 v83, 0xffff0000, v137
    v_cvt_pk_bf16_f32 v140, v84, v85
    v_lshlrev_b32 v84, 16, v140
    v_and_b32 v85, 0xffff0000, v140
    v_cvt_pk_bf16_f32 v141, v86, v87
    v_lshlrev_b32 v86, 16, v141
    v_and_b32 v87, 0xffff0000, v141
    v_add_f32 v80, v80, v116
    v_add_f32 v81, v81, v116
    v_add_f32 v82, v82, v116
    v_add_f32 v83, v83, v116
    v_add_f32 v84, v84, v116
    v_add_f32 v85, v85, v116
    v_add_f32 v86, v86, v116
    v_add_f32 v87, v87, v116
    v_cvt_pk_bf16_f32 v136, v80, v81
    v_lshlrev_b32 v80, 16, v136
    v_and_b32 v81, 0xffff0000, v136
    v_cvt_pk_bf16_f32 v137, v82, v83
    v_lshlrev_b32 v82, 16, v137
    v_and_b32 v83, 0xffff0000, v137
    v_cvt_pk_bf16_f32 v140, v84, v85
    v_lshlrev_b32 v84, 16, v140
    v_and_b32 v85, 0xffff0000, v140
    v_cvt_pk_bf16_f32 v141, v86, v87
    v_lshlrev_b32 v86, 16, v141
    v_and_b32 v87, 0xffff0000, v141
    v_lshlrev_b32 v136, 16, v120
    v_and_b32 v137, 0xffff0000, v120
    v_lshlrev_b32 v138, 16, v121
    v_and_b32 v139, 0xffff0000, v121
    v_lshlrev_b32 v140, 16, v122
    v_and_b32 v141, 0xffff0000, v122
    v_lshlrev_b32 v142, 16, v123
    v_and_b32 v143, 0xffff0000, v123
    v_mul_f32 v80, v80, v136
    v_mul_f32 v81, v81, v137
    v_mul_f32 v82, v82, v138
    v_mul_f32 v83, v83, v139
    v_mul_f32 v84, v84, v140
    v_mul_f32 v85, v85, v141
    v_mul_f32 v86, v86, v142
    v_mul_f32 v87, v87, v143
    v_cvt_pk_bf16_f32 v120, v80, v81
    v_cvt_pk_bf16_f32 v121, v82, v83
    v_cvt_pk_bf16_f32 v122, v84, v85
    v_cvt_pk_bf16_f32 v123, v86, v87
    s_nop 0
    v_permlane16_swap_b32 v120, v122
    v_permlane16_swap_b32 v121, v123
    buffer_store_dwordx4 v[120:123], v114, s[20:23], s51 offen
    s_mov_b32 s51, 43008
    v_cvt_pk_bf16_f32 v136, v88, v89
    v_lshlrev_b32 v88, 16, v136
    v_and_b32 v89, 0xffff0000, v136
    v_cvt_pk_bf16_f32 v137, v90, v91
    v_lshlrev_b32 v90, 16, v137
    v_and_b32 v91, 0xffff0000, v137
    v_cvt_pk_bf16_f32 v140, v92, v93
    v_lshlrev_b32 v92, 16, v140
    v_and_b32 v93, 0xffff0000, v140
    v_cvt_pk_bf16_f32 v141, v94, v95
    v_lshlrev_b32 v94, 16, v141
    v_and_b32 v95, 0xffff0000, v141
    v_add_f32 v88, v88, v117
    v_add_f32 v89, v89, v117
    v_add_f32 v90, v90, v117
    v_add_f32 v91, v91, v117
    v_add_f32 v92, v92, v117
    v_add_f32 v93, v93, v117
    v_add_f32 v94, v94, v117
    v_add_f32 v95, v95, v117
    v_cvt_pk_bf16_f32 v136, v88, v89
    v_lshlrev_b32 v88, 16, v136
    v_and_b32 v89, 0xffff0000, v136
    v_cvt_pk_bf16_f32 v137, v90, v91
    v_lshlrev_b32 v90, 16, v137
    v_and_b32 v91, 0xffff0000, v137
    v_cvt_pk_bf16_f32 v140, v92, v93
    v_lshlrev_b32 v92, 16, v140
    v_and_b32 v93, 0xffff0000, v140
    v_cvt_pk_bf16_f32 v141, v94, v95
    v_lshlrev_b32 v94, 16, v141
    v_and_b32 v95, 0xffff0000, v141
    v_lshlrev_b32 v136, 16, v124
    v_and_b32 v137, 0xffff0000, v124
    v_lshlrev_b32 v138, 16, v125
    v_and_b32 v139, 0xffff0000, v125
    v_lshlrev_b32 v140, 16, v126
    v_and_b32 v141, 0xffff0000, v126
    v_lshlrev_b32 v142, 16, v127
    v_and_b32 v143, 0xffff0000, v127
    v_mul_f32 v88, v88, v136
    v_mul_f32 v89, v89, v137
    v_mul_f32 v90, v90, v138
    v_mul_f32 v91, v91, v139
    v_mul_f32 v92, v92, v140
    v_mul_f32 v93, v93, v141
    v_mul_f32 v94, v94, v142
    v_mul_f32 v95, v95, v143
    v_cvt_pk_bf16_f32 v124, v88, v89
    v_cvt_pk_bf16_f32 v125, v90, v91
    v_cvt_pk_bf16_f32 v126, v92, v93
    v_cvt_pk_bf16_f32 v127, v94, v95
    s_nop 0
    v_permlane16_swap_b32 v124, v126
    v_permlane16_swap_b32 v125, v127
    buffer_store_dwordx4 v[124:127], v114, s[20:23], s51 offen
    s_mov_b32 s51, 86016
    v_cvt_pk_bf16_f32 v136, v96, v97
    v_lshlrev_b32 v96, 16, v136
    v_and_b32 v97, 0xffff0000, v136
    v_cvt_pk_bf16_f32 v137, v98, v99
    v_lshlrev_b32 v98, 16, v137
    v_and_b32 v99, 0xffff0000, v137
    v_cvt_pk_bf16_f32 v140, v100, v101
    v_lshlrev_b32 v100, 16, v140
    v_and_b32 v101, 0xffff0000, v140
    v_cvt_pk_bf16_f32 v141, v102, v103
    v_lshlrev_b32 v102, 16, v141
    v_and_b32 v103, 0xffff0000, v141
    v_add_f32 v96, v96, v118
    v_add_f32 v97, v97, v118
    v_add_f32 v98, v98, v118
    v_add_f32 v99, v99, v118
    v_add_f32 v100, v100, v118
    v_add_f32 v101, v101, v118
    v_add_f32 v102, v102, v118
    v_add_f32 v103, v103, v118
    v_cvt_pk_bf16_f32 v136, v96, v97
    v_lshlrev_b32 v96, 16, v136
    v_and_b32 v97, 0xffff0000, v136
    v_cvt_pk_bf16_f32 v137, v98, v99
    v_lshlrev_b32 v98, 16, v137
    v_and_b32 v99, 0xffff0000, v137
    v_cvt_pk_bf16_f32 v140, v100, v101
    v_lshlrev_b32 v100, 16, v140
    v_and_b32 v101, 0xffff0000, v140
    v_cvt_pk_bf16_f32 v141, v102, v103
    v_lshlrev_b32 v102, 16, v141
    v_and_b32 v103, 0xffff0000, v141
    v_lshlrev_b32 v136, 16, v128
    v_and_b32 v137, 0xffff0000, v128
    v_lshlrev_b32 v138, 16, v129
    v_and_b32 v139, 0xffff0000, v129
    v_lshlrev_b32 v140, 16, v130
    v_and_b32 v141, 0xffff0000, v130
    v_lshlrev_b32 v142, 16, v131
    v_and_b32 v143, 0xffff0000, v131
    v_mul_f32 v96, v96, v136
    v_mul_f32 v97, v97, v137
    v_mul_f32 v98, v98, v138
    v_mul_f32 v99, v99, v139
    v_mul_f32 v100, v100, v140
    v_mul_f32 v101, v101, v141
    v_mul_f32 v102, v102, v142
    v_mul_f32 v103, v103, v143
    v_cvt_pk_bf16_f32 v128, v96, v97
    v_cvt_pk_bf16_f32 v129, v98, v99
    v_cvt_pk_bf16_f32 v130, v100, v101
    v_cvt_pk_bf16_f32 v131, v102, v103
    s_nop 0
    v_permlane16_swap_b32 v128, v130
    v_permlane16_swap_b32 v129, v131
    buffer_store_dwordx4 v[128:131], v114, s[20:23], s51 offen
    s_mov_b32 s51, 129024
    v_cvt_pk_bf16_f32 v136, v104, v105
    v_lshlrev_b32 v104, 16, v136
    v_and_b32 v105, 0xffff0000, v136
    v_cvt_pk_bf16_f32 v137, v106, v107
    v_lshlrev_b32 v106, 16, v137
    v_and_b32 v107, 0xffff0000, v137
    v_cvt_pk_bf16_f32 v140, v108, v109
    v_lshlrev_b32 v108, 16, v140
    v_and_b32 v109, 0xffff0000, v140
    v_cvt_pk_bf16_f32 v141, v110, v111
    v_lshlrev_b32 v110, 16, v141
    v_and_b32 v111, 0xffff0000, v141
    v_add_f32 v104, v104, v119
    v_add_f32 v105, v105, v119
    v_add_f32 v106, v106, v119
    v_add_f32 v107, v107, v119
    v_add_f32 v108, v108, v119
    v_add_f32 v109, v109, v119
    v_add_f32 v110, v110, v119
    v_add_f32 v111, v111, v119
    v_cvt_pk_bf16_f32 v136, v104, v105
    v_lshlrev_b32 v104, 16, v136
    v_and_b32 v105, 0xffff0000, v136
    v_cvt_pk_bf16_f32 v137, v106, v107
    v_lshlrev_b32 v106, 16, v137
    v_and_b32 v107, 0xffff0000, v137
    v_cvt_pk_bf16_f32 v140, v108, v109
    v_lshlrev_b32 v108, 16, v140
    v_and_b32 v109, 0xffff0000, v140
    v_cvt_pk_bf16_f32 v141, v110, v111
    v_lshlrev_b32 v110, 16, v141
    v_and_b32 v111, 0xffff0000, v141
    v_lshlrev_b32 v136, 16, v132
    v_and_b32 v137, 0xffff0000, v132
    v_lshlrev_b32 v138, 16, v133
    v_and_b32 v139, 0xffff0000, v133
    v_lshlrev_b32 v140, 16, v134
    v_and_b32 v141, 0xffff0000, v134
    v_lshlrev_b32 v142, 16, v135
    v_and_b32 v143, 0xffff0000, v135
    v_mul_f32 v104, v104, v136
    v_mul_f32 v105, v105, v137
    v_mul_f32 v106, v106, v138
    v_mul_f32 v107, v107, v139
    v_mul_f32 v108, v108, v140
    v_mul_f32 v109, v109, v141
    v_mul_f32 v110, v110, v142
    v_mul_f32 v111, v111, v143
    v_cvt_pk_bf16_f32 v132, v104, v105
    v_cvt_pk_bf16_f32 v133, v106, v107
    v_cvt_pk_bf16_f32 v134, v108, v109
    v_cvt_pk_bf16_f32 v135, v110, v111
    s_nop 0
    v_permlane16_swap_b32 v132, v134
    v_permlane16_swap_b32 v133, v135
    buffer_store_dwordx4 v[132:135], v114, s[20:23], s51 offen
    s_nop 1
    s_branch K2_END
K2_SPARE:
    s_lshl_b32 s40, s36, 2
    s_add_u32 s40, s40, s37
    s_sub_u32 s40, s40, 28
    s_lshr_b32 s41, s40, 1
    s_and_b32 s42, s40, 1
    s_add_u32 s8, s32, 18874368
    s_addc_u32 s9, s33, 0
    s_mov_b32 s10, 4194304
    s_mov_b32 s11, 0x00020000
    s_add_u32 s12, s32, 14680064
    s_addc_u32 s13, s33, 0
    s_mov_b32 s14, 4194304
    s_mov_b32 s15, 0x00020000
    s_mov_b32 s20, s32
    s_mov_b32 s21, s33
    s_mov_b32 s22, 5505024
    s_mov_b32 s23, 0x00020000
    v_and_b32 v1, 63, v0
    v_lshrrev_b32 v2, 6, v0
    s_nop 0
    v_readfirstlane_b32 s43, v2
    s_lshl_b32 s44, s41, 13
    s_nop 0
    s_lshl_b32 s45, s43, 11
    s_add_u32 s44, s44, s45
    v_lshlrev_b32 v3, 4, v1
    v_add_u32 v3, s44, v3
    v_mov_b32 v8, 0
    v_mov_b32 v9, 0
    v_mov_b32 v10, 0
    v_mov_b32 v11, 0
    v_mov_b32 v12, 0
    v_mov_b32 v13, 0
    v_mov_b32 v14, 0
    v_mov_b32 v15, 0
    s_mov_b32 s46, 0
    buffer_load_dwordx4 v[16:19], v3, s[8:11], s46 offen
    buffer_load_dwordx4 v[20:23], v3, s[8:11], s46 offen offset:1024
    s_mov_b32 s46, 131072
    buffer_load_dwordx4 v[24:27], v3, s[8:11], s46 offen
    buffer_load_dwordx4 v[28:31], v3, s[8:11], s46 offen offset:1024
    s_mov_b32 s46, 262144
    buffer_load_dwordx4 v[32:35], v3, s[8:11], s46 offen
    buffer_load_dwordx4 v[36:39], v3, s[8:11], s46 offen offset:1024
    s_mov_b32 s46, 393216
    buffer_load_dwordx4 v[40:43], v3, s[8:11], s46 offen
    buffer_load_dwordx4 v[44:47], v3, s[8:11], s46 offen offset:1024
    s_mov_b32 s46, 524288
    buffer_load_dwordx4 v[48:51], v3, s[8:11], s46 offen
    buffer_load_dwordx4 v[52:55], v3, s[8:11], s46 offen offset:1024
    s_mov_b32 s46, 655360
    buffer_load_dwordx4 v[56:59], v3, s[8:11], s46 offen
    buffer_load_dwordx4 v[60:63], v3, s[8:11], s46 offen offset:1024
    s_mov_b32 s46, 786432
    buffer_load_dwordx4 v[64:67], v3, s[8:11], s46 offen
    buffer_load_dwordx4 v[68:71], v3, s[8:11], s46 offen offset:1024
    s_mov_b32 s46, 917504
    buffer_load_dwordx4 v[72:75], v3, s[8:11], s46 offen
    buffer_load_dwordx4 v[76:79], v3, s[8:11], s46 offen offset:1024
    s_waitcnt vmcnt(14)
    v_add_f32 v8, v8, v16
    v_add_f32 v9, v9, v17
    v_add_f32 v10, v10, v18
    v_add_f32 v11, v11, v19
    v_add_f32 v12, v12, v20
    v_add_f32 v13, v13, v21
    v_add_f32 v14, v14, v22
    v_add_f32 v15, v15, v23
    s_waitcnt vmcnt(12)
    v_add_f32 v8, v8, v24
    v_add_f32 v9, v9, v25
    v_add_f32 v10, v10, v26
    v_add_f32 v11, v11, v27
    v_add_f32 v12, v12, v28
    v_add_f32 v13, v13, v29
    v_add_f32 v14, v14, v30
    v_add_f32 v15, v15, v31
    s_waitcnt vmcnt(10)
    v_add_f32 v8, v8, v32
    v_add_f32 v9, v9, v33
    v_add_f32 v10, v10, v34
    v_add_f32 v11, v11, v35
    v_add_f32 v12, v12, v36
    v_add_f32 v13, v13, v37
    v_add_f32 v14, v14, v38
    v_add_f32 v15, v15, v39
    s_waitcnt vmcnt(8)
    v_add_f32 v8, v8, v40
    v_add_f32 v9, v9, v41
    v_add_f32 v10, v10, v42
    v_add_f32 v11, v11, v43
    v_add_f32 v12, v12, v44
    v_add_f32 v13, v13, v45
    v_add_f32 v14, v14, v46
    v_add_f32 v15, v15, v47
    s_waitcnt vmcnt(6)
    v_add_f32 v8, v8, v48
    v_add_f32 v9, v9, v49
    v_add_f32 v10, v10, v50
    v_add_f32 v11, v11, v51
    v_add_f32 v12, v12, v52
    v_add_f32 v13, v13, v53
    v_add_f32 v14, v14, v54
    v_add_f32 v15, v15, v55
    s_waitcnt vmcnt(4)
    v_add_f32 v8, v8, v56
    v_add_f32 v9, v9, v57
    v_add_f32 v10, v10, v58
    v_add_f32 v11, v11, v59
    v_add_f32 v12, v12, v60
    v_add_f32 v13, v13, v61
    v_add_f32 v14, v14, v62
    v_add_f32 v15, v15, v63
    s_waitcnt vmcnt(2)
    v_add_f32 v8, v8, v64
    v_add_f32 v9, v9, v65
    v_add_f32 v10, v10, v66
    v_add_f32 v11, v11, v67
    v_add_f32 v12, v12, v68
    v_add_f32 v13, v13, v69
    v_add_f32 v14, v14, v70
    v_add_f32 v15, v15, v71
    s_waitcnt vmcnt(0)
    v_add_f32 v8, v8, v72
    v_add_f32 v9, v9, v73
    v_add_f32 v10, v10, v74
    v_add_f32 v11, v11, v75
    v_add_f32 v12, v12, v76
    v_add_f32 v13, v13, v77
    v_add_f32 v14, v14, v78
    v_add_f32 v15, v15, v79
    s_mov_b32 s46, 1048576
    buffer_load_dwordx4 v[16:19], v3, s[8:11], s46 offen
    buffer_load_dwordx4 v[20:23], v3, s[8:11], s46 offen offset:1024
    s_mov_b32 s46, 1179648
    buffer_load_dwordx4 v[24:27], v3, s[8:11], s46 offen
    buffer_load_dwordx4 v[28:31], v3, s[8:11], s46 offen offset:1024
    s_mov_b32 s46, 1310720
    buffer_load_dwordx4 v[32:35], v3, s[8:11], s46 offen
    buffer_load_dwordx4 v[36:39], v3, s[8:11], s46 offen offset:1024
    s_mov_b32 s46, 1441792
    buffer_load_dwordx4 v[40:43], v3, s[8:11], s46 offen
    buffer_load_dwordx4 v[44:47], v3, s[8:11], s46 offen offset:1024
    s_mov_b32 s46, 1572864
    buffer_load_dwordx4 v[48:51], v3, s[8:11], s46 offen
    buffer_load_dwordx4 v[52:55], v3, s[8:11], s46 offen offset:1024
    s_mov_b32 s46, 1703936
    buffer_load_dwordx4 v[56:59], v3, s[8:11], s46 offen
    buffer_load_dwordx4 v[60:63], v3, s[8:11], s46 offen offset:1024
    s_mov_b32 s46, 1835008
    buffer_load_dwordx4 v[64:67], v3, s[8:11], s46 offen
    buffer_load_dwordx4 v[68:71], v3, s[8:11], s46 offen offset:1024
    s_mov_b32 s46, 1966080
    buffer_load_dwordx4 v[72:75], v3, s[8:11], s46 offen
    buffer_load_dwordx4 v[76:79], v3, s[8:11], s46 offen offset:1024
    s_waitcnt vmcnt(14)
    v_add_f32 v8, v8, v16
    v_add_f32 v9, v9, v17
    v_add_f32 v10, v10, v18
    v_add_f32 v11, v11, v19
    v_add_f32 v12, v12, v20
    v_add_f32 v13, v13, v21
    v_add_f32 v14, v14, v22
    v_add_f32 v15, v15, v23
    s_waitcnt vmcnt(12)
    v_add_f32 v8, v8, v24
    v_add_f32 v9, v9, v25
    v_add_f32 v10, v10, v26
    v_add_f32 v11, v11, v27
    v_add_f32 v12, v12, v28
    v_add_f32 v13, v13, v29
    v_add_f32 v14, v14, v30
    v_add_f32 v15, v15, v31
    s_waitcnt vmcnt(10)
    v_add_f32 v8, v8, v32
    v_add_f32 v9, v9, v33
    v_add_f32 v10, v10, v34
    v_add_f32 v11, v11, v35
    v_add_f32 v12, v12, v36
    v_add_f32 v13, v13, v37
    v_add_f32 v14, v14, v38
    v_add_f32 v15, v15, v39
    s_waitcnt vmcnt(8)
    v_add_f32 v8, v8, v40
    v_add_f32 v9, v9, v41
    v_add_f32 v10, v10, v42
    v_add_f32 v11, v11, v43
    v_add_f32 v12, v12, v44
    v_add_f32 v13, v13, v45
    v_add_f32 v14, v14, v46
    v_add_f32 v15, v15, v47
    s_waitcnt vmcnt(6)
    v_add_f32 v8, v8, v48
    v_add_f32 v9, v9, v49
    v_add_f32 v10, v10, v50
    v_add_f32 v11, v11, v51
    v_add_f32 v12, v12, v52
    v_add_f32 v13, v13, v53
    v_add_f32 v14, v14, v54
    v_add_f32 v15, v15, v55
    s_waitcnt vmcnt(4)
    v_add_f32 v8, v8, v56
    v_add_f32 v9, v9, v57
    v_add_f32 v10, v10, v58
    v_add_f32 v11, v11, v59
    v_add_f32 v12, v12, v60
    v_add_f32 v13, v13, v61
    v_add_f32 v14, v14, v62
    v_add_f32 v15, v15, v63
    s_waitcnt vmcnt(2)
    v_add_f32 v8, v8, v64
    v_add_f32 v9, v9, v65
    v_add_f32 v10, v10, v66
    v_add_f32 v11, v11, v67
    v_add_f32 v12, v12, v68
    v_add_f32 v13, v13, v69
    v_add_f32 v14, v14, v70
    v_add_f32 v15, v15, v71
    s_waitcnt vmcnt(0)
    v_add_f32 v8, v8, v72
    v_add_f32 v9, v9, v73
    v_add_f32 v10, v10, v74
    v_add_f32 v11, v11, v75
    v_add_f32 v12, v12, v76
    v_add_f32 v13, v13, v77
    v_add_f32 v14, v14, v78
    v_add_f32 v15, v15, v79
    s_mov_b32 s46, 2097152
    buffer_load_dwordx4 v[16:19], v3, s[8:11], s46 offen
    buffer_load_dwordx4 v[20:23], v3, s[8:11], s46 offen offset:1024
    s_mov_b32 s46, 2228224
    buffer_load_dwordx4 v[24:27], v3, s[8:11], s46 offen
    buffer_load_dwordx4 v[28:31], v3, s[8:11], s46 offen offset:1024
    s_mov_b32 s46, 2359296
    buffer_load_dwordx4 v[32:35], v3, s[8:11], s46 offen
    buffer_load_dwordx4 v[36:39], v3, s[8:11], s46 offen offset:1024
    s_mov_b32 s46, 2490368
    buffer_load_dwordx4 v[40:43], v3, s[8:11], s46 offen
    buffer_load_dwordx4 v[44:47], v3, s[8:11], s46 offen offset:1024
    s_mov_b32 s46, 2621440
    buffer_load_dwordx4 v[48:51], v3, s[8:11], s46 offen
    buffer_load_dwordx4 v[52:55], v3, s[8:11], s46 offen offset:1024
    s_mov_b32 s46, 2752512
    buffer_load_dwordx4 v[56:59], v3, s[8:11], s46 offen
    buffer_load_dwordx4 v[60:63], v3, s[8:11], s46 offen offset:1024
    s_mov_b32 s46, 2883584
    buffer_load_dwordx4 v[64:67], v3, s[8:11], s46 offen
    buffer_load_dwordx4 v[68:71], v3, s[8:11], s46 offen offset:1024
    s_mov_b32 s46, 3014656
    buffer_load_dwordx4 v[72:75], v3, s[8:11], s46 offen
    buffer_load_dwordx4 v[76:79], v3, s[8:11], s46 offen offset:1024
    s_waitcnt vmcnt(14)
    v_add_f32 v8, v8, v16
    v_add_f32 v9, v9, v17
    v_add_f32 v10, v10, v18
    v_add_f32 v11, v11, v19
    v_add_f32 v12, v12, v20
    v_add_f32 v13, v13, v21
    v_add_f32 v14, v14, v22
    v_add_f32 v15, v15, v23
    s_waitcnt vmcnt(12)
    v_add_f32 v8, v8, v24
    v_add_f32 v9, v9, v25
    v_add_f32 v10, v10, v26
    v_add_f32 v11, v11, v27
    v_add_f32 v12, v12, v28
    v_add_f32 v13, v13, v29
    v_add_f32 v14, v14, v30
    v_add_f32 v15, v15, v31
    s_waitcnt vmcnt(10)
    v_add_f32 v8, v8, v32
    v_add_f32 v9, v9, v33
    v_add_f32 v10, v10, v34
    v_add_f32 v11, v11, v35
    v_add_f32 v12, v12, v36
    v_add_f32 v13, v13, v37
    v_add_f32 v14, v14, v38
    v_add_f32 v15, v15, v39
    s_waitcnt vmcnt(8)
    v_add_f32 v8, v8, v40
    v_add_f32 v9, v9, v41
    v_add_f32 v10, v10, v42
    v_add_f32 v11, v11, v43
    v_add_f32 v12, v12, v44
    v_add_f32 v13, v13, v45
    v_add_f32 v14, v14, v46
    v_add_f32 v15, v15, v47
    s_waitcnt vmcnt(6)
    v_add_f32 v8, v8, v48
    v_add_f32 v9, v9, v49
    v_add_f32 v10, v10, v50
    v_add_f32 v11, v11, v51
    v_add_f32 v12, v12, v52
    v_add_f32 v13, v13, v53
    v_add_f32 v14, v14, v54
    v_add_f32 v15, v15, v55
    s_waitcnt vmcnt(4)
    v_add_f32 v8, v8, v56
    v_add_f32 v9, v9, v57
    v_add_f32 v10, v10, v58
    v_add_f32 v11, v11, v59
    v_add_f32 v12, v12, v60
    v_add_f32 v13, v13, v61
    v_add_f32 v14, v14, v62
    v_add_f32 v15, v15, v63
    s_waitcnt vmcnt(2)
    v_add_f32 v8, v8, v64
    v_add_f32 v9, v9, v65
    v_add_f32 v10, v10, v66
    v_add_f32 v11, v11, v67
    v_add_f32 v12, v12, v68
    v_add_f32 v13, v13, v69
    v_add_f32 v14, v14, v70
    v_add_f32 v15, v15, v71
    s_waitcnt vmcnt(0)
    v_add_f32 v8, v8, v72
    v_add_f32 v9, v9, v73
    v_add_f32 v10, v10, v74
    v_add_f32 v11, v11, v75
    v_add_f32 v12, v12, v76
    v_add_f32 v13, v13, v77
    v_add_f32 v14, v14, v78
    v_add_f32 v15, v15, v79
    s_mov_b32 s46, 3145728
    buffer_load_dwordx4 v[16:19], v3, s[8:11], s46 offen
    buffer_load_dwordx4 v[20:23], v3, s[8:11], s46 offen offset:1024
    s_mov_b32 s46, 3276800
    buffer_load_dwordx4 v[24:27], v3, s[8:11], s46 offen
    buffer_load_dwordx4 v[28:31], v3, s[8:11], s46 offen offset:1024
    s_mov_b32 s46, 3407872
    buffer_load_dwordx4 v[32:35], v3, s[8:11], s46 offen
    buffer_load_dwordx4 v[36:39], v3, s[8:11], s46 offen offset:1024
    s_mov_b32 s46, 3538944
    buffer_load_dwordx4 v[40:43], v3, s[8:11], s46 offen
    buffer_load_dwordx4 v[44:47], v3, s[8:11], s46 offen offset:1024
    s_mov_b32 s46, 3670016
    buffer_load_dwordx4 v[48:51], v3, s[8:11], s46 offen
    buffer_load_dwordx4 v[52:55], v3, s[8:11], s46 offen offset:1024
    s_mov_b32 s46, 3801088
    buffer_load_dwordx4 v[56:59], v3, s[8:11], s46 offen
    buffer_load_dwordx4 v[60:63], v3, s[8:11], s46 offen offset:1024
    s_mov_b32 s46, 3932160
    buffer_load_dwordx4 v[64:67], v3, s[8:11], s46 offen
    buffer_load_dwordx4 v[68:71], v3, s[8:11], s46 offen offset:1024
    s_mov_b32 s46, 4063232
    buffer_load_dwordx4 v[72:75], v3, s[8:11], s46 offen
    buffer_load_dwordx4 v[76:79], v3, s[8:11], s46 offen offset:1024
    s_waitcnt vmcnt(14)
    v_add_f32 v8, v8, v16
    v_add_f32 v9, v9, v17
    v_add_f32 v10, v10, v18
    v_add_f32 v11, v11, v19
    v_add_f32 v12, v12, v20
    v_add_f32 v13, v13, v21
    v_add_f32 v14, v14, v22
    v_add_f32 v15, v15, v23
    s_waitcnt vmcnt(12)
    v_add_f32 v8, v8, v24
    v_add_f32 v9, v9, v25
    v_add_f32 v10, v10, v26
    v_add_f32 v11, v11, v27
    v_add_f32 v12, v12, v28
    v_add_f32 v13, v13, v29
    v_add_f32 v14, v14, v30
    v_add_f32 v15, v15, v31
    s_waitcnt vmcnt(10)
    v_add_f32 v8, v8, v32
    v_add_f32 v9, v9, v33
    v_add_f32 v10, v10, v34
    v_add_f32 v11, v11, v35
    v_add_f32 v12, v12, v36
    v_add_f32 v13, v13, v37
    v_add_f32 v14, v14, v38
    v_add_f32 v15, v15, v39
    s_waitcnt vmcnt(8)
    v_add_f32 v8, v8, v40
    v_add_f32 v9, v9, v41
    v_add_f32 v10, v10, v42
    v_add_f32 v11, v11, v43
    v_add_f32 v12, v12, v44
    v_add_f32 v13, v13, v45
    v_add_f32 v14, v14, v46
    v_add_f32 v15, v15, v47
    s_waitcnt vmcnt(6)
    v_add_f32 v8, v8, v48
    v_add_f32 v9, v9, v49
    v_add_f32 v10, v10, v50
    v_add_f32 v11, v11, v51
    v_add_f32 v12, v12, v52
    v_add_f32 v13, v13, v53
    v_add_f32 v14, v14, v54
    v_add_f32 v15, v15, v55
    s_waitcnt vmcnt(4)
    v_add_f32 v8, v8, v56
    v_add_f32 v9, v9, v57
    v_add_f32 v10, v10, v58
    v_add_f32 v11, v11, v59
    v_add_f32 v12, v12, v60
    v_add_f32 v13, v13, v61
    v_add_f32 v14, v14, v62
    v_add_f32 v15, v15, v63
    s_waitcnt vmcnt(2)
    v_add_f32 v8, v8, v64
    v_add_f32 v9, v9, v65
    v_add_f32 v10, v10, v66
    v_add_f32 v11, v11, v67
    v_add_f32 v12, v12, v68
    v_add_f32 v13, v13, v69
    v_add_f32 v14, v14, v70
    v_add_f32 v15, v15, v71
    s_waitcnt vmcnt(0)
    v_add_f32 v8, v8, v72
    v_add_f32 v9, v9, v73
    v_add_f32 v10, v10, v74
    v_add_f32 v11, v11, v75
    v_add_f32 v12, v12, v76
    v_add_f32 v13, v13, v77
    v_add_f32 v14, v14, v78
    v_add_f32 v15, v15, v79
    v_cvt_pk_bf16_f32 v16, v8, v9
    v_cvt_pk_bf16_f32 v17, v10, v11
    v_cvt_pk_bf16_f32 v18, v12, v13
    v_cvt_pk_bf16_f32 v19, v14, v15
    s_lshl_b32 s46, s43, 10
    v_lshlrev_b32 v4, 3, v1
    v_add_u32 v5, s46, v4
    ds_write_b64 v5, v[16:17]
    ds_write_b64 v5, v[18:19] offset:512
    s_waitcnt lgkmcnt(0)
    s_barrier
    ds_read_b64 v[8:9], v4 offset:0
    ds_read_b64 v[10:11], v4 offset:1024
    ds_read_b64 v[12:13], v4 offset:2048
    ds_read_b64 v[14:15], v4 offset:3072
    ds_read_b64 v[16:17], v4 offset:512
    ds_read_b64 v[18:19], v4 offset:1536
    ds_read_b64 v[20:21], v4 offset:2560
    ds_read_b64 v[22:23], v4 offset:3584
    s_lshl_b32 s46, s42, 10
    s_lshl_b32 s47, s43, 8
    s_add_u32 s46, s46, s47
    v_and_b32 v5, 15, v1
    v_add_u32 v5, s46, v5
    v_lshrrev_b32 v6, 4, v1
    v_lshlrev_b32 v7, 11, v5
    v_lshlrev_b32 v24, 4, v6
    v_add_u32 v7, v7, v24
    s_lshl_b32 s47, s41, 7
    v_add_u32 v7, s47, v7
    v_mul_u32_u24 v25, 2688, v5
    v_lshlrev_b32 v24, 3, v6
    v_add_u32 v25, v25, v24
    s_mul_i32 s47, s41, 56
    v_add_u32 v25, s47, v25
    v_add_u32 v26, 32, v25
    v_cmp_eq_u32 vcc, 3, v6
    v_mov_b32 v27, 2130706432
    s_nop 0
    v_cndmask_b32 v26, v26, v27, vcc
    v_and_b32 v27, 15, v1
    v_add_u32 v27, 48, v27
    v_lshlrev_b32 v27, 2, v27
    s_mov_b32 s48, 0x358637bd
    s_mov_b32 s47, 0
    buffer_load_dwordx4 v[32:35], v7, s[12:15], s47 offen
    buffer_load_dwordx4 v[36:39], v7, s[12:15], s47 offen offset:64
    s_mov_b32 s47, 32768
    buffer_load_dwordx4 v[40:43], v7, s[12:15], s47 offen
    buffer_load_dwordx4 v[44:47], v7, s[12:15], s47 offen offset:64
    s_mov_b32 s47, 65536
    buffer_load_dwordx4 v[48:51], v7, s[12:15], s47 offen
    buffer_load_dwordx4 v[52:55], v7, s[12:15], s47 offen offset:64
    s_mov_b32 s47, 98304
    buffer_load_dwordx4 v[56:59], v7, s[12:15], s47 offen
    buffer_load_dwordx4 v[60:63], v7, s[12:15], s47 offen offset:64
    s_mov_b32 s47, 131072
    buffer_load_dwordx4 v[64:67], v7, s[12:15], s47 offen
    buffer_load_dwordx4 v[68:71], v7, s[12:15], s47 offen offset:64
    s_mov_b32 s47, 163840
    buffer_load_dwordx4 v[72:75], v7, s[12:15], s47 offen
    buffer_load_dwordx4 v[76:79], v7, s[12:15], s47 offen offset:64
    s_mov_b32 s47, 196608
    buffer_load_dwordx4 v[80:83], v7, s[12:15], s47 offen
    buffer_load_dwordx4 v[84:87], v7, s[12:15], s47 offen offset:64
    s_mov_b32 s47, 229376
    buffer_load_dwordx4 v[88:91], v7, s[12:15], s47 offen
    buffer_load_dwordx4 v[92:95], v7, s[12:15], s47 offen offset:64
    s_waitcnt lgkmcnt(0)
    s_waitcnt vmcnt(0)
    v_mfma_f32_16x16x32_bf16 v[96:99], v[8:11], v[32:35], 0
    v_mfma_f32_16x16x32_bf16 v[96:99], v[12:15], v[36:39], v[96:99]
    v_mfma_f32_16x16x32_bf16 v[100:103], v[16:19], v[32:35], 0
    v_mfma_f32_16x16x32_bf16 v[100:103], v[20:23], v[36:39], v[100:103]
    s_nop 5
    v_cvt_pk_bf16_f32 v104, v96, v97
    v_lshlrev_b32 v96, 16, v104
    v_and_b32 v97, 0xffff0000, v104
    v_cvt_pk_bf16_f32 v104, v98, v99
    v_lshlrev_b32 v98, 16, v104
    v_and_b32 v99, 0xffff0000, v104
    v_cvt_pk_bf16_f32 v104, v100, v101
    v_lshlrev_b32 v100, 16, v104
    v_and_b32 v101, 0xffff0000, v104
    v_cvt_pk_bf16_f32 v104, v102, v103
    v_lshlrev_b32 v102, 16, v104
    v_and_b32 v103, 0xffff0000, v104
    ds_bpermute_b32 v105, v27, v100
    s_waitcnt lgkmcnt(0)
    v_add_f32 v105, s48, v105
    v_cvt_pk_bf16_f32 v105, v105, v105
    v_lshlrev_b32 v105, 16, v105
    v_rcp_f32 v105, v105
    s_nop 0
    v_mul_f32 v96, v96, v105
    v_mul_f32 v97, v97, v105
    v_mul_f32 v98, v98, v105
    v_mul_f32 v99, v99, v105
    v_mul_f32 v100, v100, v105
    v_mul_f32 v101, v101, v105
    v_mul_f32 v102, v102, v105
    v_mul_f32 v103, v103, v105
    v_cvt_pk_bf16_f32 v106, v96, v97
    v_cvt_pk_bf16_f32 v107, v98, v99
    v_cvt_pk_bf16_f32 v108, v100, v101
    v_cvt_pk_bf16_f32 v109, v102, v103
    s_mov_b32 s47, 0
    buffer_store_dwordx2 v[106:107], v25, s[20:23], s47 offen
    buffer_store_dwordx2 v[108:109], v26, s[20:23], s47 offen
    v_mfma_f32_16x16x32_bf16 v[96:99], v[8:11], v[40:43], 0
    v_mfma_f32_16x16x32_bf16 v[96:99], v[12:15], v[44:47], v[96:99]
    v_mfma_f32_16x16x32_bf16 v[100:103], v[16:19], v[40:43], 0
    v_mfma_f32_16x16x32_bf16 v[100:103], v[20:23], v[44:47], v[100:103]
    s_nop 5
    v_cvt_pk_bf16_f32 v104, v96, v97
    v_lshlrev_b32 v96, 16, v104
    v_and_b32 v97, 0xffff0000, v104
    v_cvt_pk_bf16_f32 v104, v98, v99
    v_lshlrev_b32 v98, 16, v104
    v_and_b32 v99, 0xffff0000, v104
    v_cvt_pk_bf16_f32 v104, v100, v101
    v_lshlrev_b32 v100, 16, v104
    v_and_b32 v101, 0xffff0000, v104
    v_cvt_pk_bf16_f32 v104, v102, v103
    v_lshlrev_b32 v102, 16, v104
    v_and_b32 v103, 0xffff0000, v104
    ds_bpermute_b32 v105, v27, v100
    s_waitcnt lgkmcnt(0)
    v_add_f32 v105, s48, v105
    v_cvt_pk_bf16_f32 v105, v105, v105
    v_lshlrev_b32 v105, 16, v105
    v_rcp_f32 v105, v105
    s_nop 0
    v_mul_f32 v96, v96, v105
    v_mul_f32 v97, v97, v105
    v_mul_f32 v98, v98, v105
    v_mul_f32 v99, v99, v105
    v_mul_f32 v100, v100, v105
    v_mul_f32 v101, v101, v105
    v_mul_f32 v102, v102, v105
    v_mul_f32 v103, v103, v105
    v_cvt_pk_bf16_f32 v106, v96, v97
    v_cvt_pk_bf16_f32 v107, v98, v99
    v_cvt_pk_bf16_f32 v108, v100, v101
    v_cvt_pk_bf16_f32 v109, v102, v103
    s_mov_b32 s47, 43008
    buffer_store_dwordx2 v[106:107], v25, s[20:23], s47 offen
    buffer_store_dwordx2 v[108:109], v26, s[20:23], s47 offen
    v_mfma_f32_16x16x32_bf16 v[96:99], v[8:11], v[48:51], 0
    v_mfma_f32_16x16x32_bf16 v[96:99], v[12:15], v[52:55], v[96:99]
    v_mfma_f32_16x16x32_bf16 v[100:103], v[16:19], v[48:51], 0
    v_mfma_f32_16x16x32_bf16 v[100:103], v[20:23], v[52:55], v[100:103]
    s_nop 5
    v_cvt_pk_bf16_f32 v104, v96, v97
    v_lshlrev_b32 v96, 16, v104
    v_and_b32 v97, 0xffff0000, v104
    v_cvt_pk_bf16_f32 v104, v98, v99
    v_lshlrev_b32 v98, 16, v104
    v_and_b32 v99, 0xffff0000, v104
    v_cvt_pk_bf16_f32 v104, v100, v101
    v_lshlrev_b32 v100, 16, v104
    v_and_b32 v101, 0xffff0000, v104
    v_cvt_pk_bf16_f32 v104, v102, v103
    v_lshlrev_b32 v102, 16, v104
    v_and_b32 v103, 0xffff0000, v104
    ds_bpermute_b32 v105, v27, v100
    s_waitcnt lgkmcnt(0)
    v_add_f32 v105, s48, v105
    v_cvt_pk_bf16_f32 v105, v105, v105
    v_lshlrev_b32 v105, 16, v105
    v_rcp_f32 v105, v105
    s_nop 0
    v_mul_f32 v96, v96, v105
    v_mul_f32 v97, v97, v105
    v_mul_f32 v98, v98, v105
    v_mul_f32 v99, v99, v105
    v_mul_f32 v100, v100, v105
    v_mul_f32 v101, v101, v105
    v_mul_f32 v102, v102, v105
    v_mul_f32 v103, v103, v105
    v_cvt_pk_bf16_f32 v106, v96, v97
    v_cvt_pk_bf16_f32 v107, v98, v99
    v_cvt_pk_bf16_f32 v108, v100, v101
    v_cvt_pk_bf16_f32 v109, v102, v103
    s_mov_b32 s47, 86016
    buffer_store_dwordx2 v[106:107], v25, s[20:23], s47 offen
    buffer_store_dwordx2 v[108:109], v26, s[20:23], s47 offen
    v_mfma_f32_16x16x32_bf16 v[96:99], v[8:11], v[56:59], 0
    v_mfma_f32_16x16x32_bf16 v[96:99], v[12:15], v[60:63], v[96:99]
    v_mfma_f32_16x16x32_bf16 v[100:103], v[16:19], v[56:59], 0
    v_mfma_f32_16x16x32_bf16 v[100:103], v[20:23], v[60:63], v[100:103]
    s_nop 5
    v_cvt_pk_bf16_f32 v104, v96, v97
    v_lshlrev_b32 v96, 16, v104
    v_and_b32 v97, 0xffff0000, v104
    v_cvt_pk_bf16_f32 v104, v98, v99
    v_lshlrev_b32 v98, 16, v104
    v_and_b32 v99, 0xffff0000, v104
    v_cvt_pk_bf16_f32 v104, v100, v101
    v_lshlrev_b32 v100, 16, v104
    v_and_b32 v101, 0xffff0000, v104
    v_cvt_pk_bf16_f32 v104, v102, v103
    v_lshlrev_b32 v102, 16, v104
    v_and_b32 v103, 0xffff0000, v104
    ds_bpermute_b32 v105, v27, v100
    s_waitcnt lgkmcnt(0)
    v_add_f32 v105, s48, v105
    v_cvt_pk_bf16_f32 v105, v105, v105
    v_lshlrev_b32 v105, 16, v105
    v_rcp_f32 v105, v105
    s_nop 0
    v_mul_f32 v96, v96, v105
    v_mul_f32 v97, v97, v105
    v_mul_f32 v98, v98, v105
    v_mul_f32 v99, v99, v105
    v_mul_f32 v100, v100, v105
    v_mul_f32 v101, v101, v105
    v_mul_f32 v102, v102, v105
    v_mul_f32 v103, v103, v105
    v_cvt_pk_bf16_f32 v106, v96, v97
    v_cvt_pk_bf16_f32 v107, v98, v99
    v_cvt_pk_bf16_f32 v108, v100, v101
    v_cvt_pk_bf16_f32 v109, v102, v103
    s_mov_b32 s47, 129024
    buffer_store_dwordx2 v[106:107], v25, s[20:23], s47 offen
    buffer_store_dwordx2 v[108:109], v26, s[20:23], s47 offen
    v_mfma_f32_16x16x32_bf16 v[96:99], v[8:11], v[64:67], 0
    v_mfma_f32_16x16x32_bf16 v[96:99], v[12:15], v[68:71], v[96:99]
    v_mfma_f32_16x16x32_bf16 v[100:103], v[16:19], v[64:67], 0
    v_mfma_f32_16x16x32_bf16 v[100:103], v[20:23], v[68:71], v[100:103]
    s_nop 5
    v_cvt_pk_bf16_f32 v104, v96, v97
    v_lshlrev_b32 v96, 16, v104
    v_and_b32 v97, 0xffff0000, v104
    v_cvt_pk_bf16_f32 v104, v98, v99
    v_lshlrev_b32 v98, 16, v104
    v_and_b32 v99, 0xffff0000, v104
    v_cvt_pk_bf16_f32 v104, v100, v101
    v_lshlrev_b32 v100, 16, v104
    v_and_b32 v101, 0xffff0000, v104
    v_cvt_pk_bf16_f32 v104, v102, v103
    v_lshlrev_b32 v102, 16, v104
    v_and_b32 v103, 0xffff0000, v104
    ds_bpermute_b32 v105, v27, v100
    s_waitcnt lgkmcnt(0)
    v_add_f32 v105, s48, v105
    v_cvt_pk_bf16_f32 v105, v105, v105
    v_lshlrev_b32 v105, 16, v105
    v_rcp_f32 v105, v105
    s_nop 0
    v_mul_f32 v96, v96, v105
    v_mul_f32 v97, v97, v105
    v_mul_f32 v98, v98, v105
    v_mul_f32 v99, v99, v105
    v_mul_f32 v100, v100, v105
    v_mul_f32 v101, v101, v105
    v_mul_f32 v102, v102, v105
    v_mul_f32 v103, v103, v105
    v_cvt_pk_bf16_f32 v106, v96, v97
    v_cvt_pk_bf16_f32 v107, v98, v99
    v_cvt_pk_bf16_f32 v108, v100, v101
    v_cvt_pk_bf16_f32 v109, v102, v103
    s_mov_b32 s47, 172032
    buffer_store_dwordx2 v[106:107], v25, s[20:23], s47 offen
    buffer_store_dwordx2 v[108:109], v26, s[20:23], s47 offen
    v_mfma_f32_16x16x32_bf16 v[96:99], v[8:11], v[72:75], 0
    v_mfma_f32_16x16x32_bf16 v[96:99], v[12:15], v[76:79], v[96:99]
    v_mfma_f32_16x16x32_bf16 v[100:103], v[16:19], v[72:75], 0
    v_mfma_f32_16x16x32_bf16 v[100:103], v[20:23], v[76:79], v[100:103]
    s_nop 5
    v_cvt_pk_bf16_f32 v104, v96, v97
    v_lshlrev_b32 v96, 16, v104
    v_and_b32 v97, 0xffff0000, v104
    v_cvt_pk_bf16_f32 v104, v98, v99
    v_lshlrev_b32 v98, 16, v104
    v_and_b32 v99, 0xffff0000, v104
    v_cvt_pk_bf16_f32 v104, v100, v101
    v_lshlrev_b32 v100, 16, v104
    v_and_b32 v101, 0xffff0000, v104
    v_cvt_pk_bf16_f32 v104, v102, v103
    v_lshlrev_b32 v102, 16, v104
    v_and_b32 v103, 0xffff0000, v104
    ds_bpermute_b32 v105, v27, v100
    s_waitcnt lgkmcnt(0)
    v_add_f32 v105, s48, v105
    v_cvt_pk_bf16_f32 v105, v105, v105
    v_lshlrev_b32 v105, 16, v105
    v_rcp_f32 v105, v105
    s_nop 0
    v_mul_f32 v96, v96, v105
    v_mul_f32 v97, v97, v105
    v_mul_f32 v98, v98, v105
    v_mul_f32 v99, v99, v105
    v_mul_f32 v100, v100, v105
    v_mul_f32 v101, v101, v105
    v_mul_f32 v102, v102, v105
    v_mul_f32 v103, v103, v105
    v_cvt_pk_bf16_f32 v106, v96, v97
    v_cvt_pk_bf16_f32 v107, v98, v99
    v_cvt_pk_bf16_f32 v108, v100, v101
    v_cvt_pk_bf16_f32 v109, v102, v103
    s_mov_b32 s47, 215040
    buffer_store_dwordx2 v[106:107], v25, s[20:23], s47 offen
    buffer_store_dwordx2 v[108:109], v26, s[20:23], s47 offen
    v_mfma_f32_16x16x32_bf16 v[96:99], v[8:11], v[80:83], 0
    v_mfma_f32_16x16x32_bf16 v[96:99], v[12:15], v[84:87], v[96:99]
    v_mfma_f32_16x16x32_bf16 v[100:103], v[16:19], v[80:83], 0
    v_mfma_f32_16x16x32_bf16 v[100:103], v[20:23], v[84:87], v[100:103]
    s_nop 5
    v_cvt_pk_bf16_f32 v104, v96, v97
    v_lshlrev_b32 v96, 16, v104
    v_and_b32 v97, 0xffff0000, v104
    v_cvt_pk_bf16_f32 v104, v98, v99
    v_lshlrev_b32 v98, 16, v104
    v_and_b32 v99, 0xffff0000, v104
    v_cvt_pk_bf16_f32 v104, v100, v101
    v_lshlrev_b32 v100, 16, v104
    v_and_b32 v101, 0xffff0000, v104
    v_cvt_pk_bf16_f32 v104, v102, v103
    v_lshlrev_b32 v102, 16, v104
    v_and_b32 v103, 0xffff0000, v104
    ds_bpermute_b32 v105, v27, v100
    s_waitcnt lgkmcnt(0)
    v_add_f32 v105, s48, v105
    v_cvt_pk_bf16_f32 v105, v105, v105
    v_lshlrev_b32 v105, 16, v105
    v_rcp_f32 v105, v105
    s_nop 0
    v_mul_f32 v96, v96, v105
    v_mul_f32 v97, v97, v105
    v_mul_f32 v98, v98, v105
    v_mul_f32 v99, v99, v105
    v_mul_f32 v100, v100, v105
    v_mul_f32 v101, v101, v105
    v_mul_f32 v102, v102, v105
    v_mul_f32 v103, v103, v105
    v_cvt_pk_bf16_f32 v106, v96, v97
    v_cvt_pk_bf16_f32 v107, v98, v99
    v_cvt_pk_bf16_f32 v108, v100, v101
    v_cvt_pk_bf16_f32 v109, v102, v103
    s_mov_b32 s47, 258048
    buffer_store_dwordx2 v[106:107], v25, s[20:23], s47 offen
    buffer_store_dwordx2 v[108:109], v26, s[20:23], s47 offen
    v_mfma_f32_16x16x32_bf16 v[96:99], v[8:11], v[88:91], 0
    v_mfma_f32_16x16x32_bf16 v[96:99], v[12:15], v[92:95], v[96:99]
    v_mfma_f32_16x16x32_bf16 v[100:103], v[16:19], v[88:91], 0
    v_mfma_f32_16x16x32_bf16 v[100:103], v[20:23], v[92:95], v[100:103]
    s_nop 5
    v_cvt_pk_bf16_f32 v104, v96, v97
    v_lshlrev_b32 v96, 16, v104
    v_and_b32 v97, 0xffff0000, v104
    v_cvt_pk_bf16_f32 v104, v98, v99
    v_lshlrev_b32 v98, 16, v104
    v_and_b32 v99, 0xffff0000, v104
    v_cvt_pk_bf16_f32 v104, v100, v101
    v_lshlrev_b32 v100, 16, v104
    v_and_b32 v101, 0xffff0000, v104
    v_cvt_pk_bf16_f32 v104, v102, v103
    v_lshlrev_b32 v102, 16, v104
    v_and_b32 v103, 0xffff0000, v104
    ds_bpermute_b32 v105, v27, v100
    s_waitcnt lgkmcnt(0)
    v_add_f32 v105, s48, v105
    v_cvt_pk_bf16_f32 v105, v105, v105
    v_lshlrev_b32 v105, 16, v105
    v_rcp_f32 v105, v105
    s_nop 0
    v_mul_f32 v96, v96, v105
    v_mul_f32 v97, v97, v105
    v_mul_f32 v98, v98, v105
    v_mul_f32 v99, v99, v105
    v_mul_f32 v100, v100, v105
    v_mul_f32 v101, v101, v105
    v_mul_f32 v102, v102, v105
    v_mul_f32 v103, v103, v105
    v_cvt_pk_bf16_f32 v106, v96, v97
    v_cvt_pk_bf16_f32 v107, v98, v99
    v_cvt_pk_bf16_f32 v108, v100, v101
    v_cvt_pk_bf16_f32 v109, v102, v103
    s_mov_b32 s47, 301056
    buffer_store_dwordx2 v[106:107], v25, s[20:23], s47 offen
    buffer_store_dwordx2 v[108:109], v26, s[20:23], s47 offen
    s_mov_b32 s47, 262144
    buffer_load_dwordx4 v[32:35], v7, s[12:15], s47 offen
    buffer_load_dwordx4 v[36:39], v7, s[12:15], s47 offen offset:64
    s_mov_b32 s47, 294912
    buffer_load_dwordx4 v[40:43], v7, s[12:15], s47 offen
    buffer_load_dwordx4 v[44:47], v7, s[12:15], s47 offen offset:64
    s_mov_b32 s47, 327680
    buffer_load_dwordx4 v[48:51], v7, s[12:15], s47 offen
    buffer_load_dwordx4 v[52:55], v7, s[12:15], s47 offen offset:64
    s_mov_b32 s47, 360448
    buffer_load_dwordx4 v[56:59], v7, s[12:15], s47 offen
    buffer_load_dwordx4 v[60:63], v7, s[12:15], s47 offen offset:64
    s_mov_b32 s47, 393216
    buffer_load_dwordx4 v[64:67], v7, s[12:15], s47 offen
    buffer_load_dwordx4 v[68:71], v7, s[12:15], s47 offen offset:64
    s_mov_b32 s47, 425984
    buffer_load_dwordx4 v[72:75], v7, s[12:15], s47 offen
    buffer_load_dwordx4 v[76:79], v7, s[12:15], s47 offen offset:64
    s_mov_b32 s47, 458752
    buffer_load_dwordx4 v[80:83], v7, s[12:15], s47 offen
    buffer_load_dwordx4 v[84:87], v7, s[12:15], s47 offen offset:64
    s_mov_b32 s47, 491520
    buffer_load_dwordx4 v[88:91], v7, s[12:15], s47 offen
    buffer_load_dwordx4 v[92:95], v7, s[12:15], s47 offen offset:64
    s_waitcnt lgkmcnt(0)
    s_waitcnt vmcnt(0)
    v_mfma_f32_16x16x32_bf16 v[96:99], v[8:11], v[32:35], 0
    v_mfma_f32_16x16x32_bf16 v[96:99], v[12:15], v[36:39], v[96:99]
    v_mfma_f32_16x16x32_bf16 v[100:103], v[16:19], v[32:35], 0
    v_mfma_f32_16x16x32_bf16 v[100:103], v[20:23], v[36:39], v[100:103]
    s_nop 5
    v_cvt_pk_bf16_f32 v104, v96, v97
    v_lshlrev_b32 v96, 16, v104
    v_and_b32 v97, 0xffff0000, v104
    v_cvt_pk_bf16_f32 v104, v98, v99
    v_lshlrev_b32 v98, 16, v104
    v_and_b32 v99, 0xffff0000, v104
    v_cvt_pk_bf16_f32 v104, v100, v101
    v_lshlrev_b32 v100, 16, v104
    v_and_b32 v101, 0xffff0000, v104
    v_cvt_pk_bf16_f32 v104, v102, v103
    v_lshlrev_b32 v102, 16, v104
    v_and_b32 v103, 0xffff0000, v104
    ds_bpermute_b32 v105, v27, v100
    s_waitcnt lgkmcnt(0)
    v_add_f32 v105, s48, v105
    v_cvt_pk_bf16_f32 v105, v105, v105
    v_lshlrev_b32 v105, 16, v105
    v_rcp_f32 v105, v105
    s_nop 0
    v_mul_f32 v96, v96, v105
    v_mul_f32 v97, v97, v105
    v_mul_f32 v98, v98, v105
    v_mul_f32 v99, v99, v105
    v_mul_f32 v100, v100, v105
    v_mul_f32 v101, v101, v105
    v_mul_f32 v102, v102, v105
    v_mul_f32 v103, v103, v105
    v_cvt_pk_bf16_f32 v106, v96, v97
    v_cvt_pk_bf16_f32 v107, v98, v99
    v_cvt_pk_bf16_f32 v108, v100, v101
    v_cvt_pk_bf16_f32 v109, v102, v103
    s_mov_b32 s47, 344064
    buffer_store_dwordx2 v[106:107], v25, s[20:23], s47 offen
    buffer_store_dwordx2 v[108:109], v26, s[20:23], s47 offen
    v_mfma_f32_16x16x32_bf16 v[96:99], v[8:11], v[40:43], 0
    v_mfma_f32_16x16x32_bf16 v[96:99], v[12:15], v[44:47], v[96:99]
    v_mfma_f32_16x16x32_bf16 v[100:103], v[16:19], v[40:43], 0
    v_mfma_f32_16x16x32_bf16 v[100:103], v[20:23], v[44:47], v[100:103]
    s_nop 5
    v_cvt_pk_bf16_f32 v104, v96, v97
    v_lshlrev_b32 v96, 16, v104
    v_and_b32 v97, 0xffff0000, v104
    v_cvt_pk_bf16_f32 v104, v98, v99
    v_lshlrev_b32 v98, 16, v104
    v_and_b32 v99, 0xffff0000, v104
    v_cvt_pk_bf16_f32 v104, v100, v101
    v_lshlrev_b32 v100, 16, v104
    v_and_b32 v101, 0xffff0000, v104
    v_cvt_pk_bf16_f32 v104, v102, v103
    v_lshlrev_b32 v102, 16, v104
    v_and_b32 v103, 0xffff0000, v104
    ds_bpermute_b32 v105, v27, v100
    s_waitcnt lgkmcnt(0)
    v_add_f32 v105, s48, v105
    v_cvt_pk_bf16_f32 v105, v105, v105
    v_lshlrev_b32 v105, 16, v105
    v_rcp_f32 v105, v105
    s_nop 0
    v_mul_f32 v96, v96, v105
    v_mul_f32 v97, v97, v105
    v_mul_f32 v98, v98, v105
    v_mul_f32 v99, v99, v105
    v_mul_f32 v100, v100, v105
    v_mul_f32 v101, v101, v105
    v_mul_f32 v102, v102, v105
    v_mul_f32 v103, v103, v105
    v_cvt_pk_bf16_f32 v106, v96, v97
    v_cvt_pk_bf16_f32 v107, v98, v99
    v_cvt_pk_bf16_f32 v108, v100, v101
    v_cvt_pk_bf16_f32 v109, v102, v103
    s_mov_b32 s47, 387072
    buffer_store_dwordx2 v[106:107], v25, s[20:23], s47 offen
    buffer_store_dwordx2 v[108:109], v26, s[20:23], s47 offen
    v_mfma_f32_16x16x32_bf16 v[96:99], v[8:11], v[48:51], 0
    v_mfma_f32_16x16x32_bf16 v[96:99], v[12:15], v[52:55], v[96:99]
    v_mfma_f32_16x16x32_bf16 v[100:103], v[16:19], v[48:51], 0
    v_mfma_f32_16x16x32_bf16 v[100:103], v[20:23], v[52:55], v[100:103]
    s_nop 5
    v_cvt_pk_bf16_f32 v104, v96, v97
    v_lshlrev_b32 v96, 16, v104
    v_and_b32 v97, 0xffff0000, v104
    v_cvt_pk_bf16_f32 v104, v98, v99
    v_lshlrev_b32 v98, 16, v104
    v_and_b32 v99, 0xffff0000, v104
    v_cvt_pk_bf16_f32 v104, v100, v101
    v_lshlrev_b32 v100, 16, v104
    v_and_b32 v101, 0xffff0000, v104
    v_cvt_pk_bf16_f32 v104, v102, v103
    v_lshlrev_b32 v102, 16, v104
    v_and_b32 v103, 0xffff0000, v104
    ds_bpermute_b32 v105, v27, v100
    s_waitcnt lgkmcnt(0)
    v_add_f32 v105, s48, v105
    v_cvt_pk_bf16_f32 v105, v105, v105
    v_lshlrev_b32 v105, 16, v105
    v_rcp_f32 v105, v105
    s_nop 0
    v_mul_f32 v96, v96, v105
    v_mul_f32 v97, v97, v105
    v_mul_f32 v98, v98, v105
    v_mul_f32 v99, v99, v105
    v_mul_f32 v100, v100, v105
    v_mul_f32 v101, v101, v105
    v_mul_f32 v102, v102, v105
    v_mul_f32 v103, v103, v105
    v_cvt_pk_bf16_f32 v106, v96, v97
    v_cvt_pk_bf16_f32 v107, v98, v99
    v_cvt_pk_bf16_f32 v108, v100, v101
    v_cvt_pk_bf16_f32 v109, v102, v103
    s_mov_b32 s47, 430080
    buffer_store_dwordx2 v[106:107], v25, s[20:23], s47 offen
    buffer_store_dwordx2 v[108:109], v26, s[20:23], s47 offen
    v_mfma_f32_16x16x32_bf16 v[96:99], v[8:11], v[56:59], 0
    v_mfma_f32_16x16x32_bf16 v[96:99], v[12:15], v[60:63], v[96:99]
    v_mfma_f32_16x16x32_bf16 v[100:103], v[16:19], v[56:59], 0
    v_mfma_f32_16x16x32_bf16 v[100:103], v[20:23], v[60:63], v[100:103]
    s_nop 5
    v_cvt_pk_bf16_f32 v104, v96, v97
    v_lshlrev_b32 v96, 16, v104
    v_and_b32 v97, 0xffff0000, v104
    v_cvt_pk_bf16_f32 v104, v98, v99
    v_lshlrev_b32 v98, 16, v104
    v_and_b32 v99, 0xffff0000, v104
    v_cvt_pk_bf16_f32 v104, v100, v101
    v_lshlrev_b32 v100, 16, v104
    v_and_b32 v101, 0xffff0000, v104
    v_cvt_pk_bf16_f32 v104, v102, v103
    v_lshlrev_b32 v102, 16, v104
    v_and_b32 v103, 0xffff0000, v104
    ds_bpermute_b32 v105, v27, v100
    s_waitcnt lgkmcnt(0)
    v_add_f32 v105, s48, v105
    v_cvt_pk_bf16_f32 v105, v105, v105
    v_lshlrev_b32 v105, 16, v105
    v_rcp_f32 v105, v105
    s_nop 0
    v_mul_f32 v96, v96, v105
    v_mul_f32 v97, v97, v105
    v_mul_f32 v98, v98, v105
    v_mul_f32 v99, v99, v105
    v_mul_f32 v100, v100, v105
    v_mul_f32 v101, v101, v105
    v_mul_f32 v102, v102, v105
    v_mul_f32 v103, v103, v105
    v_cvt_pk_bf16_f32 v106, v96, v97
    v_cvt_pk_bf16_f32 v107, v98, v99
    v_cvt_pk_bf16_f32 v108, v100, v101
    v_cvt_pk_bf16_f32 v109, v102, v103
    s_mov_b32 s47, 473088
    buffer_store_dwordx2 v[106:107], v25, s[20:23], s47 offen
    buffer_store_dwordx2 v[108:109], v26, s[20:23], s47 offen
    v_mfma_f32_16x16x32_bf16 v[96:99], v[8:11], v[64:67], 0
    v_mfma_f32_16x16x32_bf16 v[96:99], v[12:15], v[68:71], v[96:99]
    v_mfma_f32_16x16x32_bf16 v[100:103], v[16:19], v[64:67], 0
    v_mfma_f32_16x16x32_bf16 v[100:103], v[20:23], v[68:71], v[100:103]
    s_nop 5
    v_cvt_pk_bf16_f32 v104, v96, v97
    v_lshlrev_b32 v96, 16, v104
    v_and_b32 v97, 0xffff0000, v104
    v_cvt_pk_bf16_f32 v104, v98, v99
    v_lshlrev_b32 v98, 16, v104
    v_and_b32 v99, 0xffff0000, v104
    v_cvt_pk_bf16_f32 v104, v100, v101
    v_lshlrev_b32 v100, 16, v104
    v_and_b32 v101, 0xffff0000, v104
    v_cvt_pk_bf16_f32 v104, v102, v103
    v_lshlrev_b32 v102, 16, v104
    v_and_b32 v103, 0xffff0000, v104
    ds_bpermute_b32 v105, v27, v100
    s_waitcnt lgkmcnt(0)
    v_add_f32 v105, s48, v105
    v_cvt_pk_bf16_f32 v105, v105, v105
    v_lshlrev_b32 v105, 16, v105
    v_rcp_f32 v105, v105
    s_nop 0
    v_mul_f32 v96, v96, v105
    v_mul_f32 v97, v97, v105
    v_mul_f32 v98, v98, v105
    v_mul_f32 v99, v99, v105
    v_mul_f32 v100, v100, v105
    v_mul_f32 v101, v101, v105
    v_mul_f32 v102, v102, v105
    v_mul_f32 v103, v103, v105
    v_cvt_pk_bf16_f32 v106, v96, v97
    v_cvt_pk_bf16_f32 v107, v98, v99
    v_cvt_pk_bf16_f32 v108, v100, v101
    v_cvt_pk_bf16_f32 v109, v102, v103
    s_mov_b32 s47, 516096
    buffer_store_dwordx2 v[106:107], v25, s[20:23], s47 offen
    buffer_store_dwordx2 v[108:109], v26, s[20:23], s47 offen
    v_mfma_f32_16x16x32_bf16 v[96:99], v[8:11], v[72:75], 0
    v_mfma_f32_16x16x32_bf16 v[96:99], v[12:15], v[76:79], v[96:99]
    v_mfma_f32_16x16x32_bf16 v[100:103], v[16:19], v[72:75], 0
    v_mfma_f32_16x16x32_bf16 v[100:103], v[20:23], v[76:79], v[100:103]
    s_nop 5
    v_cvt_pk_bf16_f32 v104, v96, v97
    v_lshlrev_b32 v96, 16, v104
    v_and_b32 v97, 0xffff0000, v104
    v_cvt_pk_bf16_f32 v104, v98, v99
    v_lshlrev_b32 v98, 16, v104
    v_and_b32 v99, 0xffff0000, v104
    v_cvt_pk_bf16_f32 v104, v100, v101
    v_lshlrev_b32 v100, 16, v104
    v_and_b32 v101, 0xffff0000, v104
    v_cvt_pk_bf16_f32 v104, v102, v103
    v_lshlrev_b32 v102, 16, v104
    v_and_b32 v103, 0xffff0000, v104
    ds_bpermute_b32 v105, v27, v100
    s_waitcnt lgkmcnt(0)
    v_add_f32 v105, s48, v105
    v_cvt_pk_bf16_f32 v105, v105, v105
    v_lshlrev_b32 v105, 16, v105
    v_rcp_f32 v105, v105
    s_nop 0
    v_mul_f32 v96, v96, v105
    v_mul_f32 v97, v97, v105
    v_mul_f32 v98, v98, v105
    v_mul_f32 v99, v99, v105
    v_mul_f32 v100, v100, v105
    v_mul_f32 v101, v101, v105
    v_mul_f32 v102, v102, v105
    v_mul_f32 v103, v103, v105
    v_cvt_pk_bf16_f32 v106, v96, v97
    v_cvt_pk_bf16_f32 v107, v98, v99
    v_cvt_pk_bf16_f32 v108, v100, v101
    v_cvt_pk_bf16_f32 v109, v102, v103
    s_mov_b32 s47, 559104
    buffer_store_dwordx2 v[106:107], v25, s[20:23], s47 offen
    buffer_store_dwordx2 v[108:109], v26, s[20:23], s47 offen
    v_mfma_f32_16x16x32_bf16 v[96:99], v[8:11], v[80:83], 0
    v_mfma_f32_16x16x32_bf16 v[96:99], v[12:15], v[84:87], v[96:99]
    v_mfma_f32_16x16x32_bf16 v[100:103], v[16:19], v[80:83], 0
    v_mfma_f32_16x16x32_bf16 v[100:103], v[20:23], v[84:87], v[100:103]
    s_nop 5
    v_cvt_pk_bf16_f32 v104, v96, v97
    v_lshlrev_b32 v96, 16, v104
    v_and_b32 v97, 0xffff0000, v104
    v_cvt_pk_bf16_f32 v104, v98, v99
    v_lshlrev_b32 v98, 16, v104
    v_and_b32 v99, 0xffff0000, v104
    v_cvt_pk_bf16_f32 v104, v100, v101
    v_lshlrev_b32 v100, 16, v104
    v_and_b32 v101, 0xffff0000, v104
    v_cvt_pk_bf16_f32 v104, v102, v103
    v_lshlrev_b32 v102, 16, v104
    v_and_b32 v103, 0xffff0000, v104
    ds_bpermute_b32 v105, v27, v100
    s_waitcnt lgkmcnt(0)
    v_add_f32 v105, s48, v105
    v_cvt_pk_bf16_f32 v105, v105, v105
    v_lshlrev_b32 v105, 16, v105
    v_rcp_f32 v105, v105
    s_nop 0
    v_mul_f32 v96, v96, v105
    v_mul_f32 v97, v97, v105
    v_mul_f32 v98, v98, v105
    v_mul_f32 v99, v99, v105
    v_mul_f32 v100, v100, v105
    v_mul_f32 v101, v101, v105
    v_mul_f32 v102, v102, v105
    v_mul_f32 v103, v103, v105
    v_cvt_pk_bf16_f32 v106, v96, v97
    v_cvt_pk_bf16_f32 v107, v98, v99
    v_cvt_pk_bf16_f32 v108, v100, v101
    v_cvt_pk_bf16_f32 v109, v102, v103
    s_mov_b32 s47, 602112
    buffer_store_dwordx2 v[106:107], v25, s[20:23], s47 offen
    buffer_store_dwordx2 v[108:109], v26, s[20:23], s47 offen
    v_mfma_f32_16x16x32_bf16 v[96:99], v[8:11], v[88:91], 0
    v_mfma_f32_16x16x32_bf16 v[96:99], v[12:15], v[92:95], v[96:99]
    v_mfma_f32_16x16x32_bf16 v[100:103], v[16:19], v[88:91], 0
    v_mfma_f32_16x16x32_bf16 v[100:103], v[20:23], v[92:95], v[100:103]
    s_nop 5
    v_cvt_pk_bf16_f32 v104, v96, v97
    v_lshlrev_b32 v96, 16, v104
    v_and_b32 v97, 0xffff0000, v104
    v_cvt_pk_bf16_f32 v104, v98, v99
    v_lshlrev_b32 v98, 16, v104
    v_and_b32 v99, 0xffff0000, v104
    v_cvt_pk_bf16_f32 v104, v100, v101
    v_lshlrev_b32 v100, 16, v104
    v_and_b32 v101, 0xffff0000, v104
    v_cvt_pk_bf16_f32 v104, v102, v103
    v_lshlrev_b32 v102, 16, v104
    v_and_b32 v103, 0xffff0000, v104
    ds_bpermute_b32 v105, v27, v100
    s_waitcnt lgkmcnt(0)
    v_add_f32 v105, s48, v105
    v_cvt_pk_bf16_f32 v105, v105, v105
    v_lshlrev_b32 v105, 16, v105
    v_rcp_f32 v105, v105
    s_nop 0
    v_mul_f32 v96, v96, v105
    v_mul_f32 v97, v97, v105
    v_mul_f32 v98, v98, v105
    v_mul_f32 v99, v99, v105
    v_mul_f32 v100, v100, v105
    v_mul_f32 v101, v101, v105
    v_mul_f32 v102, v102, v105
    v_mul_f32 v103, v103, v105
    v_cvt_pk_bf16_f32 v106, v96, v97
    v_cvt_pk_bf16_f32 v107, v98, v99
    v_cvt_pk_bf16_f32 v108, v100, v101
    v_cvt_pk_bf16_f32 v109, v102, v103
    s_mov_b32 s47, 645120
    buffer_store_dwordx2 v[106:107], v25, s[20:23], s47 offen
    buffer_store_dwordx2 v[108:109], v26, s[20:23], s47 offen
    s_nop 1
K2_END:
K2_EXIT:
    s_endpgm
.globl k3_final_kernel
.p2align 8
.type k3_final_kernel,@function
k3_final_kernel:
    s_cmp_ge_u32 s2, 224 + 32
    s_cbranch_scc1 K3_EXIT
    s_load_dwordx2 s[4:5], s[0:1], 0
    s_load_dwordx2 s[6:7], s[0:1], 72
    s_load_dwordx2 s[32:33], s[0:1], 88
    s_and_b32 s36, s2, 7
    s_lshr_b32 s37, s2, 3
    s_mul_i32 s38, s37, 37
    s_lshr_b32 s38, s38, 8
    s_mul_i32 s39, s38, 7
    s_sub_u32 s39, s37, s39
    s_cmp_ge_u32 s37, 28
    s_cbranch_scc1 K3_END
    s_lshl_b32 s40, s36, 2
    s_add_u32 s38, s38, s40
    s_lshl_b32 s40, s38, 6
    s_lshl_b32 s41, s39, 6
    s_waitcnt lgkmcnt(0)
    s_mov_b32 s8, s32
    s_mov_b32 s9, s33
    s_mov_b32 s10, 5505024
    s_mov_b32 s11, 0x00020000
    s_add_u32 s12, s32, 23068672
    s_addc_u32 s13, s33, 0
    s_mov_b32 s14, 1204224
    s_mov_b32 s15, 0x00020000
    s_mov_b32 s16, s4
    s_mov_b32 s17, s5
    s_mov_b32 s18, 1835008
    s_mov_b32 s19, 0x00020000
    s_mov_b32 s20, s6
    s_mov_b32 s21, s7
    s_mov_b32 s22, 1835008
    s_mov_b32 s23, 0x00020000
    v_and_b32 v1, 63, v0
    v_lshrrev_b32 v12, 6, v0
    s_nop 0
    v_readfirstlane_b32 s44, v12
    s_nop 1
    s_lshr_b32 s56, s44, 1
    s_and_b32 s57, s44, 1
    v_lshrrev_b32 v12, 3, v1
    v_and_b32 v13, 7, v1
    s_mul_i32 s51, s44, 16
    s_add_u32 s52, s51, s40
    s_mov_b32 s53, 2688
    v_add_u32 v14, 0, v12
    v_add_u32 v2, s52, v14
    v_mul_lo_u32 v2, v2, s53
    v_add_u32 v14, s51, v14
    v_and_b32 v14, 7, v14
    v_xor_b32 v14, v14, v13
    v_lshl_add_u32 v2, v14, 4, v2
    v_add_u32 v14, 8, v12
    v_add_u32 v3, s52, v14
    v_mul_lo_u32 v3, v3, s53
    v_add_u32 v14, s51, v14
    v_and_b32 v14, 7, v14
    v_xor_b32 v14, v14, v13
    v_lshl_add_u32 v3, v14, 4, v3
    s_mul_i32 s51, s44, 16
    s_add_u32 s52, s51, s41
    s_mov_b32 s53, 2688
    v_add_u32 v14, 0, v12
    v_add_u32 v4, s52, v14
    v_mul_lo_u32 v4, v4, s53
    v_add_u32 v14, s51, v14
    v_and_b32 v14, 7, v14
    v_xor_b32 v14, v14, v13
    v_lshl_add_u32 v4, v14, 4, v4
    v_add_u32 v14, 8, v12
    v_add_u32 v5, s52, v14
    v_mul_lo_u32 v5, v5, s53
    v_add_u32 v14, s51, v14
    v_and_b32 v14, 7, v14
    v_xor_b32 v14, v14, v13
    v_lshl_add_u32 v5, v14, 4, v5
    s_mul_i32 s49, s44, 2048
    s_mul_i32 s50, s44, 2048
    s_add_u32 s50, s50, 8192
    v_lshrrev_b32 v12, 4, v1
    v_and_b32 v13, 15, v1
    v_and_b32 v14, 7, v13
    v_add_u32 v6, 0, v12
    v_xor_b32 v6, v6, v14
    v_lshlrev_b32 v6, 4, v6
    v_lshl_add_u32 v6, v13, 7, v6
    v_add_u32 v7, 4, v12
    v_xor_b32 v7, v7, v14
    v_lshlrev_b32 v7, 4, v7
    v_lshl_add_u32 v7, v13, 7, v7
    s_mul_i32 s58, s56, 4096
    s_mul_i32 s59, s57, 4096
    s_add_u32 s59, s59, 8192
    s_mov_b32 s45, 0
    s_mov_b32 s46, 0
    s_mov_b32 s47, 0
    s_mov_b32 s48, 0
    s_add_u32 s51, s45, s49
    s_add_u32 s52, s45, s50
    s_add_u32 m0, s51, 0
    s_nop 0
    buffer_load_dwordx4 v2, s[8:11], s47 offen lds
    s_add_u32 m0, s51, 1024
    s_nop 0
    buffer_load_dwordx4 v3, s[8:11], s47 offen lds
    s_add_u32 m0, s52, 0
    s_nop 0
    buffer_load_dwordx4 v4, s[12:15], s47 offen lds
    s_add_u32 m0, s52, 1024
    s_nop 0
    buffer_load_dwordx4 v5, s[12:15], s47 offen lds
    s_add_u32 s47, s47, 128
    s_add_u32 s45, s45, 16384
    s_cmp_eq_u32 s45, 98304
    s_cselect_b32 s45, 0, s45
    s_add_u32 s51, s45, s49
    s_add_u32 s52, s45, s50
    s_add_u32 m0, s51, 0
    s_nop 0
    buffer_load_dwordx4 v2, s[8:11], s47 offen lds
    s_add_u32 m0, s51, 1024
    s_nop 0
    buffer_load_dwordx4 v3, s[8:11], s47 offen lds
    s_add_u32 m0, s52, 0
    s_nop 0
    buffer_load_dwordx4 v4, s[12:15], s47 offen lds
    s_add_u32 m0, s52, 1024
    s_nop 0
    buffer_load_dwordx4 v5, s[12:15], s47 offen lds
    s_add_u32 s47, s47, 128
    s_add_u32 s45, s45, 16384
    s_cmp_eq_u32 s45, 98304
    s_cselect_b32 s45, 0, s45
    s_add_u32 s51, s45, s49
    s_add_u32 s52, s45, s50
    s_add_u32 m0, s51, 0
    s_nop 0
    buffer_load_dwordx4 v2, s[8:11], s47 offen lds
    s_add_u32 m0, s51, 1024
    s_nop 0
    buffer_load_dwordx4 v3, s[8:11], s47 offen lds
    s_add_u32 m0, s52, 0
    s_nop 0
    buffer_load_dwordx4 v4, s[12:15], s47 offen lds
    s_add_u32 m0, s52, 1024
    s_nop 0
    buffer_load_dwordx4 v5, s[12:15], s47 offen lds
    s_add_u32 s47, s47, 128
    s_add_u32 s45, s45, 16384
    s_cmp_eq_u32 s45, 98304
    s_cselect_b32 s45, 0, s45
    s_add_u32 s51, s45, s49
    s_add_u32 s52, s45, s50
    s_add_u32 m0, s51, 0
    s_nop 0
    buffer_load_dwordx4 v2, s[8:11], s47 offen lds
    s_add_u32 m0, s51, 1024
    s_nop 0
    buffer_load_dwordx4 v3, s[8:11], s47 offen lds
    s_add_u32 m0, s52, 0
    s_nop 0
    buffer_load_dwordx4 v4, s[12:15], s47 offen lds
    s_add_u32 m0, s52, 1024
    s_nop 0
    buffer_load_dwordx4 v5, s[12:15], s47 offen lds
    s_add_u32 s47, s47, 128
    s_add_u32 s45, s45, 16384
    s_cmp_eq_u32 s45, 98304
    s_cselect_b32 s45, 0, s45
    s_add_u32 s51, s45, s49
    s_add_u32 s52, s45, s50
    s_add_u32 m0, s51, 0
    s_nop 0
    buffer_load_dwordx4 v2, s[8:11], s47 offen lds
    s_add_u32 m0, s51, 1024
    s_nop 0
    buffer_load_dwordx4 v3, s[8:11], s47 offen lds
    s_add_u32 m0, s52, 0
    s_nop 0
    buffer_load_dwordx4 v4, s[12:15], s47 offen lds
    s_add_u32 m0, s52, 1024
    s_nop 0
    buffer_load_dwordx4 v5, s[12:15], s47 offen lds
    s_add_u32 s47, s47, 128
    s_add_u32 s45, s45, 16384
    s_cmp_eq_u32 s45, 98304
    s_cselect_b32 s45, 0, s45
    v_mov_b32 v48, 0
    v_mov_b32 v49, 0
    v_mov_b32 v50, 0
    v_mov_b32 v51, 0
    v_mov_b32 v52, 0
    v_mov_b32 v53, 0
    v_mov_b32 v54, 0
    v_mov_b32 v55, 0
    v_mov_b32 v56, 0
    v_mov_b32 v57, 0
    v_mov_b32 v58, 0
    v_mov_b32 v59, 0
    v_mov_b32 v60, 0
    v_mov_b32 v61, 0
    v_mov_b32 v62, 0
    v_mov_b32 v63, 0
    s_waitcnt vmcnt(16)
    s_barrier
    s_add_u32 s53, s46, s58
    s_add_u32 s54, s46, s59
    v_add_u32 v8, s53, v6
    v_add_u32 v10, s54, v6
    v_add_u32 v9, s53, v7
    v_add_u32 v11, s54, v7
    s_add_u32 s46, s46, 16384
    s_cmp_eq_u32 s46, 98304
    s_cselect_b32 s46, 0, s46
    ds_read_b128 v[32:35], v10 offset:0
    ds_read_b128 v[36:39], v10 offset:2048
    ds_read_b128 v[16:19], v8 offset:0
    ds_read_b128 v[20:23], v8 offset:2048
    v_and_b32 v64, 15, v1
    s_lshl_b32 s51, s56, 5
    s_add_u32 s51, s51, s40
    v_add_u32 v64, s51, v64
    v_mul_u32_u24 v64, 896, v64
    v_lshrrev_b32 v65, 4, v1
    v_lshlrev_b32 v65, 3, v65
    v_add_u32 v64, v64, v65
    s_lshl_b32 s51, s57, 5
    s_add_u32 s51, s51, s41
    s_lshl_b32 s51, s51, 1
    v_add_u32 v64, s51, v64
    s_mov_b32 s55, 7
    s_nop 0
Lg_2:
    ds_read_b128 v[40:43], v11 offset:0
    ds_read_b128 v[44:47], v11 offset:2048
    ds_read_b128 v[24:27], v9 offset:0
    ds_read_b128 v[28:31], v9 offset:2048
    s_waitcnt lgkmcnt(4)
    v_mfma_f32_16x16x32_bf16 v[48:51], v[32:35], v[16:19], v[48:51]
    s_add_u32 s51, s45, s49
    s_add_u32 s52, s45, s50
    v_mfma_f32_16x16x32_bf16 v[52:55], v[36:39], v[16:19], v[52:55]
    s_add_u32 m0, s51, 0
    s_nop 0
    buffer_load_dwordx4 v2, s[8:11], s47 offen lds
    v_mfma_f32_16x16x32_bf16 v[56:59], v[32:35], v[20:23], v[56:59]
    s_add_u32 m0, s51, 1024
    s_nop 0
    buffer_load_dwordx4 v3, s[8:11], s47 offen lds
    v_mfma_f32_16x16x32_bf16 v[60:63], v[36:39], v[20:23], v[60:63]
    s_add_u32 m0, s52, 0
    s_nop 0
    buffer_load_dwordx4 v4, s[12:15], s47 offen lds
    s_add_u32 m0, s52, 1024
    s_nop 0
    buffer_load_dwordx4 v5, s[12:15], s47 offen lds
    s_add_u32 s47, s47, 128
    s_add_u32 s45, s45, 16384
    s_cmp_eq_u32 s45, 98304
    s_cselect_b32 s45, 0, s45
    s_waitcnt vmcnt(16) lgkmcnt(0)
    s_barrier
    s_add_u32 s53, s46, s58
    s_add_u32 s54, s46, s59
    v_add_u32 v8, s53, v6
    v_add_u32 v10, s54, v6
    v_add_u32 v9, s53, v7
    v_add_u32 v11, s54, v7
    s_add_u32 s46, s46, 16384
    s_cmp_eq_u32 s46, 98304
    s_cselect_b32 s46, 0, s46
    ds_read_b128 v[32:35], v10 offset:0
    ds_read_b128 v[36:39], v10 offset:2048
    ds_read_b128 v[16:19], v8 offset:0
    ds_read_b128 v[20:23], v8 offset:2048
    v_mfma_f32_16x16x32_bf16 v[48:51], v[40:43], v[24:27], v[48:51]
    v_mfma_f32_16x16x32_bf16 v[52:55], v[44:47], v[24:27], v[52:55]
    v_mfma_f32_16x16x32_bf16 v[56:59], v[40:43], v[28:31], v[56:59]
    v_mfma_f32_16x16x32_bf16 v[60:63], v[44:47], v[28:31], v[60:63]
    s_sub_u32 s55, s55, 1
    s_cmp_lg_u32 s55, 0
    s_cbranch_scc1 Lg_2
    s_mov_b32 s51, 0
    buffer_load_dwordx2 v[66:67], v64, s[16:19], s51 offen offset:0
    buffer_load_dwordx2 v[68:69], v64, s[16:19], s51 offen offset:32
    s_mov_b32 s51, 14336
    buffer_load_dwordx2 v[70:71], v64, s[16:19], s51 offen offset:0
    buffer_load_dwordx2 v[72:73], v64, s[16:19], s51 offen offset:32
    s_waitcnt vmcnt(0)
    v_cvt_pk_bf16_f32 v90, v48, v49
    v_lshlrev_b32 v48, 16, v90
    v_and_b32 v49, 0xffff0000, v90
    v_cvt_pk_bf16_f32 v90, v50, v51
    v_lshlrev_b32 v50, 16, v90
    v_and_b32 v51, 0xffff0000, v90
    v_lshlrev_b32 v74, 16, v66
    v_and_b32 v75, 0xffff0000, v66
    v_lshlrev_b32 v76, 16, v67
    v_and_b32 v77, 0xffff0000, v67
    v_add_f32 v74, v74, v48
    v_add_f32 v75, v75, v49
    v_add_f32 v76, v76, v50
    v_add_f32 v77, v77, v51
    v_cvt_pk_bf16_f32 v90, v74, v75
    v_lshlrev_b32 v74, 16, v90
    v_and_b32 v75, 0xffff0000, v90
    v_cvt_pk_bf16_f32 v90, v76, v77
    v_lshlrev_b32 v76, 16, v90
    v_and_b32 v77, 0xffff0000, v90
    v_cvt_pk_bf16_f32 v90, v52, v53
    v_lshlrev_b32 v52, 16, v90
    v_and_b32 v53, 0xffff0000, v90
    v_cvt_pk_bf16_f32 v90, v54, v55
    v_lshlrev_b32 v54, 16, v90
    v_and_b32 v55, 0xffff0000, v90
    v_lshlrev_b32 v78, 16, v68
    v_and_b32 v79, 0xffff0000, v68
    v_lshlrev_b32 v80, 16, v69
    v_and_b32 v81, 0xffff0000, v69
    v_add_f32 v78, v78, v52
    v_add_f32 v79, v79, v53
    v_add_f32 v80, v80, v54
    v_add_f32 v81, v81, v55
    v_cvt_pk_bf16_f32 v90, v78, v79
    v_lshlrev_b32 v78, 16, v90
    v_and_b32 v79, 0xffff0000, v90
    v_cvt_pk_bf16_f32 v90, v80, v81
    v_lshlrev_b32 v80, 16, v90
    v_and_b32 v81, 0xffff0000, v90
    v_cvt_pk_bf16_f32 v90, v56, v57
    v_lshlrev_b32 v56, 16, v90
    v_and_b32 v57, 0xffff0000, v90
    v_cvt_pk_bf16_f32 v90, v58, v59
    v_lshlrev_b32 v58, 16, v90
    v_and_b32 v59, 0xffff0000, v90
    v_lshlrev_b32 v82, 16, v70
    v_and_b32 v83, 0xffff0000, v70
    v_lshlrev_b32 v84, 16, v71
    v_and_b32 v85, 0xffff0000, v71
    v_add_f32 v82, v82, v56
    v_add_f32 v83, v83, v57
    v_add_f32 v84, v84, v58
    v_add_f32 v85, v85, v59
    v_cvt_pk_bf16_f32 v90, v82, v83
    v_lshlrev_b32 v82, 16, v90
    v_and_b32 v83, 0xffff0000, v90
    v_cvt_pk_bf16_f32 v90, v84, v85
    v_lshlrev_b32 v84, 16, v90
    v_and_b32 v85, 0xffff0000, v90
    v_cvt_pk_bf16_f32 v90, v60, v61
    v_lshlrev_b32 v60, 16, v90
    v_and_b32 v61, 0xffff0000, v90
    v_cvt_pk_bf16_f32 v90, v62, v63
    v_lshlrev_b32 v62, 16, v90
    v_and_b32 v63, 0xffff0000, v90
    v_lshlrev_b32 v86, 16, v72
    v_and_b32 v87, 0xffff0000, v72
    v_lshlrev_b32 v88, 16, v73
    v_and_b32 v89, 0xffff0000, v73
    v_add_f32 v86, v86, v60
    v_add_f32 v87, v87, v61
    v_add_f32 v88, v88, v62
    v_add_f32 v89, v89, v63
    v_cvt_pk_bf16_f32 v90, v86, v87
    v_lshlrev_b32 v86, 16, v90
    v_and_b32 v87, 0xffff0000, v90
    v_cvt_pk_bf16_f32 v90, v88, v89
    v_lshlrev_b32 v88, 16, v90
    v_and_b32 v89, 0xffff0000, v90
    v_mov_b32 v48, 0
    v_mov_b32 v49, 0
    v_mov_b32 v50, 0
    v_mov_b32 v51, 0
    v_mov_b32 v52, 0
    v_mov_b32 v53, 0
    v_mov_b32 v54, 0
    v_mov_b32 v55, 0
    v_mov_b32 v56, 0
    v_mov_b32 v57, 0
    v_mov_b32 v58, 0
    v_mov_b32 v59, 0
    v_mov_b32 v60, 0
    v_mov_b32 v61, 0
    v_mov_b32 v62, 0
    v_mov_b32 v63, 0
    s_mov_b32 s55, 9
    s_nop 0
Lg_3:
    ds_read_b128 v[40:43], v11 offset:0
    ds_read_b128 v[44:47], v11 offset:2048
    ds_read_b128 v[24:27], v9 offset:0
    ds_read_b128 v[28:31], v9 offset:2048
    s_waitcnt lgkmcnt(4)
    v_mfma_f32_16x16x32_bf16 v[48:51], v[32:35], v[16:19], v[48:51]
    s_add_u32 s51, s45, s49
    s_add_u32 s52, s45, s50
    v_mfma_f32_16x16x32_bf16 v[52:55], v[36:39], v[16:19], v[52:55]
    s_add_u32 m0, s51, 0
    s_nop 0
    buffer_load_dwordx4 v2, s[8:11], s47 offen lds
    v_mfma_f32_16x16x32_bf16 v[56:59], v[32:35], v[20:23], v[56:59]
    s_add_u32 m0, s51, 1024
    s_nop 0
    buffer_load_dwordx4 v3, s[8:11], s47 offen lds
    v_mfma_f32_16x16x32_bf16 v[60:63], v[36:39], v[20:23], v[60:63]
    s_add_u32 m0, s52, 0
    s_nop 0
    buffer_load_dwordx4 v4, s[12:15], s47 offen lds
    s_add_u32 m0, s52, 1024
    s_nop 0
    buffer_load_dwordx4 v5, s[12:15], s47 offen lds
    s_add_u32 s47, s47, 128
    s_add_u32 s45, s45, 16384
    s_cmp_eq_u32 s45, 98304
    s_cselect_b32 s45, 0, s45
    s_waitcnt vmcnt(16) lgkmcnt(0)
    s_barrier
    s_add_u32 s53, s46, s58
    s_add_u32 s54, s46, s59
    v_add_u32 v8, s53, v6
    v_add_u32 v10, s54, v6
    v_add_u32 v9, s53, v7
    v_add_u32 v11, s54, v7
    s_add_u32 s46, s46, 16384
    s_cmp_eq_u32 s46, 98304
    s_cselect_b32 s46, 0, s46
    ds_read_b128 v[32:35], v10 offset:0
    ds_read_b128 v[36:39], v10 offset:2048
    ds_read_b128 v[16:19], v8 offset:0
    ds_read_b128 v[20:23], v8 offset:2048
    v_mfma_f32_16x16x32_bf16 v[48:51], v[40:43], v[24:27], v[48:51]
    v_mfma_f32_16x16x32_bf16 v[52:55], v[44:47], v[24:27], v[52:55]
    v_mfma_f32_16x16x32_bf16 v[56:59], v[40:43], v[28:31], v[56:59]
    v_mfma_f32_16x16x32_bf16 v[60:63], v[44:47], v[28:31], v[60:63]
    s_sub_u32 s55, s55, 1
    s_cmp_lg_u32 s55, 0
    s_cbranch_scc1 Lg_3
    ds_read_b128 v[40:43], v11 offset:0
    ds_read_b128 v[44:47], v11 offset:2048
    ds_read_b128 v[24:27], v9 offset:0
    ds_read_b128 v[28:31], v9 offset:2048
    s_waitcnt lgkmcnt(4)
    v_mfma_f32_16x16x32_bf16 v[48:51], v[32:35], v[16:19], v[48:51]
    v_mfma_f32_16x16x32_bf16 v[52:55], v[36:39], v[16:19], v[52:55]
    v_mfma_f32_16x16x32_bf16 v[56:59], v[32:35], v[20:23], v[56:59]
    v_mfma_f32_16x16x32_bf16 v[60:63], v[36:39], v[20:23], v[60:63]
    s_waitcnt vmcnt(12) lgkmcnt(0)
    s_barrier
    s_add_u32 s53, s46, s58
    s_add_u32 s54, s46, s59
    v_add_u32 v8, s53, v6
    v_add_u32 v10, s54, v6
    v_add_u32 v9, s53, v7
    v_add_u32 v11, s54, v7
    s_add_u32 s46, s46, 16384
    s_cmp_eq_u32 s46, 98304
    s_cselect_b32 s46, 0, s46
    ds_read_b128 v[32:35], v10 offset:0
    ds_read_b128 v[36:39], v10 offset:2048
    ds_read_b128 v[16:19], v8 offset:0
    ds_read_b128 v[20:23], v8 offset:2048
    v_mfma_f32_16x16x32_bf16 v[48:51], v[40:43], v[24:27], v[48:51]
    v_mfma_f32_16x16x32_bf16 v[52:55], v[44:47], v[24:27], v[52:55]
    v_mfma_f32_16x16x32_bf16 v[56:59], v[40:43], v[28:31], v[56:59]
    v_mfma_f32_16x16x32_bf16 v[60:63], v[44:47], v[28:31], v[60:63]
    ds_read_b128 v[40:43], v11 offset:0
    ds_read_b128 v[44:47], v11 offset:2048
    ds_read_b128 v[24:27], v9 offset:0
    ds_read_b128 v[28:31], v9 offset:2048
    s_waitcnt lgkmcnt(4)
    v_mfma_f32_16x16x32_bf16 v[48:51], v[32:35], v[16:19], v[48:51]
    v_mfma_f32_16x16x32_bf16 v[52:55], v[36:39], v[16:19], v[52:55]
    v_mfma_f32_16x16x32_bf16 v[56:59], v[32:35], v[20:23], v[56:59]
    v_mfma_f32_16x16x32_bf16 v[60:63], v[36:39], v[20:23], v[60:63]
    s_waitcnt vmcnt(8) lgkmcnt(0)
    s_barrier
    s_add_u32 s53, s46, s58
    s_add_u32 s54, s46, s59
    v_add_u32 v8, s53, v6
    v_add_u32 v10, s54, v6
    v_add_u32 v9, s53, v7
    v_add_u32 v11, s54, v7
    s_add_u32 s46, s46, 16384
    s_cmp_eq_u32 s46, 98304
    s_cselect_b32 s46, 0, s46
    ds_read_b128 v[32:35], v10 offset:0
    ds_read_b128 v[36:39], v10 offset:2048
    ds_read_b128 v[16:19], v8 offset:0
    ds_read_b128 v[20:23], v8 offset:2048
    v_mfma_f32_16x16x32_bf16 v[48:51], v[40:43], v[24:27], v[48:51]
    v_mfma_f32_16x16x32_bf16 v[52:55], v[44:47], v[24:27], v[52:55]
    v_mfma_f32_16x16x32_bf16 v[56:59], v[40:43], v[28:31], v[56:59]
    v_mfma_f32_16x16x32_bf16 v[60:63], v[44:47], v[28:31], v[60:63]
    ds_read_b128 v[40:43], v11 offset:0
    ds_read_b128 v[44:47], v11 offset:2048
    ds_read_b128 v[24:27], v9 offset:0
    ds_read_b128 v[28:31], v9 offset:2048
    s_waitcnt lgkmcnt(4)
    v_mfma_f32_16x16x32_bf16 v[48:51], v[32:35], v[16:19], v[48:51]
    v_mfma_f32_16x16x32_bf16 v[52:55], v[36:39], v[16:19], v[52:55]
    v_mfma_f32_16x16x32_bf16 v[56:59], v[32:35], v[20:23], v[56:59]
    v_mfma_f32_16x16x32_bf16 v[60:63], v[36:39], v[20:23], v[60:63]
    s_waitcnt vmcnt(4) lgkmcnt(0)
    s_barrier
    s_add_u32 s53, s46, s58
    s_add_u32 s54, s46, s59
    v_add_u32 v8, s53, v6
    v_add_u32 v10, s54, v6
    v_add_u32 v9, s53, v7
    v_add_u32 v11, s54, v7
    s_add_u32 s46, s46, 16384
    s_cmp_eq_u32 s46, 98304
    s_cselect_b32 s46, 0, s46
    ds_read_b128 v[32:35], v10 offset:0
    ds_read_b128 v[36:39], v10 offset:2048
    ds_read_b128 v[16:19], v8 offset:0
    ds_read_b128 v[20:23], v8 offset:2048
    v_mfma_f32_16x16x32_bf16 v[48:51], v[40:43], v[24:27], v[48:51]
    v_mfma_f32_16x16x32_bf16 v[52:55], v[44:47], v[24:27], v[52:55]
    v_mfma_f32_16x16x32_bf16 v[56:59], v[40:43], v[28:31], v[56:59]
    v_mfma_f32_16x16x32_bf16 v[60:63], v[44:47], v[28:31], v[60:63]
    ds_read_b128 v[40:43], v11 offset:0
    ds_read_b128 v[44:47], v11 offset:2048
    ds_read_b128 v[24:27], v9 offset:0
    ds_read_b128 v[28:31], v9 offset:2048
    s_waitcnt lgkmcnt(4)
    v_mfma_f32_16x16x32_bf16 v[48:51], v[32:35], v[16:19], v[48:51]
    v_mfma_f32_16x16x32_bf16 v[52:55], v[36:39], v[16:19], v[52:55]
    v_mfma_f32_16x16x32_bf16 v[56:59], v[32:35], v[20:23], v[56:59]
    v_mfma_f32_16x16x32_bf16 v[60:63], v[36:39], v[20:23], v[60:63]
    s_waitcnt vmcnt(0) lgkmcnt(0)
    s_barrier
    s_add_u32 s53, s46, s58
    s_add_u32 s54, s46, s59
    v_add_u32 v8, s53, v6
    v_add_u32 v10, s54, v6
    v_add_u32 v9, s53, v7
    v_add_u32 v11, s54, v7
    s_add_u32 s46, s46, 16384
    s_cmp_eq_u32 s46, 98304
    s_cselect_b32 s46, 0, s46
    ds_read_b128 v[32:35], v10 offset:0
    ds_read_b128 v[36:39], v10 offset:2048
    ds_read_b128 v[16:19], v8 offset:0
    ds_read_b128 v[20:23], v8 offset:2048
    v_mfma_f32_16x16x32_bf16 v[48:51], v[40:43], v[24:27], v[48:51]
    v_mfma_f32_16x16x32_bf16 v[52:55], v[44:47], v[24:27], v[52:55]
    v_mfma_f32_16x16x32_bf16 v[56:59], v[40:43], v[28:31], v[56:59]
    v_mfma_f32_16x16x32_bf16 v[60:63], v[44:47], v[28:31], v[60:63]
    ds_read_b128 v[40:43], v11 offset:0
    ds_read_b128 v[44:47], v11 offset:2048
    ds_read_b128 v[24:27], v9 offset:0
    ds_read_b128 v[28:31], v9 offset:2048
    s_waitcnt lgkmcnt(4)
    v_mfma_f32_16x16x32_bf16 v[48:51], v[32:35], v[16:19], v[48:51]
    v_mfma_f32_16x16x32_bf16 v[52:55], v[36:39], v[16:19], v[52:55]
    v_mfma_f32_16x16x32_bf16 v[56:59], v[32:35], v[20:23], v[56:59]
    v_mfma_f32_16x16x32_bf16 v[60:63], v[36:39], v[20:23], v[60:63]
    s_waitcnt lgkmcnt(0)
    v_mfma_f32_16x16x32_bf16 v[48:51], v[40:43], v[24:27], v[48:51]
    v_mfma_f32_16x16x32_bf16 v[52:55], v[44:47], v[24:27], v[52:55]
    v_mfma_f32_16x16x32_bf16 v[56:59], v[40:43], v[28:31], v[56:59]
    v_mfma_f32_16x16x32_bf16 v[60:63], v[44:47], v[28:31], v[60:63]
    s_nop 4
    v_cvt_pk_bf16_f32 v90, v48, v49
    v_lshlrev_b32 v48, 16, v90
    v_and_b32 v49, 0xffff0000, v90
    v_cvt_pk_bf16_f32 v90, v50, v51
    v_lshlrev_b32 v50, 16, v90
    v_and_b32 v51, 0xffff0000, v90
    v_add_f32 v74, v74, v48
    v_add_f32 v75, v75, v49
    v_add_f32 v76, v76, v50
    v_add_f32 v77, v77, v51
    v_cvt_pk_bf16_f32 v66, v74, v75
    v_cvt_pk_bf16_f32 v67, v76, v77
    s_mov_b32 s51, 0
    buffer_store_dwordx2 v[66:67], v64, s[20:23], s51 offen offset:0
    v_cvt_pk_bf16_f32 v90, v52, v53
    v_lshlrev_b32 v52, 16, v90
    v_and_b32 v53, 0xffff0000, v90
    v_cvt_pk_bf16_f32 v90, v54, v55
    v_lshlrev_b32 v54, 16, v90
    v_and_b32 v55, 0xffff0000, v90
    v_add_f32 v78, v78, v52
    v_add_f32 v79, v79, v53
    v_add_f32 v80, v80, v54
    v_add_f32 v81, v81, v55
    v_cvt_pk_bf16_f32 v68, v78, v79
    v_cvt_pk_bf16_f32 v69, v80, v81
    s_mov_b32 s51, 0
    buffer_store_dwordx2 v[68:69], v64, s[20:23], s51 offen offset:32
    v_cvt_pk_bf16_f32 v90, v56, v57
    v_lshlrev_b32 v56, 16, v90
    v_and_b32 v57, 0xffff0000, v90
    v_cvt_pk_bf16_f32 v90, v58, v59
    v_lshlrev_b32 v58, 16, v90
    v_and_b32 v59, 0xffff0000, v90
    v_add_f32 v82, v82, v56
    v_add_f32 v83, v83, v57
    v_add_f32 v84, v84, v58
    v_add_f32 v85, v85, v59
    v_cvt_pk_bf16_f32 v70, v82, v83
    v_cvt_pk_bf16_f32 v71, v84, v85
    s_mov_b32 s51, 14336
    buffer_store_dwordx2 v[70:71], v64, s[20:23], s51 offen offset:0
    v_cvt_pk_bf16_f32 v90, v60, v61
    v_lshlrev_b32 v60, 16, v90
    v_and_b32 v61, 0xffff0000, v90
    v_cvt_pk_bf16_f32 v90, v62, v63
    v_lshlrev_b32 v62, 16, v90
    v_and_b32 v63, 0xffff0000, v90
    v_add_f32 v86, v86, v60
    v_add_f32 v87, v87, v61
    v_add_f32 v88, v88, v62
    v_add_f32 v89, v89, v63
    v_cvt_pk_bf16_f32 v72, v86, v87
    v_cvt_pk_bf16_f32 v73, v88, v89
    s_mov_b32 s51, 14336
    buffer_store_dwordx2 v[72:73], v64, s[20:23], s51 offen offset:32
    s_nop 1
K3_END:
K3_EXIT:
    s_endpgm
.section .rodata,"a"
.p2align 6
.amdhsa_kernel k1_front_kernel
  .amdhsa_next_free_vgpr 256
  .amdhsa_next_free_sgpr 102
  .amdhsa_accum_offset 256
  .amdhsa_group_segment_fixed_size 0
  .amdhsa_kernarg_size 96
  .amdhsa_user_sgpr_count 2
  .amdhsa_user_sgpr_kernarg_segment_ptr 1
  .amdhsa_system_sgpr_workgroup_id_x 1
.end_amdhsa_kernel

.p2align 6
.amdhsa_kernel k2_spatial_kernel
  .amdhsa_next_free_vgpr 144
  .amdhsa_next_free_sgpr 102
  .amdhsa_accum_offset 144
  .amdhsa_group_segment_fixed_size 0
  .amdhsa_kernarg_size 96
  .amdhsa_user_sgpr_count 2
  .amdhsa_user_sgpr_kernarg_segment_ptr 1
  .amdhsa_system_sgpr_workgroup_id_x 1
.end_amdhsa_kernel

.p2align 6
.amdhsa_kernel k3_final_kernel
  .amdhsa_next_free_vgpr 94
  .amdhsa_next_free_sgpr 102
  .amdhsa_accum_offset 96
  .amdhsa_group_segment_fixed_size 0
  .amdhsa_kernarg_size 96
  .amdhsa_user_sgpr_count 2
  .amdhsa_user_sgpr_kernarg_segment_ptr 1
  .amdhsa_system_sgpr_workgroup_id_x 1
.end_amdhsa_kernel
```
